```python
import torch

def _softmax(x, axis=-1):
    return torch.softmax(x, dim=axis)
def _gelu(x):
    return torch.nn.functional.gelu(x, approximate="tanh")
def _silu(x):
    return torch.nn.functional.silu(x)
def _sigmoid(x):
    return torch.sigmoid(x)
def _layernorm(x, axis=-1, eps=1e-5):
    m = x.mean(dim=axis, keepdim=True)
    v = x.var(dim=axis, keepdim=True, unbiased=False)
    return (x - m) / torch.sqrt(v + eps)
def _scatter_add(tgt, idx, src, axis=0):
    return tgt.clone().index_add_(axis, idx, src)
def _segment_sum(src, seg, n):
    out = torch.zeros((n,) + src.shape[1:], dtype=src.dtype)
    return out.index_add_(0, seg, src)
def _pad(x, pw):
    flat = tuple(v for pair in reversed(pw) for v in pair)
    return torch.nn.functional.pad(x, flat)

kernel_name = 'interleave_layers__sliding_local_dilated__linear_kernel_hedgehog__prompt'

def setup_inputs():

    _w = (lambda a: (lambda t: t.to(torch.bfloat16) if t.is_floating_point() else t)(torch.as_tensor(a)))
    def _A_setup():
        B, S, D = 1, 2048, 512
        return {
            "x": _w((lambda *s: torch.randn(*s, dtype=torch.bfloat16) * 0.05)(B, S, D)),
            "wqkv": _w((lambda *s: torch.randn(*s, dtype=torch.bfloat16) * 0.05)(D, 3 * D)),
            "wo": _w((lambda *s: torch.randn(*s, dtype=torch.bfloat16) * 0.05)(D, D)),
        }
    _A_in = _A_setup()

    def _B_setup():
        B, S, D, H = 1, 2048, 512, 32
        Dh = D // H
        return {
            "x": _w((lambda *s: torch.randn(*s, dtype=torch.bfloat16) * 0.05)(B, S, D)),
            "wqkv": _w((lambda *s: torch.randn(*s, dtype=torch.bfloat16) * 0.4)(D, 3 * D)),
            "w_phi": _w((lambda *s: torch.randn(*s, dtype=torch.bfloat16) * 0.4)(H, Dh, Dh) * (Dh ** -0.5)),
            "wo": _w((lambda *s: torch.randn(*s, dtype=torch.bfloat16) * 0.1)(D, D)),
        }
    _B_in = _B_setup()

    return {
        "A_x": _A_in["x"],
        "A_wqkv": _A_in["wqkv"],
        "A_wo": _A_in["wo"],
        "B_x": _B_in["x"],
        "B_wqkv": _B_in["wqkv"],
        "B_w_phi": _B_in["w_phi"],
        "B_wo": _B_in["wo"],
    }

def reference(A_x, A_wqkv, A_wo, B_x, B_wqkv, B_w_phi, B_wo):
    def _A_ref(x, wqkv, wo):
        B, S, D = x.shape
        H = 32; Dh = D // H
        W, dil = 8, 2
        qkv = (lambda x, *d: x.permute(*d))((x @ wqkv).reshape(B, S, 3, H, Dh), 2, 0, 3, 1, 4)
        q, k, v = qkv[0], qkv[1], qkv[2]
        scale = Dh ** -0.5
        pos = torch.arange(S)
        off = torch.arange(W) * dil
        idx = pos[:, None] - off[None, :]
        mask = idx >= 0
        idx_c = torch.where(mask, idx, 0).reshape(-1)
        kg = k[:, :, idx_c, :].reshape(B, H, S, W, Dh)
        vg = v[:, :, idx_c, :].reshape(B, H, S, W, Dh)
        logits = torch.einsum("bhsd,bhswd->bhsw", q, kg) * scale
        logits = torch.where(mask[None, None, :, :], logits, -1e9)
        attn = _softmax(logits, axis=-1)
        o = torch.einsum("bhsw,bhswd->bhsd", attn, vg)
        return (lambda x, *d: x.permute(*d))(o, 0, 2, 1, 3).reshape(B, S, D) @ wo

    def _B_ref(x, wqkv, w_phi, wo):
        B, S, D = x.shape
        H = 32; Dh = D // H
        qkv = (lambda x, *d: x.permute(*d))((x @ wqkv).reshape(B, S, 3, H, Dh), 2, 0, 3, 1, 4)
        q, k, v = qkv[0], qkv[1], qkv[2]
        pq = torch.einsum("bhsd,hdf->bhsf", q, w_phi)
        pk = torch.einsum("bhsd,hdf->bhsf", k, w_phi)
        phi_q = torch.concatenate([_softmax(pq, axis=-1), _softmax(-pq, axis=-1)], axis=-1)
        phi_k = torch.concatenate([_softmax(pk, axis=-1), _softmax(-pk, axis=-1)], axis=-1)
        kv = torch.einsum("bhsf,bhsd->bhfd", phi_k, v)
        z  = torch.einsum("bhsf->bhf", phi_k)
        num = torch.einsum("bhqf,bhfd->bhqd", phi_q, kv)
        den = torch.einsum("bhqf,bhf->bhq", phi_q, z)[..., None] + 1e-6
        o = num / den
        return (lambda x, *d: x.permute(*d))(o, 0, 2, 1, 3).reshape(B, S, D) @ wo

    x = A_x
    x = x + _A_ref(_layernorm(x, axis=-1), A_wqkv, A_wo)
    x = x + _B_ref(_layernorm(x, axis=-1), B_wqkv, B_w_phi, B_wo)
    x = x + _A_ref(_layernorm(x, axis=-1), A_wqkv, A_wo)
    x = x + _B_ref(_layernorm(x, axis=-1), B_wqkv, B_w_phi, B_wo)
    return x
```

```asm
; @launch grid=(256,1,1) block=(256,1,1) lds=163840
.amdgcn_target "amdgcn-amd-amdhsa--gfx950"
.text
.globl interleave_layers__sliding_local_dilated__linear_kernel_hedgehog__prompt_kernel
.p2align 8
.type interleave_layers__sliding_local_dilated__linear_kernel_hedgehog__prompt_kernel,@function
interleave_layers__sliding_local_dilated__linear_kernel_hedgehog__prompt_kernel:
    s_load_dwordx2 s[8:9], s[0:1], 0
    s_load_dwordx2 s[12:13], s[0:1], 8
    s_cmp_ge_u32 s2, 256
    s_cbranch_scc1 L_exit
    v_and_b32 v1, 63, v0
    v_lshrrev_b32 v0, 6, v0
    v_lshlrev_b32 v1, 4, v1
    s_lshr_b32 s51, s2, 3
    s_and_b32 s44, s2, 7
    s_getpc_b64 s[36:37]
L_pc:
    s_sub_u32 s36, s36, L_pc-interleave_layers__sliding_local_dilated__linear_kernel_hedgehog__prompt_kernel
    s_subb_u32 s37, s37, 0
    s_mov_b32 s38, L_code_end-interleave_layers__sliding_local_dilated__linear_kernel_hedgehog__prompt_kernel
    s_mov_b32 s39, 0x20000
    v_lshlrev_b32 v2, 3, v1
    s_lshl_b32 s80, s51, 11
    s_mov_b32 exec_lo, 0xffff
    s_mov_b32 exec_hi, 0
    buffer_load_dword v2, v2, s[36:39], s80 offen
    s_mov_b64 exec, -1
    v_readfirstlane_b32 s40, v0
    s_and_b32 s41, s51, 7
    s_lshr_b32 s42, s51, 3
    s_lshl2_add_u32 s43, s44, s42
    s_lshl_b32 s45, s42, 1
    s_xor_b32 s45, s45, s41
    s_mul_i32 s52, s45, 196608
    s_mov_b32 s10, 2097152
    s_mov_b32 s11, 0x20000
    s_mov_b32 s14, 1572864
    s_mov_b32 s15, 0x20000
    v_lshrrev_b32 v5, 7, v1
    v_lshrrev_b32 v6, 4, v1
    v_xor_b32 v6, v6, v1
    v_and_b32 v6, 0x70, v6
    s_lshl_b32 s84, s43, 16
    s_lshl_b32 s85, s40, 14
    s_add_u32 s85, s85, s84
    v_lshl_add_u32 v0, v5, 10, v6
    v_add_u32 v0, s85, v0
    v_xor_b32 v3, 64, v0
    v_add_u32 v3, 7168, v3
    s_lshl_b32 s85, s40, 2
    v_add_u32 v5, s85, v5
    v_lshlrev_b32 v6, 3, v5
    v_xor_b32 v6, v6, v1
    v_and_b32 v6, 0x70, v6
    s_sub_u32 s85, s84, 16384
    s_max_i32 s85, s85, 0
    v_lshl_add_u32 v4, v5, 10, v6
    v_add_u32 v4, s85, v4
    v_lshrrev_b32 v7, 7, v1
    v_bfe_u32 v8, v1, 8, 1
    s_and_b32 s84, s40, 1
    s_lshl_b32 s84, s84, 1
    v_or_b32 v8, s84, v8
    v_and_b32 v9, 0x70, v1
    v_lshlrev_b32 v8, 5, v8
    v_xor_b32 v8, v8, v9
    v_mul_u32_u24 v7, 3072, v7
    s_mul_i32 s84, s40, 24576
    s_lshl_b32 s85, s41, 7
    s_add_u32 s84, s84, s85
    v_add3_u32 v7, v7, v8, s84
    v_add_u32 v8, 98304, v7
    s_lshl_b32 s88, s40, 14
    s_lshl_b32 s89, s40, 9
    s_add_u32 s89, s89, 139264
    s_mul_i32 s90, s40, 3072
    s_add_u32 s90, s90, 65536
    s_lshl_b32 s91, s45, 7
    s_cmp_eq_u32 s40, 0
    s_cselect_b32 s94, 0xffffff00, -1
    s_mov_b32 s95, 0
    s_waitcnt lgkmcnt(0)
    s_xor_b32 s87, s91, 0
    s_add_u32 m0, s88, 0
    s_nop 0
    buffer_load_dwordx4 v0, s[8:11], s87 offen lds
    buffer_load_dwordx4 v3, s[8:11], s87 offen offset:1024 lds
    s_add_u32 m0, s89, 0
    s_mov_b64 exec, s[94:95]
    buffer_load_dwordx4 v4, s[8:11], s87 offen lds
    s_mov_b64 exec, -1
    s_add_u32 m0, s90, 0
    s_nop 0
    buffer_load_dwordx4 v7, s[12:15], s52 offen offset:0 lds
    buffer_load_dwordx4 v7, s[12:15], s52 offen offset:1024 lds
    buffer_load_dwordx4 v7, s[12:15], s52 offen offset:2048 lds
    s_add_u32 m0, s90, 12288
    s_nop 0
    buffer_load_dwordx4 v8, s[12:15], s52 offen offset:0 lds
    buffer_load_dwordx4 v8, s[12:15], s52 offen offset:1024 lds
    buffer_load_dwordx4 v8, s[12:15], s52 offen offset:2048 lds
    s_load_dwordx2 s[16:17], s[0:1], 16
    s_load_dwordx2 s[20:21], s[0:1], 32
    s_load_dwordx2 s[24:25], s[0:1], 48
    s_load_dwordx2 s[28:29], s[0:1], 56
    s_load_dwordx2 s[32:33], s[0:1], 72
    s_load_dwordx2 s[4:5], s[0:1], 40
    s_xor_b32 s53, s45, 1
    s_mul_i32 s53, s53, 196608
    s_xor_b32 s54, s45, 2
    s_mul_i32 s54, s54, 196608
    s_xor_b32 s55, s45, 3
    s_mul_i32 s55, s55, 196608
    s_xor_b32 s56, s45, 4
    s_mul_i32 s56, s56, 196608
    s_xor_b32 s57, s45, 5
    s_mul_i32 s57, s57, 196608
    s_xor_b32 s58, s45, 6
    s_mul_i32 s58, s58, 196608
    s_xor_b32 s59, s45, 7
    s_mul_i32 s59, s59, 196608
    s_mov_b32 s18, 524288
    s_mov_b32 s19, 0x20000
    s_mov_b32 s22, 1572864
    s_mov_b32 s23, 0x20000
    s_mov_b32 s26, 524288
    s_mov_b32 s27, 0x20000
    s_mov_b32 s30, 2097152
    s_mov_b32 s31, 0x20000
    s_mov_b32 s34, 268435456
    s_mov_b32 s35, 0x20000
    s_waitcnt lgkmcnt(0)
    s_load_dword s46, s[32:33], 0
    s_mov_b32 s36, s4
    s_mov_b32 s37, s5
    s_mov_b32 s38, 16384
    s_mov_b32 s39, 0x20000
    s_getreg_b32 s49, hwreg(HW_REG_XCC_ID, 0, 4)
    s_mov_b32 s48, 0x8000
    s_mul_i32 s50, s44, 1048576
    s_add_u32 s50, s50, 1048576
    s_mul_i32 s80, s42, 131072
    s_add_u32 s80, s80, s50
    s_lshl_b32 s81, s41, 2
    s_add_u32 s81, s81, s40
    s_mul_i32 s75, s81, 10240
    s_add_u32 s75, s75, 65536
    s_lshl3_add_u32 s72, s81, s42
    s_mul_i32 s72, s72, 1152
    s_add_u32 s72, s72, s50
    s_add_u32 s72, s72, 655360
    s_lshl_b32 s60, s81, 9
    s_add_u32 s60, s60, s80
    s_lshl_b32 s61, s40, 14
    s_add_u32 s61, s61, s80
    s_lshl_b32 s62, s41, 11
    s_add_u32 s62, s62, s61
    s_add_u32 s62, s62, 65536
    s_lshr_b32 s63, s45, 1
    s_xor_b32 s63, s63, s40
    s_lshl_b32 s63, s63, 12
    s_add_u32 s63, s63, s80
    s_add_u32 s63, s63, 65536
    s_lshl_b32 s65, s42, 2
    s_add_u32 s65, s65, s40
    s_lshl_b32 s65, s65, 10
    s_add_u32 s65, s65, s50
    s_add_u32 s65, s65, 532480
    s_lshr_b32 s64, s41, 1
    s_lshl_b32 s64, s64, 8
    s_and_b32 s80, s41, 1
    s_lshl_b32 s80, s80, 3
    s_add_u32 s64, s64, s80
    s_add_u32 s64, s64, s65
    s_lshl_b32 s66, s42, 7
    s_add_u32 s66, s66, s50
    s_add_u32 s66, s66, 524288
    s_lshl_b32 s67, s41, 2
    s_add_u32 s67, s67, s66
    s_lshl_b32 s68, s40, 12
    s_lshl_b32 s69, s40, 10
    s_lshl_b32 s70, s42, 14
    s_add_u32 s70, s70, s69
    s_add_u32 s70, s70, 65536
    s_lshl_b32 s71, s42, 17
    s_lshl_b32 s81, s41, 2
    s_add_u32 s81, s81, s42
    s_mul_i32 s73, s81, 9216
    s_add_u32 s73, s73, s50
    s_add_u32 s73, s73, 655360
    s_lshl_b32 s74, s81, 3
    s_add_u32 s74, s74, s44
    s_mul_i32 s74, s74, 1280
    s_add_u32 s74, s74, 65536
    s_cmp_eq_u32 s43, 0
    s_cselect_b32 s77, 0xf149f2ca, 0
    v_or_b32 v9, s40, v1
    v_cmp_eq_u32 vcc, 0, v9
    v_mov_b32 v9, 0x40000000
    s_nop 0
    v_cndmask_b32 v9, v9, 0, vcc
    v_lshrrev_b32 v20, 7, v1
    v_bfe_u32 v21, v1, 8, 1
    s_and_b32 s80, s40, 1
    s_lshl_b32 s80, s80, 1
    v_or_b32 v21, s80, v21
    v_and_b32 v22, 0x70, v1
    v_lshlrev_b32 v21, 5, v21
    v_xor_b32 v21, v21, v22
    v_mul_u32_u24 v20, 1024, v20
    s_mul_i32 s80, s40, 8192
    s_lshl_b32 s81, s41, 7
    s_add_u32 s80, s80, s81
    v_add3_u32 v20, v20, v21, s80
    v_mov_b32 v22, 0x3f803f80
    v_mov_b32 v23, 0x3f803f80
    v_mov_b32 v24, 0x3f803f80
    v_mov_b32 v25, 0x3f803f80
    v_lshrrev_b32 v5, 7, v1
    v_and_b32 v6, 0x70, v1
    v_lshl_add_u32 v5, v5, 11, v6
    v_add_u32 v5, 139264, v5
    ds_write_b128 v5, v[22:25]
    v_and_b32 v21, 0xf0, v1
    v_lshlrev_b32 v21, 3, v21
    v_lshrrev_b32 v5, 1, v1
    v_and_b32 v5, 0x70, v5
    v_lshrrev_b32 v6, 5, v1
    v_and_b32 v6, 0x10, v6
    v_xor_b32 v6, v6, v5
    v_bfe_u32 v31, v1, 8, 1
    v_lshl_or_b32 v6, v31, 3, v6
    s_lshl_b32 s80, s42, 12
    s_add_u32 s80, s80, s88
    v_add3_u32 v31, v6, v21, s80
    v_xor_b32 v32, 32, v31
    v_xor_b32 v33, 64, v31
    v_xor_b32 v34, 96, v31
    v_lshrrev_b32 v6, 4, v1
    v_and_b32 v6, 0x30, v6
    v_xor_b32 v6, v6, v5
    v_or_b32 v21, v21, v6
    v_xor_b32 v26, 64, v21
    v_add_u32 v27, 139264, v21
    v_add_u32 v28, 139264, v26
    v_add_u32 v29, s88, v21
    v_add_u32 v30, s88, v26
    v_bfe_u32 v36, v1, 7, 2
    v_xor_b32 v36, s40, v36
    v_lshrrev_b32 v35, 8, v1
    v_mul_u32_u24 v35, 3072, v35
    v_lshl_add_u32 v35, v36, 5, v35
    v_bfe_u32 v36, v1, 6, 2
    v_lshl_add_u32 v35, v36, 7, v35
    v_bfe_u32 v36, v1, 4, 2
    v_lshl_add_u32 v35, v36, 3, v35
    v_add_u32 v35, 65536, v35
    s_xor_b32 s87, s91, 128
    s_add_u32 m0, s88, 2048
    s_nop 0
    buffer_load_dwordx4 v0, s[8:11], s87 offen lds
    buffer_load_dwordx4 v3, s[8:11], s87 offen offset:1024 lds
    s_add_u32 m0, s89, 2048
    s_mov_b64 exec, s[94:95]
    buffer_load_dwordx4 v4, s[8:11], s87 offen lds
    s_mov_b64 exec, -1
    s_add_u32 m0, s90, 24576
    s_nop 0
    buffer_load_dwordx4 v7, s[12:15], s53 offen offset:0 lds
    buffer_load_dwordx4 v7, s[12:15], s53 offen offset:1024 lds
    buffer_load_dwordx4 v7, s[12:15], s53 offen offset:2048 lds
    s_add_u32 m0, s90, 36864
    s_nop 0
    buffer_load_dwordx4 v8, s[12:15], s53 offen offset:0 lds
    buffer_load_dwordx4 v8, s[12:15], s53 offen offset:1024 lds
    buffer_load_dwordx4 v8, s[12:15], s53 offen offset:2048 lds
    v_lshlrev_b32 v68, 3, v1
    s_lshl_b32 s80, s2, 2
    s_add_u32 s80, s80, s40
    s_mul_i32 s81, s80, 1536
    s_lshl_b32 s82, s80, 9
    s_mov_b32 exec_lo, 0xfff
    s_mov_b32 exec_hi, 0
    buffer_load_dword v69, v68, s[20:23], s81 offen
    s_mov_b32 exec_lo, 0xf
    buffer_load_dword v70, v68, s[16:19], s82 offen
    buffer_load_dword v71, v68, s[24:27], s82 offen
    s_mov_b64 exec, -1
    s_waitcnt vmcnt(12) lgkmcnt(0)
    s_barrier
    ds_read_b128 v[164:167], v29 offset:0
    ds_read_b128 v[160:163], v27 offset:0
    ds_read_b64_tr_b16 a[0:1], v35 offset:0
    ds_read_b64_tr_b16 a[2:3], v35 offset:512
    ds_read_b64_tr_b16 a[64:65], v35 offset:1024
    ds_read_b64_tr_b16 a[66:67], v35 offset:1536
    ds_read_b64_tr_b16 a[128:129], v35 offset:2048
    ds_read_b64_tr_b16 a[130:131], v35 offset:2560
    ds_read_b128 v[144:147], v21 offset:0
    ds_read_b128 v[148:151], v21 offset:16384
    ds_read_b128 v[152:155], v21 offset:32768
    ds_read_b128 v[156:159], v21 offset:49152
    s_waitcnt lgkmcnt(11)
    v_mfma_f32_16x16x32_bf16 v[132:135], v[22:25], v[164:167], 0
    ds_read_b128 v[188:191], v30 offset:0
    v_mfma_f32_16x16x32_bf16 v[136:139], v[164:167], v[164:167], 0
    ds_read_b128 v[184:187], v28 offset:0
    s_xor_b32 s87, s91, 256
    s_waitcnt lgkmcnt(12)
    v_mfma_f32_16x16x32_bf16 v[140:143], v[160:163], v[160:163], 0
    s_waitcnt lgkmcnt(5)
    s_add_u32 m0, s88, 4096
    v_mfma_f32_16x16x32_bf16 v[88:91], a[0:3], v[160:163], 0
    ds_read_b64_tr_b16 a[4:5], v35 offset:12288
    buffer_load_dwordx4 v0, s[8:11], s87 offen lds
    v_mfma_f32_16x16x32_bf16 v[108:111], a[64:67], v[160:163], 0
    ds_read_b64_tr_b16 a[6:7], v35 offset:12800
    v_mfma_f32_16x16x32_bf16 v[128:131], v[160:163], a[128:131], 0
    ds_read_b64_tr_b16 a[68:69], v35 offset:13312
    buffer_load_dwordx4 v3, s[8:11], s87 offen offset:1024 lds
    v_mfma_f32_16x16x32_bf16 v[72:75], a[0:3], v[144:147], 0
    ds_read_b64_tr_b16 a[70:71], v35 offset:13824
    v_mfma_f32_16x16x32_bf16 v[92:95], a[64:67], v[144:147], 0
    ds_read_b64_tr_b16 a[132:133], v35 offset:14336
    v_mfma_f32_16x16x32_bf16 v[112:115], v[144:147], a[128:131], 0
    s_waitcnt lgkmcnt(7)
    v_mfma_f32_16x16x32_bf16 v[76:79], a[0:3], v[148:151], 0
    ds_read_b64_tr_b16 a[134:135], v35 offset:14848
    s_add_u32 m0, s89, 4096
    v_mfma_f32_16x16x32_bf16 v[96:99], a[64:67], v[148:151], 0
    ds_read_b128 v[168:171], v26 offset:0
    v_mfma_f32_16x16x32_bf16 v[116:119], v[148:151], a[128:131], 0
    ds_read_b128 v[172:175], v26 offset:16384
    v_mfma_f32_16x16x32_bf16 v[80:83], a[0:3], v[152:155], 0
    ds_read_b128 v[176:179], v26 offset:32768
    v_mfma_f32_16x16x32_bf16 v[100:103], a[64:67], v[152:155], 0
    ds_read_b128 v[180:183], v26 offset:49152
    s_mov_b64 exec, s[94:95]
    buffer_load_dwordx4 v4, s[8:11], s87 offen lds
    s_mov_b64 exec, -1
    v_mfma_f32_16x16x32_bf16 v[120:123], v[152:155], a[128:131], 0
    s_add_u32 m0, s90, 49152
    v_mfma_f32_16x16x32_bf16 v[84:87], a[0:3], v[156:159], 0
    v_mfma_f32_16x16x32_bf16 v[104:107], a[64:67], v[156:159], 0
    buffer_load_dwordx4 v7, s[12:15], s54 offen offset:0 lds
    v_mfma_f32_16x16x32_bf16 v[124:127], v[156:159], a[128:131], 0
    s_waitcnt lgkmcnt(10)
    v_mfma_f32_16x16x32_bf16 v[132:135], v[22:25], v[188:191], v[132:135]
    v_mfma_f32_16x16x32_bf16 v[136:139], v[188:191], v[188:191], v[136:139]
    buffer_load_dwordx4 v7, s[12:15], s54 offen offset:1024 lds
    v_mfma_f32_16x16x32_bf16 v[140:143], v[184:187], v[184:187], v[140:143]
    s_waitcnt vmcnt(8) lgkmcnt(0)
    s_barrier
    v_mfma_f32_16x16x32_bf16 v[88:91], a[4:7], v[184:187], v[88:91]
    ds_read_b128 v[164:167], v29 offset:2048
    buffer_load_dwordx4 v7, s[12:15], s54 offen offset:2048 lds
    v_mfma_f32_16x16x32_bf16 v[108:111], a[68:71], v[184:187], v[108:111]
    ds_read_b128 v[160:163], v27 offset:2048
    v_mfma_f32_16x16x32_bf16 v[128:131], v[184:187], a[132:135], v[128:131]
    ds_read_b64_tr_b16 a[8:9], v35 offset:24576
    v_mfma_f32_16x16x32_bf16 v[72:75], a[4:7], v[168:171], v[72:75]
    ds_read_b64_tr_b16 a[10:11], v35 offset:25088
    v_mfma_f32_16x16x32_bf16 v[92:95], a[68:71], v[168:171], v[92:95]
    ds_read_b64_tr_b16 a[72:73], v35 offset:25600
    v_mfma_f32_16x16x32_bf16 v[112:115], v[168:171], a[132:135], v[112:115]
    ds_read_b64_tr_b16 a[74:75], v35 offset:26112
    s_add_u32 m0, s90, 61440
    v_mfma_f32_16x16x32_bf16 v[76:79], a[4:7], v[172:175], v[76:79]
    ds_read_b64_tr_b16 a[136:137], v35 offset:26624
    buffer_load_dwordx4 v8, s[12:15], s54 offen offset:0 lds
    v_mfma_f32_16x16x32_bf16 v[96:99], a[68:71], v[172:175], v[96:99]
    ds_read_b64_tr_b16 a[138:139], v35 offset:27136
    buffer_load_dwordx4 v8, s[12:15], s54 offen offset:1024 lds
    v_mfma_f32_16x16x32_bf16 v[116:119], v[172:175], a[132:135], v[116:119]
    ds_read_b128 v[144:147], v21 offset:2048
    v_mfma_f32_16x16x32_bf16 v[80:83], a[4:7], v[176:179], v[80:83]
    ds_read_b128 v[148:151], v21 offset:18432
    v_mfma_f32_16x16x32_bf16 v[100:103], a[68:71], v[176:179], v[100:103]
    ds_read_b128 v[152:155], v21 offset:34816
    buffer_load_dwordx4 v8, s[12:15], s54 offen offset:2048 lds
    v_mfma_f32_16x16x32_bf16 v[120:123], v[176:179], a[132:135], v[120:123]
    ds_read_b128 v[156:159], v21 offset:51200
    v_mfma_f32_16x16x32_bf16 v[84:87], a[4:7], v[180:183], v[84:87]
    v_mfma_f32_16x16x32_bf16 v[104:107], a[68:71], v[180:183], v[104:107]
    v_mfma_f32_16x16x32_bf16 v[124:127], v[180:183], a[132:135], v[124:127]
    s_waitcnt lgkmcnt(10)
    s_waitcnt lgkmcnt(0)
    s_mul_i32 s46, s46, 0x9e3779a1
    s_add_u32 s46, s46, 0x7f4a7c10
    v_mov_b32 v202, s46
    v_mov_b32 v203, s49
    s_lshl_b32 s83, s44, 8
    s_lshl3_add_u32 s83, s51, s83
    s_add_u32 s83, s83, 4096
    buffer_store_dwordx2 v[202:203], v9, s[32:35], s83 offen sc1
    v_mfma_f32_16x16x32_bf16 v[132:135], v[22:25], v[164:167], v[132:135]
    ds_read_b128 v[188:191], v30 offset:2048
    v_mov_b32 v42, 156288
    v_bfe_u32 v36, v1, 6, 2
    v_mfma_f32_16x16x32_bf16 v[136:139], v[164:167], v[164:167], v[136:139]
    ds_read_b128 v[184:187], v28 offset:2048
    v_lshrrev_b32 v37, 8, v1
    s_xor_b32 s87, s91, 384
    v_mfma_f32_16x16x32_bf16 v[140:143], v[160:163], v[160:163], v[140:143]
    v_cmp_eq_u32 vcc, v36, v37
    v_bfe_u32 v38, v1, 4, 4
    s_add_u32 m0, s88, 6144
    v_mfma_f32_16x16x32_bf16 v[88:91], a[8:11], v[160:163], v[88:91]
    ds_read_b64_tr_b16 a[12:13], v35 offset:36864
    buffer_load_dwordx4 v0, s[8:11], s87 offen lds
    v_mfma_f32_16x16x32_bf16 v[108:111], a[72:75], v[160:163], v[108:111]
    ds_read_b64_tr_b16 a[14:15], v35 offset:37376
    v_lshlrev_b32 v38, 2, v38
    v_mfma_f32_16x16x32_bf16 v[128:131], v[160:163], a[136:139], v[128:131]
    ds_read_b64_tr_b16 a[76:77], v35 offset:37888
    buffer_load_dwordx4 v3, s[8:11], s87 offen offset:1024 lds
    v_mfma_f32_16x16x32_bf16 v[72:75], a[8:11], v[144:147], v[72:75]
    ds_read_b64_tr_b16 a[78:79], v35 offset:38400
    s_lshl_b32 s80, s40, 6
    v_mfma_f32_16x16x32_bf16 v[92:95], a[72:75], v[144:147], v[92:95]
    ds_read_b64_tr_b16 a[140:141], v35 offset:38912
    s_add_u32 s80, s80, 155648
    v_add_u32 v39, 155904, v38
    v_add_u32 v38, s80, v38
    v_mfma_f32_16x16x32_bf16 v[112:115], v[144:147], a[136:139], v[112:115]
    v_cndmask_b32 v38, v42, v38, vcc
    v_cndmask_b32 v39, v42, v39, vcc
    v_mfma_f32_16x16x32_bf16 v[76:79], a[8:11], v[148:151], v[76:79]
    ds_read_b64_tr_b16 a[142:143], v35 offset:39424
    s_add_u32 m0, s89, 6144
    v_mfma_f32_16x16x32_bf16 v[96:99], a[72:75], v[148:151], v[96:99]
    ds_read_b128 v[168:171], v26 offset:2048
    v_mfma_f32_16x16x32_bf16 v[116:119], v[148:151], a[136:139], v[116:119]
    ds_read_b128 v[172:175], v26 offset:18432
    v_mfma_f32_16x16x32_bf16 v[80:83], a[8:11], v[152:155], v[80:83]
    ds_read_b128 v[176:179], v26 offset:34816
    s_mul_i32 s80, s40, 192
    s_add_u32 s80, s80, 156672
    v_lshrrev_b32 v43, 8, v1
    v_mfma_f32_16x16x32_bf16 v[100:103], a[72:75], v[152:155], v[100:103]
    ds_read_b128 v[180:183], v26 offset:51200
    v_lshl_add_u32 v43, v43, 4, s80
    s_mov_b64 exec, s[94:95]
    buffer_load_dwordx4 v4, s[8:11], s87 offen lds
    s_mov_b64 exec, -1
    v_mfma_f32_16x16x32_bf16 v[120:123], v[152:155], a[136:139], v[120:123]
    s_add_u32 m0, s90, 0
    v_bfe_u32 v44, v1, 4, 4
    v_lshl_add_u32 v44, v44, 2, s80
    v_mfma_f32_16x16x32_bf16 v[84:87], a[8:11], v[156:159], v[84:87]
    v_and_b32 v36, 0xf0, v1
    v_cmp_eq_u32 vcc, 0, v36
    v_mfma_f32_16x16x32_bf16 v[104:107], a[72:75], v[156:159], v[104:107]
    buffer_load_dwordx4 v7, s[12:15], s55 offen offset:0 lds
    v_cndmask_b32 v40, v42, v43, vcc
    v_mfma_f32_16x16x32_bf16 v[124:127], v[156:159], a[136:139], v[124:127]
    s_waitcnt lgkmcnt(10)
    v_cmp_eq_u32 vcc, 0, v37
    v_mfma_f32_16x16x32_bf16 v[132:135], v[22:25], v[188:191], v[132:135]
    v_mfma_f32_16x16x32_bf16 v[136:139], v[188:191], v[188:191], v[136:139]
    buffer_load_dwordx4 v7, s[12:15], s55 offen offset:1024 lds
    v_cndmask_b32 v41, v42, v44, vcc
    v_mfma_f32_16x16x32_bf16 v[140:143], v[184:187], v[184:187], v[140:143]
    s_waitcnt vmcnt(6) lgkmcnt(0)
    s_barrier
    v_bfe_u32 v36, v1, 4, 2
    v_mfma_f32_16x16x32_bf16 v[88:91], a[12:15], v[184:187], v[88:91]
    ds_read_b128 v[164:167], v29 offset:4096
    buffer_load_dwordx4 v7, s[12:15], s55 offen offset:2048 lds
    v_cmp_eq_u32 s[4:5], 1, v36
    v_cmp_eq_u32 s[6:7], 2, v36
    v_mfma_f32_16x16x32_bf16 v[108:111], a[76:79], v[184:187], v[108:111]
    ds_read_b128 v[160:163], v27 offset:4096
    v_cmp_eq_u32 s[78:79], 3, v36
    v_mfma_f32_16x16x32_bf16 v[128:131], v[184:187], a[140:143], v[128:131]
    ds_read_b64_tr_b16 a[16:17], v35 offset:49152
    v_mfma_f32_16x16x32_bf16 v[72:75], a[12:15], v[168:171], v[72:75]
    ds_read_b64_tr_b16 a[18:19], v35 offset:49664
    v_mfma_f32_16x16x32_bf16 v[92:95], a[76:79], v[168:171], v[92:95]
    ds_read_b64_tr_b16 a[80:81], v35 offset:50176
    s_mov_b32 s80, 155648
    v_bfe_u32 v45, v1, 4, 4
    v_lshl_add_u32 v45, v45, 2, s80
    v_mfma_f32_16x16x32_bf16 v[112:115], v[168:171], a[140:143], v[112:115]
    ds_read_b64_tr_b16 a[82:83], v35 offset:50688
    v_lshrrev_b32 v46, 8, v1
    s_add_u32 m0, s90, 12288
    v_mfma_f32_16x16x32_bf16 v[76:79], a[12:15], v[172:175], v[76:79]
    ds_read_b64_tr_b16 a[144:145], v35 offset:51200
    buffer_load_dwordx4 v8, s[12:15], s55 offen offset:0 lds
    v_lshl_add_u32 v46, v46, 4, s80
    v_mfma_f32_16x16x32_bf16 v[96:99], a[76:79], v[172:175], v[96:99]
    ds_read_b64_tr_b16 a[146:147], v35 offset:51712
    buffer_load_dwordx4 v8, s[12:15], s55 offen offset:1024 lds
    v_mov_b32 v57, 0xf149f2ca
    v_bfe_u32 v56, v1, 4, 4
    v_mfma_f32_16x16x32_bf16 v[116:119], v[172:175], a[140:143], v[116:119]
    ds_read_b128 v[144:147], v21 offset:4096
    v_lshrrev_b32 v47, 8, v1
    v_mfma_f32_16x16x32_bf16 v[80:83], a[12:15], v[176:179], v[80:83]
    ds_read_b128 v[148:151], v21 offset:20480
    v_lshlrev_b32 v47, 2, v47
    v_mfma_f32_16x16x32_bf16 v[100:103], a[76:79], v[176:179], v[100:103]
    ds_read_b128 v[152:155], v21 offset:36864
    buffer_load_dwordx4 v8, s[12:15], s55 offen offset:2048 lds
    v_sub_u32 v56, v56, v47
    v_mfma_f32_16x16x32_bf16 v[120:123], v[176:179], a[140:143], v[120:123]
    ds_read_b128 v[156:159], v21 offset:53248
    v_add_u32 v47, 0, v56
    v_mfma_f32_16x16x32_bf16 v[84:87], a[12:15], v[180:183], v[84:87]
    v_and_b32 v47, 0xfffffff1, v47
    v_mfma_f32_16x16x32_bf16 v[104:107], a[76:79], v[180:183], v[104:107]
    v_mfma_f32_16x16x32_bf16 v[124:127], v[180:183], a[140:143], v[124:127]
    s_waitcnt lgkmcnt(10)
    v_mfma_f32_16x16x32_bf16 v[132:135], v[22:25], v[164:167], v[132:135]
    ds_read_b128 v[188:191], v30 offset:4096
    v_mfma_f32_16x16x32_bf16 v[136:139], v[164:167], v[164:167], v[136:139]
    ds_read_b128 v[184:187], v28 offset:4096
    s_xor_b32 s87, s91, 512
    v_mfma_f32_16x16x32_bf16 v[140:143], v[160:163], v[160:163], v[140:143]
    s_waitcnt lgkmcnt(5)
    s_add_u32 m0, s88, 8192
    v_mfma_f32_16x16x32_bf16 v[88:91], a[16:19], v[160:163], v[88:91]
    ds_read_b64_tr_b16 a[20:21], v35 offset:61440
    buffer_load_dwordx4 v0, s[8:11], s87 offen lds
    v_mfma_f32_16x16x32_bf16 v[108:111], a[80:83], v[160:163], v[108:111]
    ds_read_b64_tr_b16 a[22:23], v35 offset:61952
    v_mfma_f32_16x16x32_bf16 v[128:131], v[160:163], a[144:147], v[128:131]
    ds_read_b64_tr_b16 a[84:85], v35 offset:62464
    buffer_load_dwordx4 v3, s[8:11], s87 offen offset:1024 lds
    v_mfma_f32_16x16x32_bf16 v[72:75], a[16:19], v[144:147], v[72:75]
    ds_read_b64_tr_b16 a[86:87], v35 offset:62976
    v_mfma_f32_16x16x32_bf16 v[92:95], a[80:83], v[144:147], v[92:95]
    ds_read_b64_tr_b16 a[148:149], v35 offset:63488
    v_mfma_f32_16x16x32_bf16 v[112:115], v[144:147], a[144:147], v[112:115]
    s_waitcnt lgkmcnt(7)
    v_mfma_f32_16x16x32_bf16 v[76:79], a[16:19], v[148:151], v[76:79]
    ds_read_b64_tr_b16 a[150:151], v35 offset:64000
    s_add_u32 m0, s89, 8192
    v_mfma_f32_16x16x32_bf16 v[96:99], a[80:83], v[148:151], v[96:99]
    ds_read_b128 v[168:171], v26 offset:4096
    v_mfma_f32_16x16x32_bf16 v[116:119], v[148:151], a[144:147], v[116:119]
    ds_read_b128 v[172:175], v26 offset:20480
    v_mfma_f32_16x16x32_bf16 v[80:83], a[16:19], v[152:155], v[80:83]
    ds_read_b128 v[176:179], v26 offset:36864
    v_mfma_f32_16x16x32_bf16 v[100:103], a[80:83], v[152:155], v[100:103]
    ds_read_b128 v[180:183], v26 offset:53248
    s_mov_b64 exec, s[94:95]
    buffer_load_dwordx4 v4, s[8:11], s87 offen lds
    s_mov_b64 exec, -1
    v_mfma_f32_16x16x32_bf16 v[120:123], v[152:155], a[144:147], v[120:123]
    s_add_u32 m0, s90, 24576
    v_mfma_f32_16x16x32_bf16 v[84:87], a[16:19], v[156:159], v[84:87]
    v_mfma_f32_16x16x32_bf16 v[104:107], a[80:83], v[156:159], v[104:107]
    buffer_load_dwordx4 v7, s[12:15], s56 offen offset:0 lds
    v_mfma_f32_16x16x32_bf16 v[124:127], v[156:159], a[144:147], v[124:127]
    s_waitcnt lgkmcnt(10)
    v_mfma_f32_16x16x32_bf16 v[132:135], v[22:25], v[188:191], v[132:135]
    v_mfma_f32_16x16x32_bf16 v[136:139], v[188:191], v[188:191], v[136:139]
    buffer_load_dwordx4 v7, s[12:15], s56 offen offset:1024 lds
    v_mfma_f32_16x16x32_bf16 v[140:143], v[184:187], v[184:187], v[140:143]
    s_waitcnt vmcnt(5) lgkmcnt(0)
    s_barrier
    v_mfma_f32_16x16x32_bf16 v[88:91], a[20:23], v[184:187], v[88:91]
    ds_read_b128 v[164:167], v29 offset:6144
    buffer_load_dwordx4 v7, s[12:15], s56 offen offset:2048 lds
    v_mfma_f32_16x16x32_bf16 v[108:111], a[84:87], v[184:187], v[108:111]
    ds_read_b128 v[160:163], v27 offset:6144
    v_mfma_f32_16x16x32_bf16 v[128:131], v[184:187], a[148:151], v[128:131]
    ds_read_b64_tr_b16 a[24:25], v35 offset:0
    v_mfma_f32_16x16x32_bf16 v[72:75], a[20:23], v[168:171], v[72:75]
    ds_read_b64_tr_b16 a[26:27], v35 offset:512
    v_mfma_f32_16x16x32_bf16 v[92:95], a[84:87], v[168:171], v[92:95]
    ds_read_b64_tr_b16 a[88:89], v35 offset:1024
    v_mfma_f32_16x16x32_bf16 v[112:115], v[168:171], a[148:151], v[112:115]
    ds_read_b64_tr_b16 a[90:91], v35 offset:1536
    s_add_u32 m0, s90, 36864
    v_mfma_f32_16x16x32_bf16 v[76:79], a[20:23], v[172:175], v[76:79]
    ds_read_b64_tr_b16 a[152:153], v35 offset:2048
    buffer_load_dwordx4 v8, s[12:15], s56 offen offset:0 lds
    v_mfma_f32_16x16x32_bf16 v[96:99], a[84:87], v[172:175], v[96:99]
    ds_read_b64_tr_b16 a[154:155], v35 offset:2560
    buffer_load_dwordx4 v8, s[12:15], s56 offen offset:1024 lds
    v_mfma_f32_16x16x32_bf16 v[116:119], v[172:175], a[148:151], v[116:119]
    ds_read_b128 v[144:147], v21 offset:6144
    v_mfma_f32_16x16x32_bf16 v[80:83], a[20:23], v[176:179], v[80:83]
    ds_read_b128 v[148:151], v21 offset:22528
    v_mfma_f32_16x16x32_bf16 v[100:103], a[84:87], v[176:179], v[100:103]
    ds_read_b128 v[152:155], v21 offset:38912
    buffer_load_dwordx4 v8, s[12:15], s56 offen offset:2048 lds
    v_mfma_f32_16x16x32_bf16 v[120:123], v[176:179], a[148:151], v[120:123]
    ds_read_b128 v[156:159], v21 offset:55296
    v_mfma_f32_16x16x32_bf16 v[84:87], a[20:23], v[180:183], v[84:87]
    v_mfma_f32_16x16x32_bf16 v[104:107], a[84:87], v[180:183], v[104:107]
    v_mfma_f32_16x16x32_bf16 v[124:127], v[180:183], a[148:151], v[124:127]
    s_waitcnt lgkmcnt(10)
    v_mfma_f32_16x16x32_bf16 v[132:135], v[22:25], v[164:167], v[132:135]
    ds_read_b128 v[188:191], v30 offset:6144
    v_cmp_eq_u32 vcc, 0, v47
    v_mfma_f32_16x16x32_bf16 v[136:139], v[164:167], v[164:167], v[136:139]
    ds_read_b128 v[184:187], v28 offset:6144
    v_cndmask_b32 v52, v57, 0, vcc
    v_add_u32 v47, 16, v56
    s_xor_b32 s87, s91, 640
    v_mfma_f32_16x16x32_bf16 v[140:143], v[160:163], v[160:163], v[140:143]
    s_waitcnt lgkmcnt(5)
    v_and_b32 v47, 0xfffffff1, v47
    v_cmp_eq_u32 vcc, 0, v47
    s_add_u32 m0, s88, 10240
    v_mfma_f32_16x16x32_bf16 v[88:91], a[24:27], v[160:163], v[88:91]
    ds_read_b64_tr_b16 a[28:29], v35 offset:12288
    buffer_load_dwordx4 v0, s[8:11], s87 offen lds
    v_mfma_f32_16x16x32_bf16 v[108:111], a[88:91], v[160:163], v[108:111]
    ds_read_b64_tr_b16 a[30:31], v35 offset:12800
    v_cndmask_b32 v48, v57, 0, vcc
    v_mfma_f32_16x16x32_bf16 v[128:131], v[160:163], a[152:155], v[128:131]
    ds_read_b64_tr_b16 a[92:93], v35 offset:13312
    buffer_load_dwordx4 v3, s[8:11], s87 offen offset:1024 lds
    v_add_u32 v47, -1, v56
    v_and_b32 v47, 0xfffffff1, v47
    v_mfma_f32_16x16x32_bf16 v[72:75], a[24:27], v[144:147], v[72:75]
    ds_read_b64_tr_b16 a[94:95], v35 offset:13824
    v_cmp_eq_u32 vcc, 0, v47
    v_mfma_f32_16x16x32_bf16 v[92:95], a[88:91], v[144:147], v[92:95]
    ds_read_b64_tr_b16 a[156:157], v35 offset:14336
    v_cndmask_b32 v53, v57, 0, vcc
    v_mfma_f32_16x16x32_bf16 v[112:115], v[144:147], a[152:155], v[112:115]
    s_waitcnt lgkmcnt(7)
    v_add_u32 v47, 15, v56
    v_and_b32 v47, 0xfffffff1, v47
    v_mfma_f32_16x16x32_bf16 v[76:79], a[24:27], v[148:151], v[76:79]
    ds_read_b64_tr_b16 a[158:159], v35 offset:14848
    v_cmp_eq_u32 vcc, 0, v47
    s_add_u32 m0, s89, 10240
    v_mfma_f32_16x16x32_bf16 v[96:99], a[88:91], v[148:151], v[96:99]
    ds_read_b128 v[168:171], v26 offset:6144
    v_cndmask_b32 v49, v57, 0, vcc
    v_mfma_f32_16x16x32_bf16 v[116:119], v[148:151], a[152:155], v[116:119]
    ds_read_b128 v[172:175], v26 offset:22528
    v_add_u32 v47, -2, v56
    v_mfma_f32_16x16x32_bf16 v[80:83], a[24:27], v[152:155], v[80:83]
    ds_read_b128 v[176:179], v26 offset:38912
    v_and_b32 v47, 0xfffffff1, v47
    v_mfma_f32_16x16x32_bf16 v[100:103], a[88:91], v[152:155], v[100:103]
    ds_read_b128 v[180:183], v26 offset:55296
    v_cmp_eq_u32 vcc, 0, v47
    s_mov_b64 exec, s[94:95]
    buffer_load_dwordx4 v4, s[8:11], s87 offen lds
    s_mov_b64 exec, -1
    v_mfma_f32_16x16x32_bf16 v[120:123], v[152:155], a[152:155], v[120:123]
    s_add_u32 m0, s90, 49152
    v_cndmask_b32 v54, v57, 0, vcc
    v_add_u32 v47, 14, v56
    v_mfma_f32_16x16x32_bf16 v[84:87], a[24:27], v[156:159], v[84:87]
    v_and_b32 v47, 0xfffffff1, v47
    v_cmp_eq_u32 vcc, 0, v47
    v_mfma_f32_16x16x32_bf16 v[104:107], a[88:91], v[156:159], v[104:107]
    buffer_load_dwordx4 v7, s[12:15], s57 offen offset:0 lds
    v_cndmask_b32 v50, v57, 0, vcc
    v_mfma_f32_16x16x32_bf16 v[124:127], v[156:159], a[152:155], v[124:127]
    s_waitcnt lgkmcnt(10)
    v_add_u32 v47, -3, v56
    v_and_b32 v47, 0xfffffff1, v47
    v_mfma_f32_16x16x32_bf16 v[132:135], v[22:25], v[188:191], v[132:135]
    v_cmp_eq_u32 vcc, 0, v47
    v_mfma_f32_16x16x32_bf16 v[136:139], v[188:191], v[188:191], v[136:139]
    buffer_load_dwordx4 v7, s[12:15], s57 offen offset:1024 lds
    v_cndmask_b32 v55, v57, 0, vcc
    v_mfma_f32_16x16x32_bf16 v[140:143], v[184:187], v[184:187], v[140:143]
    s_waitcnt vmcnt(5) lgkmcnt(0)
    s_barrier
    v_mfma_f32_16x16x32_bf16 v[88:91], a[28:31], v[184:187], v[88:91]
    ds_read_b128 v[164:167], v29 offset:8192
    buffer_load_dwordx4 v7, s[12:15], s57 offen offset:2048 lds
    v_add_u32 v47, 13, v56
    v_mfma_f32_16x16x32_bf16 v[108:111], a[92:95], v[184:187], v[108:111]
    ds_read_b128 v[160:163], v27 offset:8192
    v_and_b32 v47, 0xfffffff1, v47
    v_mfma_f32_16x16x32_bf16 v[128:131], v[184:187], a[156:159], v[128:131]
    ds_read_b64_tr_b16 a[32:33], v35 offset:24576
    v_cmp_eq_u32 vcc, 0, v47
    v_mfma_f32_16x16x32_bf16 v[72:75], a[28:31], v[168:171], v[72:75]
    ds_read_b64_tr_b16 a[34:35], v35 offset:25088
    v_cndmask_b32 v51, v57, 0, vcc
    v_mfma_f32_16x16x32_bf16 v[92:95], a[92:95], v[168:171], v[92:95]
    ds_read_b64_tr_b16 a[96:97], v35 offset:25600
    v_add_u32 v36, 159744, v1
    v_mfma_f32_16x16x32_bf16 v[112:115], v[168:171], a[156:159], v[112:115]
    ds_read_b64_tr_b16 a[98:99], v35 offset:26112
    ds_write_b128 v36, v[48:51]
    ds_write_b128 v36, v[52:55] offset:1024
    s_add_u32 m0, s90, 61440
    v_mfma_f32_16x16x32_bf16 v[76:79], a[28:31], v[172:175], v[76:79]
    ds_read_b64_tr_b16 a[160:161], v35 offset:26624
    buffer_load_dwordx4 v8, s[12:15], s57 offen offset:0 lds
    v_mfma_f32_16x16x32_bf16 v[96:99], a[92:95], v[172:175], v[96:99]
    ds_read_b64_tr_b16 a[162:163], v35 offset:27136
    buffer_load_dwordx4 v8, s[12:15], s57 offen offset:1024 lds
    v_mfma_f32_16x16x32_bf16 v[116:119], v[172:175], a[156:159], v[116:119]
    ds_read_b128 v[144:147], v21 offset:8192
    v_min_f32 v58, s77, v48
    v_mfma_f32_16x16x32_bf16 v[80:83], a[28:31], v[176:179], v[80:83]
    ds_read_b128 v[148:151], v21 offset:24576
    v_min_f32 v59, s77, v49
    v_min_f32 v60, s77, v50
    v_mfma_f32_16x16x32_bf16 v[100:103], a[92:95], v[176:179], v[100:103]
    ds_read_b128 v[152:155], v21 offset:40960
    buffer_load_dwordx4 v8, s[12:15], s57 offen offset:2048 lds
    v_min_f32 v61, s77, v51
    v_mfma_f32_16x16x32_bf16 v[120:123], v[176:179], a[156:159], v[120:123]
    ds_read_b128 v[156:159], v21 offset:57344
    v_and_b32 v47, 0xf0, v1
    v_mfma_f32_16x16x32_bf16 v[84:87], a[28:31], v[180:183], v[84:87]
    v_lshrrev_b32 v56, 9, v1
    v_mfma_f32_16x16x32_bf16 v[104:107], a[92:95], v[180:183], v[104:107]
    v_mfma_f32_16x16x32_bf16 v[124:127], v[180:183], a[156:159], v[124:127]
    s_waitcnt lgkmcnt(12)
    v_mfma_f32_16x16x32_bf16 v[132:135], v[22:25], v[164:167], v[132:135]
    ds_read_b128 v[188:191], v30 offset:8192
    v_lshl_or_b32 v47, v56, 8, v47
    v_bfe_u32 v56, v1, 8, 1
    v_mfma_f32_16x16x32_bf16 v[136:139], v[164:167], v[164:167], v[136:139]
    ds_read_b128 v[184:187], v28 offset:8192
    v_lshl_or_b32 v47, v56, 14, v47
    s_xor_b32 s87, s91, 768
    v_mfma_f32_16x16x32_bf16 v[140:143], v[160:163], v[160:163], v[140:143]
    s_waitcnt lgkmcnt(5)
    v_bfe_u32 v62, v1, 4, 5
    s_add_u32 m0, s88, 12288
    v_mfma_f32_16x16x32_bf16 v[88:91], a[32:35], v[160:163], v[88:91]
    ds_read_b64_tr_b16 a[36:37], v35 offset:36864
    buffer_load_dwordx4 v0, s[8:11], s87 offen lds
    v_mfma_f32_16x16x32_bf16 v[108:111], a[96:99], v[160:163], v[108:111]
    ds_read_b64_tr_b16 a[38:39], v35 offset:37376
    v_mfma_f32_16x16x32_bf16 v[128:131], v[160:163], a[160:163], v[128:131]
    ds_read_b64_tr_b16 a[100:101], v35 offset:37888
    buffer_load_dwordx4 v3, s[8:11], s87 offen offset:1024 lds
    s_lshl2_add_u32 s80, s42, s40
    s_lshl_b32 s80, s80, 5
    v_mfma_f32_16x16x32_bf16 v[72:75], a[32:35], v[144:147], v[72:75]
    ds_read_b64_tr_b16 a[102:103], v35 offset:38400
    s_lshl_b32 s81, s41, 7
    v_add_u32 v62, s80, v62
    v_mfma_f32_16x16x32_bf16 v[92:95], a[96:99], v[144:147], v[92:95]
    ds_read_b64_tr_b16 a[164:165], v35 offset:38912
    v_mul_u32_u24 v56, 3072, v62
    v_lshl_add_u32 v57, v62, 10, s81
    v_mfma_f32_16x16x32_bf16 v[112:115], v[144:147], a[160:163], v[112:115]
    s_waitcnt lgkmcnt(7)
    v_lshrrev_b32 v62, 9, v1
    v_lshl_add_u32 v56, v62, 10, v56
    v_mfma_f32_16x16x32_bf16 v[76:79], a[32:35], v[148:151], v[76:79]
    ds_read_b64_tr_b16 a[166:167], v35 offset:39424
    v_add_u32 v56, s81, v56
    s_add_u32 m0, s89, 12288
    v_mfma_f32_16x16x32_bf16 v[96:99], a[96:99], v[148:151], v[96:99]
    ds_read_b128 v[168:171], v26 offset:8192
    v_lshl_add_u32 v57, v62, 30, v57
    v_mfma_f32_16x16x32_bf16 v[116:119], v[148:151], a[160:163], v[116:119]
    ds_read_b128 v[172:175], v26 offset:24576
    v_lshrrev_b32 v65, 4, v1
    v_mfma_f32_16x16x32_bf16 v[80:83], a[32:35], v[152:155], v[80:83]
    ds_read_b128 v[176:179], v26 offset:40960
    v_mfma_f32_16x16x32_bf16 v[100:103], a[96:99], v[152:155], v[100:103]
    ds_read_b128 v[180:183], v26 offset:57344
    s_mov_b64 exec, s[94:95]
    buffer_load_dwordx4 v4, s[8:11], s87 offen lds
    s_mov_b64 exec, -1
    v_mfma_f32_16x16x32_bf16 v[120:123], v[152:155], a[160:163], v[120:123]
    s_lshl_b32 s80, s41, 2
    v_mfma_f32_16x16x32_bf16 v[84:87], a[32:35], v[156:159], v[84:87]
    s_add_u32 s80, s80, s40
    v_mfma_f32_16x16x32_bf16 v[104:107], a[96:99], v[156:159], v[104:107]
    s_lshl_b32 s81, s80, 11
    s_add_u32 m0, s90, 0
    v_mfma_f32_16x16x32_bf16 v[124:127], v[156:159], a[160:163], v[124:127]
    s_waitcnt lgkmcnt(10)
    s_mul_i32 s82, s42, 131072
    v_mfma_f32_16x16x32_bf16 v[132:135], v[22:25], v[188:191], v[132:135]
    s_add_u32 s81, s81, s82
    v_mfma_f32_16x16x32_bf16 v[136:139], v[188:191], v[188:191], v[136:139]
    s_add_u32 s81, s81, s50
    v_mov_b32 v63, 0x40000000
    v_mov_b32 v64, 0x40000000
    v_mfma_f32_16x16x32_bf16 v[140:143], v[184:187], v[184:187], v[140:143]
    s_waitcnt vmcnt(3) lgkmcnt(0)
    s_barrier
    v_mov_b32 v62, 0x40000000
    buffer_load_dwordx4 v7, s[12:15], s58 offen offset:0 lds
    buffer_load_dwordx4 v7, s[12:15], s58 offen offset:1024 lds
    v_mfma_f32_16x16x32_bf16 v[88:91], a[36:39], v[184:187], v[88:91]
    ds_read_b128 v[164:167], v29 offset:10240
    buffer_load_dwordx4 v7, s[12:15], s58 offen offset:2048 lds
    v_subrev_u32 v66, 0, v65
    v_cmp_gt_u32 vcc, 16, v66
    v_mfma_f32_16x16x32_bf16 v[108:111], a[100:103], v[184:187], v[108:111]
    ds_read_b128 v[160:163], v27 offset:10240
    v_lshl_add_u32 v66, v66, 7, s81
    v_mfma_f32_16x16x32_bf16 v[128:131], v[184:187], a[164:167], v[128:131]
    ds_read_b64_tr_b16 a[40:41], v35 offset:49152
    v_cndmask_b32 v63, v63, v66, vcc
    v_mfma_f32_16x16x32_bf16 v[72:75], a[36:39], v[168:171], v[72:75]
    ds_read_b64_tr_b16 a[42:43], v35 offset:49664
    v_subrev_u32 v66, 16, v65
    v_mfma_f32_16x16x32_bf16 v[92:95], a[100:103], v[168:171], v[92:95]
    ds_read_b64_tr_b16 a[104:105], v35 offset:50176
    v_cmp_gt_u32 vcc, 1, v66
    v_mfma_f32_16x16x32_bf16 v[112:115], v[168:171], a[164:167], v[112:115]
    ds_read_b64_tr_b16 a[106:107], v35 offset:50688
    v_lshl_add_u32 v66, v66, 7, s66
    s_add_u32 m0, s90, 12288
    v_mfma_f32_16x16x32_bf16 v[76:79], a[36:39], v[172:175], v[76:79]
    ds_read_b64_tr_b16 a[168:169], v35 offset:51200
    buffer_load_dwordx4 v8, s[12:15], s58 offen offset:0 lds
    v_cndmask_b32 v63, v63, v66, vcc
    v_mfma_f32_16x16x32_bf16 v[96:99], a[100:103], v[172:175], v[96:99]
    ds_read_b64_tr_b16 a[170:171], v35 offset:51712
    buffer_load_dwordx4 v8, s[12:15], s58 offen offset:1024 lds
    v_mfma_f32_16x16x32_bf16 v[116:119], v[172:175], a[164:167], v[116:119]
    ds_read_b128 v[144:147], v21 offset:10240
    s_add_u32 s81, s81, 65536
    v_subrev_u32 v66, 0, v65
    v_cmp_gt_u32 vcc, 16, v66
    v_mfma_f32_16x16x32_bf16 v[80:83], a[36:39], v[176:179], v[80:83]
    ds_read_b128 v[148:151], v21 offset:26624
    v_lshl_add_u32 v66, v66, 7, s81
    v_mfma_f32_16x16x32_bf16 v[100:103], a[100:103], v[176:179], v[100:103]
    ds_read_b128 v[152:155], v21 offset:43008
    buffer_load_dwordx4 v8, s[12:15], s58 offen offset:2048 lds
    v_cndmask_b32 v64, v64, v66, vcc
    v_mfma_f32_16x16x32_bf16 v[120:123], v[176:179], a[164:167], v[120:123]
    ds_read_b128 v[156:159], v21 offset:59392
    v_mfma_f32_16x16x32_bf16 v[84:87], a[36:39], v[180:183], v[84:87]
    s_lshl_b32 s81, s80, 7
    v_mfma_f32_16x16x32_bf16 v[104:107], a[100:103], v[180:183], v[104:107]
    s_lshl_b32 s82, s42, 12
    v_mfma_f32_16x16x32_bf16 v[124:127], v[180:183], a[164:167], v[124:127]
    s_waitcnt lgkmcnt(10)
    v_mfma_f32_16x16x32_bf16 v[132:135], v[22:25], v[164:167], v[132:135]
    ds_read_b128 v[188:191], v30 offset:10240
    v_mfma_f32_16x16x32_bf16 v[136:139], v[164:167], v[164:167], v[136:139]
    ds_read_b128 v[184:187], v28 offset:10240
    s_add_u32 s81, s81, s82
    s_xor_b32 s87, s91, 896
    v_mfma_f32_16x16x32_bf16 v[140:143], v[160:163], v[160:163], v[140:143]
    s_waitcnt lgkmcnt(5)
    s_add_u32 s81, s81, s50
    s_add_u32 m0, s88, 14336
    v_mfma_f32_16x16x32_bf16 v[88:91], a[40:43], v[160:163], v[88:91]
    ds_read_b64_tr_b16 a[44:45], v35 offset:61440
    buffer_load_dwordx4 v0, s[8:11], s87 offen lds
    s_add_u32 s81, s81, 532480
    v_subrev_u32 v66, 16, v65
    v_cmp_gt_u32 vcc, 1, v66
    v_mfma_f32_16x16x32_bf16 v[108:111], a[104:107], v[160:163], v[108:111]
    ds_read_b64_tr_b16 a[46:47], v35 offset:61952
    v_lshl_add_u32 v66, v66, 7, s81
    v_mfma_f32_16x16x32_bf16 v[128:131], v[160:163], a[168:171], v[128:131]
    ds_read_b64_tr_b16 a[108:109], v35 offset:62464
    buffer_load_dwordx4 v3, s[8:11], s87 offen offset:1024 lds
    v_cndmask_b32 v64, v64, v66, vcc
    v_mfma_f32_16x16x32_bf16 v[72:75], a[40:43], v[144:147], v[72:75]
    ds_read_b64_tr_b16 a[110:111], v35 offset:62976
    v_mfma_f32_16x16x32_bf16 v[92:95], a[104:107], v[144:147], v[92:95]
    ds_read_b64_tr_b16 a[172:173], v35 offset:63488
    v_mfma_f32_16x16x32_bf16 v[112:115], v[144:147], a[168:171], v[112:115]
    s_waitcnt lgkmcnt(7)
    s_mul_i32 s81, s40, 2304
    v_mfma_f32_16x16x32_bf16 v[76:79], a[40:43], v[148:151], v[76:79]
    ds_read_b64_tr_b16 a[174:175], v35 offset:64000
    s_add_u32 s81, s81, s73
    v_subrev_u32 v66, 17, v65
    v_cmp_gt_u32 vcc, 18, v66
    s_add_u32 m0, s89, 14336
    v_mfma_f32_16x16x32_bf16 v[96:99], a[104:107], v[148:151], v[96:99]
    ds_read_b128 v[168:171], v26 offset:10240
    v_lshl_add_u32 v66, v66, 7, s81
    v_mfma_f32_16x16x32_bf16 v[116:119], v[148:151], a[168:171], v[116:119]
    ds_read_b128 v[172:175], v26 offset:26624
    v_cndmask_b32 v62, v62, v66, vcc
    v_mfma_f32_16x16x32_bf16 v[80:83], a[40:43], v[152:155], v[80:83]
    ds_read_b128 v[176:179], v26 offset:43008
    v_mfma_f32_16x16x32_bf16 v[100:103], a[104:107], v[152:155], v[100:103]
    ds_read_b128 v[180:183], v26 offset:59392
    s_lshl_b32 s81, s80, 9
    s_mov_b64 exec, s[94:95]
    buffer_load_dwordx4 v4, s[8:11], s87 offen lds
    s_mov_b64 exec, -1
    v_mfma_f32_16x16x32_bf16 v[120:123], v[152:155], a[168:171], v[120:123]
    s_lshl_b32 s82, s42, 14
    v_mfma_f32_16x16x32_bf16 v[84:87], a[40:43], v[156:159], v[84:87]
    s_add_u32 s81, s81, s82
    v_mfma_f32_16x16x32_bf16 v[104:107], a[104:107], v[156:159], v[104:107]
    s_add_u32 s81, s81, s50
    s_add_u32 m0, s90, 24576
    v_mfma_f32_16x16x32_bf16 v[124:127], v[156:159], a[168:171], v[124:127]
    s_waitcnt lgkmcnt(10)
    s_add_u32 s81, s81, 557056
    v_subrev_u32 v66, 35, v65
    v_mfma_f32_16x16x32_bf16 v[132:135], v[22:25], v[188:191], v[132:135]
    buffer_load_dwordx4 v7, s[12:15], s59 offen offset:0 lds
    v_cmp_gt_u32 vcc, 4, v66
    v_lshl_add_u32 v66, v66, 7, s81
    v_mfma_f32_16x16x32_bf16 v[136:139], v[188:191], v[188:191], v[136:139]
    buffer_load_dwordx4 v7, s[12:15], s59 offen offset:1024 lds
    v_cndmask_b32 v62, v62, v66, vcc
    v_mfma_f32_16x16x32_bf16 v[140:143], v[184:187], v[184:187], v[140:143]
    s_waitcnt vmcnt(5) lgkmcnt(0)
    s_barrier
    v_mfma_f32_16x16x32_bf16 v[88:91], a[44:47], v[184:187], v[88:91]
    ds_read_b128 v[164:167], v29 offset:12288
    buffer_load_dwordx4 v7, s[12:15], s59 offen offset:2048 lds
    v_mfma_f32_16x16x32_bf16 v[108:111], a[108:111], v[184:187], v[108:111]
    ds_read_b128 v[160:163], v27 offset:12288
    s_lshl_b32 s81, s41, 7
    v_mfma_f32_16x16x32_bf16 v[128:131], v[184:187], a[172:175], v[128:131]
    ds_read_b64_tr_b16 a[48:49], v35 offset:0
    s_lshl_b32 s82, s42, 10
    v_mfma_f32_16x16x32_bf16 v[72:75], a[44:47], v[168:171], v[72:75]
    ds_read_b64_tr_b16 a[50:51], v35 offset:512
    s_add_u32 s81, s81, s82
    v_mfma_f32_16x16x32_bf16 v[92:95], a[108:111], v[168:171], v[92:95]
    ds_read_b64_tr_b16 a[112:113], v35 offset:1024
    s_add_u32 s81, s81, s50
    v_mfma_f32_16x16x32_bf16 v[112:115], v[168:171], a[172:175], v[112:115]
    ds_read_b64_tr_b16 a[114:115], v35 offset:1536
    s_add_u32 s81, s81, 548864
    v_subrev_u32 v66, 39, v65
    v_cmp_gt_u32 vcc, 1, v66
    s_add_u32 m0, s90, 36864
    v_mfma_f32_16x16x32_bf16 v[76:79], a[44:47], v[172:175], v[76:79]
    ds_read_b64_tr_b16 a[176:177], v35 offset:2048
    buffer_load_dwordx4 v8, s[12:15], s59 offen offset:0 lds
    v_lshl_add_u32 v66, v66, 7, s81
    v_mfma_f32_16x16x32_bf16 v[96:99], a[108:111], v[172:175], v[96:99]
    ds_read_b64_tr_b16 a[178:179], v35 offset:2560
    buffer_load_dwordx4 v8, s[12:15], s59 offen offset:1024 lds
    v_cndmask_b32 v62, v62, v66, vcc
    v_mfma_f32_16x16x32_bf16 v[116:119], v[172:175], a[172:175], v[116:119]
    ds_read_b128 v[144:147], v21 offset:12288
    v_mfma_f32_16x16x32_bf16 v[80:83], a[44:47], v[176:179], v[80:83]
    ds_read_b128 v[148:151], v21 offset:28672
    s_add_u32 s81, s66, 1024
    v_subrev_u32 v66, 41, v65
    v_mfma_f32_16x16x32_bf16 v[100:103], a[108:111], v[176:179], v[100:103]
    ds_read_b128 v[152:155], v21 offset:45056
    buffer_load_dwordx4 v8, s[12:15], s59 offen offset:2048 lds
    v_cmp_gt_u32 vcc, 1, v66
    v_mfma_f32_16x16x32_bf16 v[120:123], v[176:179], a[172:175], v[120:123]
    ds_read_b128 v[156:159], v21 offset:61440
    v_lshl_add_u32 v66, v66, 7, s81
    v_mfma_f32_16x16x32_bf16 v[84:87], a[44:47], v[180:183], v[84:87]
    v_cndmask_b32 v62, v62, v66, vcc
    v_mfma_f32_16x16x32_bf16 v[104:107], a[108:111], v[180:183], v[104:107]
    v_mfma_f32_16x16x32_bf16 v[124:127], v[180:183], a[172:175], v[124:127]
    s_waitcnt lgkmcnt(10)
    v_mfma_f32_16x16x32_bf16 v[132:135], v[22:25], v[164:167], v[132:135]
    ds_read_b128 v[188:191], v30 offset:12288
    v_mfma_f32_16x16x32_bf16 v[136:139], v[164:167], v[164:167], v[136:139]
    ds_read_b128 v[184:187], v28 offset:12288
    s_lshl_b32 s86, s44, 8
    v_mfma_f32_16x16x32_bf16 v[140:143], v[160:163], v[160:163], v[140:143]
    s_waitcnt lgkmcnt(5)
    v_mfma_f32_16x16x32_bf16 v[88:91], a[48:51], v[160:163], v[88:91]
    ds_read_b64_tr_b16 a[52:53], v35 offset:12288
    v_mfma_f32_16x16x32_bf16 v[108:111], a[112:115], v[160:163], v[108:111]
    ds_read_b64_tr_b16 a[54:55], v35 offset:12800
    s_add_u32 s86, s86, 4096
    v_mfma_f32_16x16x32_bf16 v[128:131], v[160:163], a[176:179], v[128:131]
    ds_read_b64_tr_b16 a[116:117], v35 offset:13312
    v_bfe_u32 v5, v1, 4, 5
    v_mfma_f32_16x16x32_bf16 v[72:75], a[48:51], v[144:147], v[72:75]
    ds_read_b64_tr_b16 a[118:119], v35 offset:13824
    v_lshlrev_b32 v5, 3, v5
    v_mfma_f32_16x16x32_bf16 v[92:95], a[112:115], v[144:147], v[92:95]
    ds_read_b64_tr_b16 a[180:181], v35 offset:14336
    v_mfma_f32_16x16x32_bf16 v[112:115], v[144:147], a[176:179], v[112:115]
    s_waitcnt lgkmcnt(7)
    v_mfma_f32_16x16x32_bf16 v[76:79], a[48:51], v[148:151], v[76:79]
    ds_read_b64_tr_b16 a[182:183], v35 offset:14848
    v_mfma_f32_16x16x32_bf16 v[96:99], a[112:115], v[148:151], v[96:99]
    ds_read_b128 v[168:171], v26 offset:12288
    v_mfma_f32_16x16x32_bf16 v[116:119], v[148:151], a[176:179], v[116:119]
    ds_read_b128 v[172:175], v26 offset:28672
    buffer_load_dwordx2 v[202:203], v5, s[32:35], s86 offen offset:0 sc1
    v_mfma_f32_16x16x32_bf16 v[80:83], a[48:51], v[152:155], v[80:83]
    ds_read_b128 v[176:179], v26 offset:45056
    v_mfma_f32_16x16x32_bf16 v[100:103], a[112:115], v[152:155], v[100:103]
    ds_read_b128 v[180:183], v26 offset:61440
    v_mfma_f32_16x16x32_bf16 v[120:123], v[152:155], a[176:179], v[120:123]
    v_mfma_f32_16x16x32_bf16 v[84:87], a[48:51], v[156:159], v[84:87]
    v_mfma_f32_16x16x32_bf16 v[104:107], a[112:115], v[156:159], v[104:107]
    v_mfma_f32_16x16x32_bf16 v[124:127], v[156:159], a[176:179], v[124:127]
    s_waitcnt lgkmcnt(10)
    v_mfma_f32_16x16x32_bf16 v[132:135], v[22:25], v[188:191], v[132:135]
    buffer_load_dword v6, v57, s[16:19], 0 offen
    v_mfma_f32_16x16x32_bf16 v[136:139], v[188:191], v[188:191], v[136:139]
    v_mfma_f32_16x16x32_bf16 v[140:143], v[184:187], v[184:187], v[140:143]
    s_waitcnt vmcnt(2) lgkmcnt(0)
    s_barrier
    v_mfma_f32_16x16x32_bf16 v[88:91], a[52:55], v[184:187], v[88:91]
    ds_read_b128 v[164:167], v29 offset:14336
    v_mfma_f32_16x16x32_bf16 v[108:111], a[116:119], v[184:187], v[108:111]
    ds_read_b128 v[160:163], v27 offset:14336
    buffer_load_dword v63, v63, s[32:35], 0 offen sc1
    v_mfma_f32_16x16x32_bf16 v[128:131], v[184:187], a[180:183], v[128:131]
    ds_read_b64_tr_b16 a[56:57], v35 offset:24576
    v_mfma_f32_16x16x32_bf16 v[72:75], a[52:55], v[168:171], v[72:75]
    ds_read_b64_tr_b16 a[58:59], v35 offset:25088
    v_mfma_f32_16x16x32_bf16 v[92:95], a[116:119], v[168:171], v[92:95]
    ds_read_b64_tr_b16 a[120:121], v35 offset:25600
    v_mfma_f32_16x16x32_bf16 v[112:115], v[168:171], a[180:183], v[112:115]
    ds_read_b64_tr_b16 a[122:123], v35 offset:26112
    v_mfma_f32_16x16x32_bf16 v[76:79], a[52:55], v[172:175], v[76:79]
    ds_read_b64_tr_b16 a[184:185], v35 offset:26624
    v_mfma_f32_16x16x32_bf16 v[96:99], a[116:119], v[172:175], v[96:99]
    ds_read_b64_tr_b16 a[186:187], v35 offset:27136
    buffer_load_dword v64, v64, s[32:35], 0 offen sc1
    v_mfma_f32_16x16x32_bf16 v[116:119], v[172:175], a[180:183], v[116:119]
    ds_read_b128 v[144:147], v21 offset:14336
    v_mfma_f32_16x16x32_bf16 v[80:83], a[52:55], v[176:179], v[80:83]
    ds_read_b128 v[148:151], v21 offset:30720
    v_mfma_f32_16x16x32_bf16 v[100:103], a[116:119], v[176:179], v[100:103]
    ds_read_b128 v[152:155], v21 offset:47104
    v_mfma_f32_16x16x32_bf16 v[120:123], v[176:179], a[180:183], v[120:123]
    ds_read_b128 v[156:159], v21 offset:63488
    v_mfma_f32_16x16x32_bf16 v[84:87], a[52:55], v[180:183], v[84:87]
    v_mfma_f32_16x16x32_bf16 v[104:107], a[116:119], v[180:183], v[104:107]
    v_mfma_f32_16x16x32_bf16 v[124:127], v[180:183], a[180:183], v[124:127]
    s_waitcnt lgkmcnt(10)
    v_mfma_f32_16x16x32_bf16 v[132:135], v[22:25], v[164:167], v[132:135]
    ds_read_b128 v[188:191], v30 offset:14336
    ds_read_b64 v[10:11], v31
    ds_read_b64 v[12:13], v32
    ds_read_b64 v[14:15], v33
    ds_read_b64 v[16:17], v34
    v_mfma_f32_16x16x32_bf16 v[136:139], v[164:167], v[164:167], v[136:139]
    ds_read_b128 v[184:187], v28 offset:14336
    v_mfma_f32_16x16x32_bf16 v[140:143], v[160:163], v[160:163], v[140:143]
    s_waitcnt lgkmcnt(9)
    v_mfma_f32_16x16x32_bf16 v[88:91], a[56:59], v[160:163], v[88:91]
    ds_read_b64_tr_b16 a[60:61], v35 offset:36864
    v_mfma_f32_16x16x32_bf16 v[108:111], a[120:123], v[160:163], v[108:111]
    ds_read_b64_tr_b16 a[62:63], v35 offset:37376
    v_mfma_f32_16x16x32_bf16 v[128:131], v[160:163], a[184:187], v[128:131]
    ds_read_b64_tr_b16 a[124:125], v35 offset:37888
    v_mfma_f32_16x16x32_bf16 v[72:75], a[56:59], v[144:147], v[72:75]
    ds_read_b64_tr_b16 a[126:127], v35 offset:38400
    v_mfma_f32_16x16x32_bf16 v[92:95], a[120:123], v[144:147], v[92:95]
    ds_read_b64_tr_b16 a[188:189], v35 offset:38912
    v_mfma_f32_16x16x32_bf16 v[112:115], v[144:147], a[184:187], v[112:115]
    s_waitcnt lgkmcnt(11)
    v_mfma_f32_16x16x32_bf16 v[76:79], a[56:59], v[148:151], v[76:79]
    ds_read_b64_tr_b16 a[190:191], v35 offset:39424
    v_mfma_f32_16x16x32_bf16 v[96:99], a[120:123], v[148:151], v[96:99]
    ds_read_b128 v[168:171], v26 offset:14336
    v_mfma_f32_16x16x32_bf16 v[116:119], v[148:151], a[184:187], v[116:119]
    ds_read_b128 v[172:175], v26 offset:30720
    v_mfma_f32_16x16x32_bf16 v[80:83], a[56:59], v[152:155], v[80:83]
    ds_read_b128 v[176:179], v26 offset:47104
    v_mfma_f32_16x16x32_bf16 v[100:103], a[120:123], v[152:155], v[100:103]
    ds_read_b128 v[180:183], v26 offset:63488
    v_mfma_f32_16x16x32_bf16 v[120:123], v[152:155], a[184:187], v[120:123]
    v_mfma_f32_16x16x32_bf16 v[84:87], a[56:59], v[156:159], v[84:87]
    v_mfma_f32_16x16x32_bf16 v[104:107], a[120:123], v[156:159], v[104:107]
    v_mfma_f32_16x16x32_bf16 v[124:127], v[156:159], a[184:187], v[124:127]
    s_waitcnt lgkmcnt(10)
    v_mfma_f32_16x16x32_bf16 v[132:135], v[22:25], v[188:191], v[132:135]
    v_mfma_f32_16x16x32_bf16 v[136:139], v[188:191], v[188:191], v[136:139]
    v_mfma_f32_16x16x32_bf16 v[140:143], v[184:187], v[184:187], v[140:143]
    s_waitcnt lgkmcnt(3)
    v_mfma_f32_16x16x32_bf16 v[88:91], a[60:63], v[184:187], v[88:91]
    v_mfma_f32_16x16x32_bf16 v[108:111], a[124:127], v[184:187], v[108:111]
    v_mfma_f32_16x16x32_bf16 v[128:131], v[184:187], a[188:191], v[128:131]
    v_mfma_f32_16x16x32_bf16 v[72:75], a[60:63], v[168:171], v[72:75]
    v_mfma_f32_16x16x32_bf16 v[92:95], a[124:127], v[168:171], v[92:95]
    v_mfma_f32_16x16x32_bf16 v[112:115], v[168:171], a[188:191], v[112:115]
    s_waitcnt lgkmcnt(0)
    v_mfma_f32_16x16x32_bf16 v[76:79], a[60:63], v[172:175], v[76:79]
    v_mfma_f32_16x16x32_bf16 v[96:99], a[124:127], v[172:175], v[96:99]
    v_mfma_f32_16x16x32_bf16 v[116:119], v[172:175], a[188:191], v[116:119]
    ds_write_b128 v40, v[88:91] offset:0
    ds_write_b128 v40, v[108:111] offset:64
    ds_write_b32 v41, v128 offset:128
    ds_read_b128 v[196:199], v43 offset:64
    ds_read_b128 v[192:195], v43 offset:0
    ds_read_b32 v200, v44 offset:128
    v_mov_b32 v67, v140
    v_mov_b32 v204, v140
    v_cndmask_b32 v136, v136, v137, s[4:5]
    v_cndmask_b32 v136, v136, v138, s[6:7]
    v_cndmask_b32 v136, v136, v139, s[78:79]
    v_cndmask_b32 v140, v140, v141, s[4:5]
    v_cndmask_b32 v140, v140, v142, s[6:7]
    v_cndmask_b32 v140, v140, v143, s[78:79]
    v_permlane16_swap_b32 v67, v204
    v_mov_b32 v204, v67
    v_mul_f32 v132, 0xbb000000, v132
    v_mul_f32 v136, 0x3b000000, v136
    v_fma_f32 v136, -v132, v132, v136
    v_max_f32 v136, 0, v136
    v_add_f32 v136, 0x3727c5ac, v136
    v_rsq_f32 v136, v136
    ds_write_b32 v38, v132 offset:320
    ds_write_b32 v38, v136 offset:0
    v_permlane32_swap_b32 v67, v204
    v_mul_f32 v67, 0xbb000000, v67
    v_mul_f32 v140, 0x3b000000, v140
    v_fma_f32 v140, -v67, v67, v140
    v_max_f32 v140, 0, v140
    v_add_f32 v140, 0x3727c5ac, v140
    v_rsq_f32 v140, v140
    v_mfma_f32_16x16x32_bf16 v[80:83], a[60:63], v[176:179], v[80:83]
    ds_write_b32 v39, v67 offset:320
    ds_write_b32 v39, v140 offset:0
    v_mfma_f32_16x16x32_bf16 v[100:103], a[124:127], v[176:179], v[100:103]
    v_mfma_f32_16x16x32_bf16 v[120:123], v[176:179], a[188:191], v[120:123]
    v_mfma_f32_16x16x32_bf16 v[84:87], a[60:63], v[180:183], v[84:87]
    v_mfma_f32_16x16x32_bf16 v[104:107], a[124:127], v[180:183], v[104:107]
    v_mfma_f32_16x16x32_bf16 v[124:127], v[180:183], a[188:191], v[124:127]
    s_waitcnt lgkmcnt(0)
    s_barrier
    v_bfe_u32 v0, v1, 4, 4
    v_lshrrev_b32 v4, 8, v1
    ds_read_b32 v160, v45 offset:320
    ds_read_b32 v172, v45 offset:384
    ds_read_b32 v184, v45 offset:448
    ds_read_b32 v208, v45 offset:512
    ds_read_b32 v142, v45 offset:0
    ds_read_b32 v170, v45 offset:64
    ds_read_b32 v182, v45 offset:128
    ds_read_b32 v190, v45 offset:192
    ds_read_b128 v[166:169], v46 offset:320
    ds_read_b128 v[178:181], v46 offset:384
    ds_read_b128 v[204:207], v46 offset:448
    ds_read_b128 v[214:217], v46 offset:512
    ds_read_b128 v[162:165], v46 offset:0
    ds_read_b128 v[174:177], v46 offset:64
    ds_read_b128 v[186:189], v46 offset:128
    ds_read_b128 v[210:213], v46 offset:192
    ds_read_b32 v220, v45 offset:576
    ds_read_b32 v218, v45 offset:256
    ds_read_b128 v[226:229], v46 offset:576
    ds_read_b128 v[222:225], v46 offset:256
    v_lshlrev_b32 v4, 7, v4
    v_lshl_add_u32 v4, v0, 1, v4
    s_lshl_b32 s83, s41, 2
    s_add_u32 s83, s83, s40
    s_waitcnt lgkmcnt(15)
    v_pk_fma_f32 v[92:93], v[160:161], v[196:197], v[92:93] op_sel_hi:[0,1,1]
    v_pk_fma_f32 v[96:97], v[172:173], v[196:197], v[96:97] op_sel_hi:[0,1,1]
    v_pk_fma_f32 v[100:101], v[184:185], v[196:197], v[100:101] op_sel_hi:[0,1,1]
    v_pk_fma_f32 v[104:105], v[208:209], v[196:197], v[104:105] op_sel_hi:[0,1,1]
    s_lshl_b32 s83, s83, 9
    v_pk_fma_f32 v[94:95], v[160:161], v[198:199], v[94:95] op_sel_hi:[0,1,1]
    v_pk_fma_f32 v[98:99], v[172:173], v[198:199], v[98:99] op_sel_hi:[0,1,1]
    v_pk_fma_f32 v[102:103], v[184:185], v[198:199], v[102:103] op_sel_hi:[0,1,1]
    v_pk_fma_f32 v[106:107], v[208:209], v[198:199], v[106:107] op_sel_hi:[0,1,1]
    buffer_load_ushort v152, v4, s[36:39], s83 offen offset:0
    buffer_load_ushort v153, v4, s[36:39], s83 offen offset:32
    buffer_load_ushort v154, v4, s[36:39], s83 offen offset:64
    buffer_load_ushort v155, v4, s[36:39], s83 offen offset:96
    v_pk_mul_f32 v[92:93], v[142:143], v[92:93] op_sel_hi:[0,1]
    s_waitcnt lgkmcnt(14)
    v_pk_mul_f32 v[96:97], v[170:171], v[96:97] op_sel_hi:[0,1]
    s_waitcnt lgkmcnt(13)
    v_pk_mul_f32 v[100:101], v[182:183], v[100:101] op_sel_hi:[0,1]
    s_waitcnt lgkmcnt(12)
    v_pk_mul_f32 v[104:105], v[190:191], v[104:105] op_sel_hi:[0,1]
    v_pk_mul_f32 v[94:95], v[142:143], v[94:95] op_sel_hi:[0,1]
    v_pk_mul_f32 v[98:99], v[170:171], v[98:99] op_sel_hi:[0,1]
    v_pk_mul_f32 v[102:103], v[182:183], v[102:103] op_sel_hi:[0,1]
    v_pk_mul_f32 v[106:107], v[190:191], v[106:107] op_sel_hi:[0,1]
    v_cvt_pk_bf16_f32 v28, v92, v93
    v_cvt_pk_bf16_f32 v30, v96, v97
    v_cvt_pk_bf16_f32 v32, v100, v101
    v_cvt_pk_bf16_f32 v34, v104, v105
    v_cvt_pk_bf16_f32 v29, v94, v95
    v_cvt_pk_bf16_f32 v31, v98, v99
    v_cvt_pk_bf16_f32 v33, v102, v103
    v_cvt_pk_bf16_f32 v35, v106, v107
    s_waitcnt lgkmcnt(3)
    v_pk_fma_f32 v[108:109], v[220:221], v[196:197], v[108:109] op_sel_hi:[0,1,1]
    v_mov_b32 v156, -1
    v_pk_fma_f32 v[72:73], v[160:161], v[192:193], v[72:73] op_sel_hi:[0,1,1]
    v_pk_fma_f32 v[76:77], v[172:173], v[192:193], v[76:77] op_sel_hi:[0,1,1]
    v_pk_fma_f32 v[80:81], v[184:185], v[192:193], v[80:81] op_sel_hi:[0,1,1]
    v_pk_fma_f32 v[84:85], v[208:209], v[192:193], v[84:85] op_sel_hi:[0,1,1]
    v_pk_fma_f32 v[110:111], v[220:221], v[198:199], v[110:111] op_sel_hi:[0,1,1]
    v_mov_b32 v157, -1
    v_pk_fma_f32 v[74:75], v[160:161], v[194:195], v[74:75] op_sel_hi:[0,1,1]
    v_pk_fma_f32 v[78:79], v[172:173], v[194:195], v[78:79] op_sel_hi:[0,1,1]
    v_pk_fma_f32 v[82:83], v[184:185], v[194:195], v[82:83] op_sel_hi:[0,1,1]
    v_pk_fma_f32 v[86:87], v[208:209], v[194:195], v[86:87] op_sel_hi:[0,1,1]
    s_waitcnt lgkmcnt(2)
    v_pk_mul_f32 v[108:109], v[218:219], v[108:109] op_sel_hi:[0,1]
    v_mov_b32 v158, -1
    v_cvt_pk_bf16_f32 v36, v72, v73
    v_cvt_pk_bf16_f32 v38, v76, v77
    v_cvt_pk_bf16_f32 v40, v80, v81
    v_cvt_pk_bf16_f32 v42, v84, v85
    v_pk_mul_f32 v[110:111], v[218:219], v[110:111] op_sel_hi:[0,1]
    v_mov_b32 v159, -1
    v_cvt_pk_bf16_f32 v37, v74, v75
    v_cvt_pk_bf16_f32 v39, v78, v79
    v_cvt_pk_bf16_f32 v41, v82, v83
    v_cvt_pk_bf16_f32 v43, v86, v87
    v_cvt_pk_bf16_f32 v26, v108, v109
    s_and_b32 s84, s40, 1
    v_mul_f32 v2, 0x3eb8aa3b, v142
    v_mul_f32 v66, 0x3eb8aa3b, v170
    v_mul_f32 v68, 0x3eb8aa3b, v182
    v_mul_f32 v70, 0x3eb8aa3b, v190
    v_cvt_pk_bf16_f32 v27, v110, v111
    s_mul_i32 s84, s84, 327680
    v_pk_fma_f32 v[112:113], v[166:167], v[200:201], v[112:113] op_sel_hi:[1,0,1]
    v_pk_fma_f32 v[116:117], v[178:179], v[200:201], v[116:117] op_sel_hi:[1,0,1]
    v_pk_fma_f32 v[120:121], v[204:205], v[200:201], v[120:121] op_sel_hi:[1,0,1]
    v_pk_fma_f32 v[124:125], v[214:215], v[200:201], v[124:125] op_sel_hi:[1,0,1]
    s_waitcnt lgkmcnt(1)
    v_pk_fma_f32 v[128:129], v[226:227], v[200:201], v[128:129] op_sel_hi:[1,0,1]
    s_add_u32 s83, s74, s84
    v_pk_fma_f32 v[114:115], v[168:169], v[200:201], v[114:115] op_sel_hi:[1,0,1]
    v_pk_fma_f32 v[118:119], v[180:181], v[200:201], v[118:119] op_sel_hi:[1,0,1]
    v_pk_fma_f32 v[122:123], v[206:207], v[200:201], v[122:123] op_sel_hi:[1,0,1]
    v_pk_fma_f32 v[126:127], v[216:217], v[200:201], v[126:127] op_sel_hi:[1,0,1]
    v_pk_fma_f32 v[130:131], v[228:229], v[200:201], v[130:131] op_sel_hi:[1,0,1]
    s_lshr_b32 s84, s40, 1
    v_pk_mul_f32 v[112:113], v[162:163], v[112:113]
    v_pk_mul_f32 v[116:117], v[174:175], v[116:117]
    v_pk_mul_f32 v[120:121], v[186:187], v[120:121]
    v_pk_mul_f32 v[124:125], v[210:211], v[124:125]
    s_waitcnt lgkmcnt(0)
    v_pk_mul_f32 v[128:129], v[222:223], v[128:129]
    s_lshl_b32 s84, s84, 8
    v_pk_mul_f32 v[114:115], v[164:165], v[114:115]
    v_pk_mul_f32 v[118:119], v[176:177], v[118:119]
    v_pk_mul_f32 v[122:123], v[188:189], v[122:123]
    v_pk_mul_f32 v[126:127], v[212:213], v[126:127]
    v_pk_mul_f32 v[130:131], v[224:225], v[130:131]
    s_add_u32 s83, s83, s84
    v_cvt_pk_bf16_f32 v134, v112, v113
    v_cvt_pk_bf16_f32 v136, v116, v117
    v_cvt_pk_bf16_f32 v138, v120, v121
    v_cvt_pk_bf16_f32 v140, v124, v125
    v_cvt_pk_bf16_f32 v132, v128, v129
    buffer_store_dwordx4 v[156:159], v1, s[32:35], s83 offen sc1
    v_cvt_pk_bf16_f32 v135, v114, v115
    v_cvt_pk_bf16_f32 v137, v118, v119
    v_cvt_pk_bf16_f32 v139, v122, v123
    v_cvt_pk_bf16_f32 v141, v126, v127
    v_cvt_pk_bf16_f32 v133, v130, v131
    v_mfma_f32_16x16x16_bf16 v[72:75], v[26:27], v[36:37], v[58:61]
    v_mfma_f32_16x16x16_bf16 v[76:79], v[28:29], v[38:39], v[48:51]
    v_mfma_f32_16x16x16_bf16 v[80:83], v[30:31], v[40:41], v[48:51]
    v_mfma_f32_16x16x16_bf16 v[84:87], v[32:33], v[42:43], v[48:51]
    v_mfma_f32_16x16x16_bf16 v[92:95], v[28:29], v[36:37], v[52:55]
    v_mfma_f32_16x16x16_bf16 v[96:99], v[30:31], v[38:39], v[52:55]
    v_mfma_f32_16x16x16_bf16 v[100:103], v[32:33], v[40:41], v[52:55]
    v_mfma_f32_16x16x16_bf16 v[104:107], v[34:35], v[42:43], v[52:55]
    s_nop 0
    v_max3_f32 v142, v72, v73, v74
    v_max3_f32 v164, v76, v77, v78
    v_max3_f32 v170, v80, v81, v82
    v_max3_f32 v176, v84, v85, v86
    v_max3_f32 v143, v75, v92, v93
    v_max3_f32 v142, v142, v94, v95
    v_max3_f32 v165, v79, v96, v97
    v_max3_f32 v171, v83, v100, v101
    v_max3_f32 v177, v87, v104, v105
    v_max3_f32 v164, v164, v98, v99
    v_max3_f32 v170, v170, v102, v103
    v_max3_f32 v176, v176, v106, v107
    v_max_f32 v142, v142, v143
    v_max_f32 v164, v164, v165
    v_max_f32 v170, v170, v171
    v_max_f32 v176, v176, v177
    v_mov_b32 v143, v142
    v_mov_b32 v165, v164
    v_mov_b32 v171, v170
    v_mov_b32 v177, v176
    v_permlane32_swap_b32 v142, v143
    v_permlane32_swap_b32 v164, v165
    v_permlane32_swap_b32 v170, v171
    v_permlane32_swap_b32 v176, v177
    v_max_f32 v142, v142, v143
    v_max_f32 v164, v164, v165
    v_max_f32 v170, v170, v171
    v_max_f32 v176, v176, v177
    v_mov_b32 v143, v142
    v_mov_b32 v165, v164
    v_mov_b32 v171, v170
    v_mov_b32 v177, v176
    v_permlane16_swap_b32 v142, v143
    v_permlane16_swap_b32 v164, v165
    v_permlane16_swap_b32 v170, v171
    v_permlane16_swap_b32 v176, v177
    v_max_f32 v142, v142, v143
    v_max_f32 v164, v164, v165
    v_max_f32 v170, v170, v171
    v_max_f32 v176, v176, v177
    v_mul_f32_e64 v142, -v142, v2
    v_mul_f32_e64 v164, -v164, v66
    v_mul_f32_e64 v170, -v170, v68
    v_mul_f32_e64 v176, -v176, v70
    v_pk_fma_f32 v[72:73], v[72:73], v[2:3], v[142:143] op_sel_hi:[1,0,0]
    v_pk_fma_f32 v[76:77], v[76:77], v[66:67], v[164:165] op_sel_hi:[1,0,0]
    v_pk_fma_f32 v[80:81], v[80:81], v[68:69], v[170:171] op_sel_hi:[1,0,0]
    v_pk_fma_f32 v[84:85], v[84:85], v[70:71], v[176:177] op_sel_hi:[1,0,0]
    v_pk_fma_f32 v[74:75], v[74:75], v[2:3], v[142:143] op_sel_hi:[1,0,0]
    v_pk_fma_f32 v[78:79], v[78:79], v[66:67], v[164:165] op_sel_hi:[1,0,0]
    v_pk_fma_f32 v[82:83], v[82:83], v[68:69], v[170:171] op_sel_hi:[1,0,0]
    v_pk_fma_f32 v[86:87], v[86:87], v[70:71], v[176:177] op_sel_hi:[1,0,0]
    v_pk_fma_f32 v[92:93], v[92:93], v[2:3], v[142:143] op_sel_hi:[1,0,0]
    v_pk_fma_f32 v[96:97], v[96:97], v[66:67], v[164:165] op_sel_hi:[1,0,0]
    v_pk_fma_f32 v[100:101], v[100:101], v[68:69], v[170:171] op_sel_hi:[1,0,0]
    v_pk_fma_f32 v[104:105], v[104:105], v[70:71], v[176:177] op_sel_hi:[1,0,0]
    v_pk_fma_f32 v[94:95], v[94:95], v[2:3], v[142:143] op_sel_hi:[1,0,0]
    v_pk_fma_f32 v[98:99], v[98:99], v[66:67], v[164:165] op_sel_hi:[1,0,0]
    v_pk_fma_f32 v[102:103], v[102:103], v[68:69], v[170:171] op_sel_hi:[1,0,0]
    v_pk_fma_f32 v[106:107], v[106:107], v[70:71], v[176:177] op_sel_hi:[1,0,0]
    v_exp_f32 v72, v72
    v_exp_f32 v76, v76
    v_exp_f32 v80, v80
    v_exp_f32 v84, v84
    v_exp_f32 v73, v73
    v_exp_f32 v77, v77
    v_exp_f32 v81, v81
    v_exp_f32 v85, v85
    v_exp_f32 v74, v74
    v_exp_f32 v78, v78
    v_exp_f32 v82, v82
    v_exp_f32 v86, v86
    v_exp_f32 v75, v75
    v_exp_f32 v79, v79
    v_exp_f32 v83, v83
    v_exp_f32 v87, v87
    v_exp_f32 v92, v92
    v_exp_f32 v96, v96
    v_exp_f32 v100, v100
    v_exp_f32 v104, v104
    v_exp_f32 v93, v93
    v_exp_f32 v97, v97
    v_exp_f32 v101, v101
    v_exp_f32 v105, v105
    v_exp_f32 v94, v94
    v_exp_f32 v98, v98
    v_exp_f32 v102, v102
    v_exp_f32 v106, v106
    v_exp_f32 v95, v95
    v_exp_f32 v99, v99
    v_exp_f32 v103, v103
    v_exp_f32 v107, v107
    v_cvt_pk_bf16_f32 v156, v72, v73
    v_cvt_pk_bf16_f32 v160, v76, v77
    v_cvt_pk_bf16_f32 v166, v80, v81
    v_cvt_pk_bf16_f32 v172, v84, v85
    v_cvt_pk_bf16_f32 v157, v74, v75
    v_cvt_pk_bf16_f32 v161, v78, v79
    v_cvt_pk_bf16_f32 v167, v82, v83
    v_cvt_pk_bf16_f32 v173, v86, v87
    v_cvt_pk_bf16_f32 v158, v92, v93
    v_cvt_pk_bf16_f32 v162, v96, v97
    v_cvt_pk_bf16_f32 v168, v100, v101
    v_cvt_pk_bf16_f32 v174, v104, v105
    v_cvt_pk_bf16_f32 v159, v94, v95
    v_cvt_pk_bf16_f32 v163, v98, v99
    v_cvt_pk_bf16_f32 v169, v102, v103
    v_cvt_pk_bf16_f32 v175, v106, v107
    v_mfma_f32_16x16x32_bf16 v[72:75], v[22:25], v[156:159], 0
    v_mfma_f32_16x16x32_bf16 v[76:79], v[22:25], v[160:163], 0
    v_mfma_f32_16x16x32_bf16 v[80:83], v[22:25], v[166:169], 0
    v_mfma_f32_16x16x32_bf16 v[84:87], v[22:25], v[172:175], 0
    v_mfma_f32_16x16x32_bf16 v[92:95], v[132:135], v[156:159], 0
    v_mfma_f32_16x16x32_bf16 v[96:99], v[134:137], v[160:163], 0
    v_mfma_f32_16x16x32_bf16 v[100:103], v[136:139], v[166:169], 0
    v_mfma_f32_16x16x32_bf16 v[104:107], v[138:141], v[172:175], 0
    s_nop 0
    v_rcp_f32 v142, v72
    v_rcp_f32 v164, v76
    v_rcp_f32 v170, v80
    v_rcp_f32 v176, v84
    v_pk_mul_f32 v[92:93], v[142:143], v[92:93] op_sel_hi:[0,1]
    v_pk_mul_f32 v[94:95], v[142:143], v[94:95] op_sel_hi:[0,1]
    v_pk_mul_f32 v[96:97], v[164:165], v[96:97] op_sel_hi:[0,1]
    v_pk_mul_f32 v[100:101], v[170:171], v[100:101] op_sel_hi:[0,1]
    v_pk_mul_f32 v[104:105], v[176:177], v[104:105] op_sel_hi:[0,1]
    v_pk_mul_f32 v[98:99], v[164:165], v[98:99] op_sel_hi:[0,1]
    v_pk_mul_f32 v[102:103], v[170:171], v[102:103] op_sel_hi:[0,1]
    v_pk_mul_f32 v[106:107], v[176:177], v[106:107] op_sel_hi:[0,1]
    v_cvt_pk_bf16_f32 v144, v92, v93
    v_cvt_pk_bf16_f32 v146, v96, v97
    v_cvt_pk_bf16_f32 v148, v100, v101
    v_cvt_pk_bf16_f32 v150, v104, v105
    v_cvt_pk_bf16_f32 v145, v94, v95
    v_cvt_pk_bf16_f32 v147, v98, v99
    v_cvt_pk_bf16_f32 v149, v102, v103
    v_cvt_pk_bf16_f32 v151, v106, v107
    s_waitcnt vmcnt(8)
    v_cmp_ne_u32 vcc, s46, v202
    s_nop 0
    s_cbranch_vccnz L_spin_1
L_ok_2:
    v_cmp_ne_u32 vcc, s49, v203
    s_nop 0
    s_cmp_eq_u64 vcc, 0
    s_cselect_b32 s47, 1, 0
    v_permlane16_swap_b32 v144, v146
    v_permlane16_swap_b32 v145, v147
    v_permlane16_swap_b32 v148, v150
    v_permlane16_swap_b32 v149, v151
    s_add_u32 s76, s46, 0
    v_mov_b32 v0, s76
    s_add_u32 s81, s60, 32768
    s_cmp_eq_u32 s47, 0
    s_cbranch_scc1 L_slow_3
    buffer_store_dwordx4 v[144:147], v47, s[32:35], s60 offen
    buffer_store_dwordx4 v[148:151], v47, s[32:35], s81 offen
L_back_4:
    s_waitcnt vmcnt(0)
    s_barrier
    s_cmp_eq_u32 s47, 0
    s_cbranch_scc1 L_slow_5
    buffer_store_dword v0, v9, s[32:35], s67 offen offset:0
L_back_6:
    v_lshl_or_b32 v18, v153, 16, v152
    v_lshl_or_b32 v19, v155, 16, v154
    v_mov_b32 v152, -1
    v_mov_b32 v153, -1
    v_mov_b32 v154, -1
    v_mov_b32 v155, -1
    s_mul_i32 s91, s40, 2304
    s_add_u32 s91, s91, s73
    s_cmp_eq_u32 s47, 0
    s_cbranch_scc1 L_slow_7
    buffer_store_dwordx4 v[152:155], v1, s[32:35], s91 offen offset:0
    buffer_store_dwordx4 v[152:155], v1, s[32:35], s91 offen offset:1024
    buffer_store_dwordx4 v[152:155], v1, s[32:35], s91 offen offset:1280
L_back_8:
    s_xor_b32 m0, s70, 0
    s_xor_b32 s92, s71, 0
    buffer_load_dwordx4 v20, s[16:19], s92 offen lds
    s_xor_b32 m0, s70, 4096
    s_xor_b32 s92, s71, 32768
    buffer_load_dwordx4 v20, s[16:19], s92 offen lds
    s_xor_b32 m0, s70, 8192
    s_xor_b32 s92, s71, 65536
    buffer_load_dwordx4 v20, s[16:19], s92 offen lds
    s_xor_b32 m0, s70, 12288
    s_xor_b32 s92, s71, 98304
    buffer_load_dwordx4 v20, s[16:19], s92 offen lds
    s_xor_b32 m0, s70, 16384
    s_xor_b32 s92, s71, 131072
    buffer_load_dwordx4 v20, s[16:19], s92 offen lds
    s_xor_b32 m0, s70, 20480
    s_xor_b32 s92, s71, 163840
    buffer_load_dwordx4 v20, s[16:19], s92 offen lds
    s_xor_b32 m0, s70, 24576
    s_xor_b32 s92, s71, 196608
    buffer_load_dwordx4 v20, s[16:19], s92 offen lds
    s_xor_b32 m0, s70, 28672
    s_xor_b32 s92, s71, 229376
    buffer_load_dwordx4 v20, s[16:19], s92 offen lds
    s_xor_b32 m0, s70, 32768
    s_xor_b32 s92, s71, 262144
    buffer_load_dwordx4 v20, s[16:19], s92 offen lds
    s_xor_b32 m0, s70, 36864
    s_xor_b32 s92, s71, 294912
    buffer_load_dwordx4 v20, s[16:19], s92 offen lds
    s_xor_b32 m0, s70, 40960
    s_xor_b32 s92, s71, 327680
    buffer_load_dwordx4 v20, s[16:19], s92 offen lds
    s_xor_b32 m0, s70, 45056
    s_xor_b32 s92, s71, 360448
    buffer_load_dwordx4 v20, s[16:19], s92 offen lds
    s_xor_b32 m0, s70, 49152
    s_xor_b32 s92, s71, 393216
    buffer_load_dwordx4 v20, s[16:19], s92 offen lds
    s_xor_b32 m0, s70, 53248
    s_xor_b32 s92, s71, 425984
    buffer_load_dwordx4 v20, s[16:19], s92 offen lds
    s_xor_b32 m0, s70, 57344
    s_xor_b32 s92, s71, 458752
    buffer_load_dwordx4 v20, s[16:19], s92 offen lds
    s_xor_b32 m0, s70, 61440
    s_xor_b32 s92, s71, 491520
    buffer_load_dwordx4 v20, s[16:19], s92 offen lds
    v_bfe_u32 v2, v1, 7, 2
    v_lshrrev_b32 v0, 8, v1
    v_mul_u32_u24 v0, 1024, v0
    v_lshl_add_u32 v0, v2, 5, v0
    v_bfe_u32 v2, v1, 6, 2
    v_lshl_add_u32 v0, v2, 7, v0
    v_bfe_u32 v2, v1, 4, 2
    v_lshl_add_u32 v0, v2, 3, v0
    v_add_u32 v0, 65536, v0
    v_xor_b32 v2, 32, v0
    v_xor_b32 v3, 64, v0
    v_xor_b32 v4, 96, v0
    s_lshl_b32 s80, s40, 11
    s_add_u32 s80, s80, 131072
    v_add_u32 v5, s80, v1
    v_lshlrev_b32 v108, 16, v10
    v_and_b32 v109, 0xffff0000, v10
    v_lshlrev_b32 v110, 16, v11
    v_and_b32 v111, 0xffff0000, v11
    v_lshlrev_b32 v112, 16, v12
    v_and_b32 v113, 0xffff0000, v12
    v_lshlrev_b32 v114, 16, v13
    v_and_b32 v115, 0xffff0000, v13
    v_lshlrev_b32 v116, 16, v14
    v_and_b32 v117, 0xffff0000, v14
    v_lshlrev_b32 v118, 16, v15
    v_and_b32 v119, 0xffff0000, v15
    v_lshlrev_b32 v120, 16, v16
    v_and_b32 v121, 0xffff0000, v16
    v_lshlrev_b32 v122, 16, v17
    v_and_b32 v123, 0xffff0000, v17
    v_and_b32 v6, 0xf0, v1
    v_lshrrev_b32 v10, 9, v1
    v_lshl_or_b32 v6, v10, 8, v6
    v_bfe_u32 v10, v1, 8, 1
    v_lshl_or_b32 v6, v10, 9, v6
    s_mov_b32 s80, 0xf0
    v_lshrrev_b32 v10, 9, v1
    v_lshlrev_b32 v10, 2, v10
    v_and_or_b32 v10, v1, s80, v10
    v_bfe_u32 v11, v1, 4, 3
    v_lshlrev_b32 v11, 2, v11
    s_add_u32 s85, s61, 4096
    s_add_u32 s86, s61, 8192
    s_add_u32 s87, s61, 12288
L_poll_9:
    buffer_load_dword v12, v11, s[32:35], s66 offen offset:0 sc1
    s_sub_u32 s48, s48, 1
    s_max_i32 s48, s48, 0
    s_cmp_lg_u32 s48, 0
    s_cselect_b64 s[94:95], -1, 0
    s_waitcnt vmcnt(0)
    v_cmp_ne_u32 vcc, s76, v12
    s_nop 0
    s_and_b64 vcc, vcc, s[94:95]
    s_cbranch_scc1 L_poll_9
    s_barrier
    buffer_load_dwordx4 v[192:195], v1, s[32:35], s61 offen offset:0 sc1
    buffer_load_dwordx4 v[196:199], v1, s[32:35], s61 offen offset:1024 sc1
    buffer_load_dwordx4 v[200:203], v1, s[32:35], s61 offen offset:2048 sc1
    buffer_load_dwordx4 v[204:207], v1, s[32:35], s61 offen offset:3072 sc1
    buffer_load_dwordx4 v[208:211], v1, s[32:35], s85 offen offset:0 sc1
    buffer_load_dwordx4 v[212:215], v1, s[32:35], s85 offen offset:1024 sc1
    buffer_load_dwordx4 v[216:219], v1, s[32:35], s85 offen offset:2048 sc1
    buffer_load_dwordx4 v[220:223], v1, s[32:35], s85 offen offset:3072 sc1
    ds_read_b64_tr_b16 v[128:129], v0 offset:0
    ds_read_b64_tr_b16 v[130:131], v0 offset:512
    ds_read_b64_tr_b16 v[132:133], v2 offset:0
    ds_read_b64_tr_b16 v[134:135], v2 offset:512
    ds_read_b64_tr_b16 v[136:137], v3 offset:0
    ds_read_b64_tr_b16 v[138:139], v3 offset:512
    ds_read_b64_tr_b16 v[140:141], v4 offset:0
    ds_read_b64_tr_b16 v[142:143], v4 offset:512
    ds_read_b64_tr_b16 v[144:145], v0 offset:4096
    ds_read_b64_tr_b16 v[146:147], v0 offset:4608
    ds_read_b64_tr_b16 v[148:149], v2 offset:4096
    ds_read_b64_tr_b16 v[150:151], v2 offset:4608
    ds_read_b64_tr_b16 v[152:153], v3 offset:4096
    ds_read_b64_tr_b16 v[154:155], v3 offset:4608
    ds_read_b64_tr_b16 v[156:157], v4 offset:4096
    ds_read_b64_tr_b16 v[158:159], v4 offset:4608
    ds_read_b64_tr_b16 v[160:161], v0 offset:8192
    ds_read_b64_tr_b16 v[162:163], v0 offset:8704
    ds_read_b64_tr_b16 v[164:165], v2 offset:8192
    ds_read_b64_tr_b16 v[166:167], v2 offset:8704
    ds_read_b64_tr_b16 v[168:169], v3 offset:8192
    ds_read_b64_tr_b16 v[170:171], v3 offset:8704
    ds_read_b64_tr_b16 v[172:173], v4 offset:8192
    ds_read_b64_tr_b16 v[174:175], v4 offset:8704
    ds_read_b64_tr_b16 v[176:177], v0 offset:12288
    ds_read_b64_tr_b16 v[178:179], v0 offset:12800
    ds_read_b64_tr_b16 v[180:181], v2 offset:12288
    ds_read_b64_tr_b16 v[182:183], v2 offset:12800
    ds_read_b64_tr_b16 v[184:185], v3 offset:12288
    ds_read_b64_tr_b16 v[186:187], v3 offset:12800
    ds_read_b64_tr_b16 v[188:189], v4 offset:12288
    ds_read_b64_tr_b16 v[190:191], v4 offset:12800
    ds_read_b64_tr_b16 v[22:23], v0 offset:16384
    ds_read_b64_tr_b16 v[24:25], v0 offset:16896
    ds_read_b64_tr_b16 v[26:27], v2 offset:16384
    ds_read_b64_tr_b16 v[28:29], v2 offset:16896
    ds_read_b64_tr_b16 v[30:31], v3 offset:16384
    ds_read_b64_tr_b16 v[32:33], v3 offset:16896
    ds_read_b64_tr_b16 v[34:35], v4 offset:16384
    ds_read_b64_tr_b16 v[36:37], v4 offset:16896
    ds_read_b64_tr_b16 v[38:39], v0 offset:20480
    ds_read_b64_tr_b16 v[40:41], v0 offset:20992
    ds_read_b64_tr_b16 v[42:43], v2 offset:20480
    ds_read_b64_tr_b16 v[44:45], v2 offset:20992
    ds_read_b64_tr_b16 v[46:47], v3 offset:20480
    ds_read_b64_tr_b16 v[48:49], v3 offset:20992
    ds_read_b64_tr_b16 v[50:51], v4 offset:20480
    ds_read_b64_tr_b16 v[52:53], v4 offset:20992
    ds_read_b64_tr_b16 v[58:59], v0 offset:24576
    ds_read_b64_tr_b16 v[60:61], v0 offset:25088
    ds_read_b64_tr_b16 v[64:65], v2 offset:24576
    ds_read_b64_tr_b16 v[66:67], v2 offset:25088
    ds_read_b64_tr_b16 v[68:69], v3 offset:24576
    ds_read_b64_tr_b16 v[70:71], v3 offset:25088
    ds_read_b64_tr_b16 v[72:73], v4 offset:24576
    ds_read_b64_tr_b16 v[74:75], v4 offset:25088
    ds_read_b64_tr_b16 v[76:77], v0 offset:28672
    ds_read_b64_tr_b16 v[78:79], v0 offset:29184
    ds_read_b64_tr_b16 v[80:81], v2 offset:28672
    ds_read_b64_tr_b16 v[82:83], v2 offset:29184
    ds_read_b64_tr_b16 v[84:85], v3 offset:28672
    ds_read_b64_tr_b16 v[86:87], v3 offset:29184
    ds_read_b64_tr_b16 v[88:89], v4 offset:28672
    ds_read_b64_tr_b16 v[90:91], v4 offset:29184
    ds_read_b64_tr_b16 v[92:93], v0 offset:32768
    ds_read_b64_tr_b16 v[94:95], v0 offset:33280
    ds_read_b64_tr_b16 v[96:97], v2 offset:32768
    ds_read_b64_tr_b16 v[98:99], v2 offset:33280
    ds_read_b64_tr_b16 v[100:101], v3 offset:32768
    ds_read_b64_tr_b16 v[102:103], v3 offset:33280
    ds_read_b64_tr_b16 v[104:105], v4 offset:32768
    ds_read_b64_tr_b16 v[106:107], v4 offset:33280
    s_waitcnt vmcnt(7) lgkmcnt(15)
    v_mfma_f32_16x16x32_bf16 v[108:111], v[128:131], v[192:195], v[108:111]
    v_mfma_f32_16x16x32_bf16 v[112:115], v[132:135], v[192:195], v[112:115]
    v_mfma_f32_16x16x32_bf16 v[116:119], v[136:139], v[192:195], v[116:119]
    v_mfma_f32_16x16x32_bf16 v[120:123], v[140:143], v[192:195], v[120:123]
    buffer_load_dwordx4 v[224:227], v1, s[32:35], s86 offen offset:0 sc1
    s_waitcnt vmcnt(7)
    v_mfma_f32_16x16x32_bf16 v[108:111], v[144:147], v[196:199], v[108:111]
    v_mfma_f32_16x16x32_bf16 v[112:115], v[148:151], v[196:199], v[112:115]
    v_mfma_f32_16x16x32_bf16 v[116:119], v[152:155], v[196:199], v[116:119]
    v_mfma_f32_16x16x32_bf16 v[120:123], v[156:159], v[196:199], v[120:123]
    buffer_load_dwordx4 v[228:231], v1, s[32:35], s86 offen offset:1024 sc1
    s_waitcnt vmcnt(7)
    v_mfma_f32_16x16x32_bf16 v[108:111], v[160:163], v[200:203], v[108:111]
    v_mfma_f32_16x16x32_bf16 v[112:115], v[164:167], v[200:203], v[112:115]
    v_mfma_f32_16x16x32_bf16 v[116:119], v[168:171], v[200:203], v[116:119]
    v_mfma_f32_16x16x32_bf16 v[120:123], v[172:175], v[200:203], v[120:123]
    buffer_load_dwordx4 v[232:235], v1, s[32:35], s86 offen offset:2048 sc1
    s_waitcnt vmcnt(7)
    v_mfma_f32_16x16x32_bf16 v[108:111], v[176:179], v[204:207], v[108:111]
    v_mfma_f32_16x16x32_bf16 v[112:115], v[180:183], v[204:207], v[112:115]
    v_mfma_f32_16x16x32_bf16 v[116:119], v[184:187], v[204:207], v[116:119]
    v_mfma_f32_16x16x32_bf16 v[120:123], v[188:191], v[204:207], v[120:123]
    buffer_load_dwordx4 v[236:239], v1, s[32:35], s86 offen offset:3072 sc1
    s_waitcnt vmcnt(7)
    v_mfma_f32_16x16x32_bf16 v[108:111], v[22:25], v[208:211], v[108:111]
    ds_read_b64_tr_b16 v[22:23], v0 offset:36864
    ds_read_b64_tr_b16 v[24:25], v0 offset:37376
    v_mfma_f32_16x16x32_bf16 v[112:115], v[26:29], v[208:211], v[112:115]
    ds_read_b64_tr_b16 v[26:27], v2 offset:36864
    ds_read_b64_tr_b16 v[28:29], v2 offset:37376
    v_mfma_f32_16x16x32_bf16 v[116:119], v[30:33], v[208:211], v[116:119]
    ds_read_b64_tr_b16 v[30:31], v3 offset:36864
    ds_read_b64_tr_b16 v[32:33], v3 offset:37376
    v_mfma_f32_16x16x32_bf16 v[120:123], v[34:37], v[208:211], v[120:123]
    ds_read_b64_tr_b16 v[34:35], v4 offset:36864
    ds_read_b64_tr_b16 v[36:37], v4 offset:37376
    buffer_load_dwordx4 v[240:243], v1, s[32:35], s87 offen offset:0 sc1
    s_waitcnt vmcnt(7)
    v_mfma_f32_16x16x32_bf16 v[108:111], v[38:41], v[212:215], v[108:111]
    ds_read_b64_tr_b16 v[38:39], v0 offset:40960
    ds_read_b64_tr_b16 v[40:41], v0 offset:41472
    v_mfma_f32_16x16x32_bf16 v[112:115], v[42:45], v[212:215], v[112:115]
    ds_read_b64_tr_b16 v[42:43], v2 offset:40960
    ds_read_b64_tr_b16 v[44:45], v2 offset:41472
    v_mfma_f32_16x16x32_bf16 v[116:119], v[46:49], v[212:215], v[116:119]
    ds_read_b64_tr_b16 v[46:47], v3 offset:40960
    ds_read_b64_tr_b16 v[48:49], v3 offset:41472
    v_mfma_f32_16x16x32_bf16 v[120:123], v[50:53], v[212:215], v[120:123]
    ds_read_b64_tr_b16 v[50:51], v4 offset:40960
    ds_read_b64_tr_b16 v[52:53], v4 offset:41472
    buffer_load_dwordx4 v[244:247], v1, s[32:35], s87 offen offset:1024 sc1
    s_waitcnt vmcnt(7)
    v_mfma_f32_16x16x32_bf16 v[108:111], v[58:61], v[216:219], v[108:111]
    ds_read_b64_tr_b16 v[58:59], v0 offset:45056
    ds_read_b64_tr_b16 v[60:61], v0 offset:45568
    v_mfma_f32_16x16x32_bf16 v[112:115], v[64:67], v[216:219], v[112:115]
    ds_read_b64_tr_b16 v[64:65], v2 offset:45056
    ds_read_b64_tr_b16 v[66:67], v2 offset:45568
    v_mfma_f32_16x16x32_bf16 v[116:119], v[68:71], v[216:219], v[116:119]
    ds_read_b64_tr_b16 v[68:69], v3 offset:45056
    ds_read_b64_tr_b16 v[70:71], v3 offset:45568
    v_mfma_f32_16x16x32_bf16 v[120:123], v[72:75], v[216:219], v[120:123]
    ds_read_b64_tr_b16 v[72:73], v4 offset:45056
    ds_read_b64_tr_b16 v[74:75], v4 offset:45568
    buffer_load_dwordx4 v[248:251], v1, s[32:35], s87 offen offset:2048 sc1
    s_waitcnt vmcnt(7) lgkmcnt(15)
    v_mfma_f32_16x16x32_bf16 v[108:111], v[76:79], v[220:223], v[108:111]
    ds_read_b64_tr_b16 v[76:77], v0 offset:49152
    ds_read_b64_tr_b16 v[78:79], v0 offset:49664
    v_mfma_f32_16x16x32_bf16 v[112:115], v[80:83], v[220:223], v[112:115]
    ds_read_b64_tr_b16 v[80:81], v2 offset:49152
    ds_read_b64_tr_b16 v[82:83], v2 offset:49664
    v_mfma_f32_16x16x32_bf16 v[116:119], v[84:87], v[220:223], v[116:119]
    ds_read_b64_tr_b16 v[84:85], v3 offset:49152
    ds_read_b64_tr_b16 v[86:87], v3 offset:49664
    v_mfma_f32_16x16x32_bf16 v[120:123], v[88:91], v[220:223], v[120:123]
    ds_read_b64_tr_b16 v[88:89], v4 offset:49152
    ds_read_b64_tr_b16 v[90:91], v4 offset:49664
    buffer_load_dwordx4 v[252:255], v1, s[32:35], s87 offen offset:3072 sc1
    s_waitcnt vmcnt(7)
    v_mfma_f32_16x16x32_bf16 v[108:111], v[92:95], v[224:227], v[108:111]
    ds_read_b64_tr_b16 v[92:93], v0 offset:53248
    ds_read_b64_tr_b16 v[94:95], v0 offset:53760
    v_mfma_f32_16x16x32_bf16 v[112:115], v[96:99], v[224:227], v[112:115]
    ds_read_b64_tr_b16 v[96:97], v2 offset:53248
    ds_read_b64_tr_b16 v[98:99], v2 offset:53760
    v_mfma_f32_16x16x32_bf16 v[116:119], v[100:103], v[224:227], v[116:119]
    ds_read_b64_tr_b16 v[100:101], v3 offset:53248
    ds_read_b64_tr_b16 v[102:103], v3 offset:53760
    v_mfma_f32_16x16x32_bf16 v[120:123], v[104:107], v[224:227], v[120:123]
    ds_read_b64_tr_b16 v[104:105], v4 offset:53248
    ds_read_b64_tr_b16 v[106:107], v4 offset:53760
    v_add_u32 v7, 1024, v7
    v_add_u32 v8, 1024, v8
    s_add_u32 m0, s69, 0
    s_nop 0
    buffer_load_dwordx4 v7, s[20:23], s52 offen lds
    s_add_u32 m0, s69, 4096
    s_waitcnt vmcnt(7)
    v_mfma_f32_16x16x32_bf16 v[108:111], v[22:25], v[228:231], v[108:111]
    ds_read_b64_tr_b16 v[22:23], v0 offset:57344
    ds_read_b64_tr_b16 v[24:25], v0 offset:57856
    v_mfma_f32_16x16x32_bf16 v[112:115], v[26:29], v[228:231], v[112:115]
    ds_read_b64_tr_b16 v[26:27], v2 offset:57344
    ds_read_b64_tr_b16 v[28:29], v2 offset:57856
    v_mfma_f32_16x16x32_bf16 v[116:119], v[30:33], v[228:231], v[116:119]
    ds_read_b64_tr_b16 v[30:31], v3 offset:57344
    ds_read_b64_tr_b16 v[32:33], v3 offset:57856
    v_mfma_f32_16x16x32_bf16 v[120:123], v[34:37], v[228:231], v[120:123]
    ds_read_b64_tr_b16 v[34:35], v4 offset:57344
    ds_read_b64_tr_b16 v[36:37], v4 offset:57856
    buffer_load_dwordx4 v8, s[20:23], s52 offen lds
    s_add_u32 m0, s69, 8192
    s_nop 0
    buffer_load_dwordx4 v7, s[20:23], s53 offen lds
    s_add_u32 m0, s69, 12288
    s_nop 0
    buffer_load_dwordx4 v8, s[20:23], s53 offen lds
    s_waitcnt vmcnt(9) lgkmcnt(15)
    v_mfma_f32_16x16x32_bf16 v[108:111], v[38:41], v[232:235], v[108:111]
    ds_read_b64_tr_b16 v[38:39], v0 offset:61440
    ds_read_b64_tr_b16 v[40:41], v0 offset:61952
    v_mfma_f32_16x16x32_bf16 v[112:115], v[42:45], v[232:235], v[112:115]
    ds_read_b64_tr_b16 v[42:43], v2 offset:61440
    ds_read_b64_tr_b16 v[44:45], v2 offset:61952
    v_mfma_f32_16x16x32_bf16 v[116:119], v[46:49], v[232:235], v[116:119]
    ds_read_b64_tr_b16 v[46:47], v3 offset:61440
    ds_read_b64_tr_b16 v[48:49], v3 offset:61952
    v_mfma_f32_16x16x32_bf16 v[120:123], v[50:53], v[232:235], v[120:123]
    ds_read_b64_tr_b16 v[50:51], v4 offset:61440
    ds_read_b64_tr_b16 v[52:53], v4 offset:61952
    s_add_u32 m0, s69, 16384
    s_nop 0
    buffer_load_dwordx4 v7, s[20:23], s54 offen lds
    s_add_u32 m0, s69, 20480
    s_nop 0
    buffer_load_dwordx4 v8, s[20:23], s54 offen lds
    s_waitcnt vmcnt(10)
    v_mfma_f32_16x16x32_bf16 v[108:111], v[58:61], v[236:239], v[108:111]
    v_mfma_f32_16x16x32_bf16 v[112:115], v[64:67], v[236:239], v[112:115]
    v_mfma_f32_16x16x32_bf16 v[116:119], v[68:71], v[236:239], v[116:119]
    v_mfma_f32_16x16x32_bf16 v[120:123], v[72:75], v[236:239], v[120:123]
    s_add_u32 m0, s69, 24576
    s_nop 0
    buffer_load_dwordx4 v7, s[20:23], s55 offen lds
    s_add_u32 m0, s69, 28672
    s_nop 0
    buffer_load_dwordx4 v8, s[20:23], s55 offen lds
    s_waitcnt vmcnt(11)
    v_mfma_f32_16x16x32_bf16 v[108:111], v[76:79], v[240:243], v[108:111]
    v_mfma_f32_16x16x32_bf16 v[112:115], v[80:83], v[240:243], v[112:115]
    v_mfma_f32_16x16x32_bf16 v[116:119], v[84:87], v[240:243], v[116:119]
    v_mfma_f32_16x16x32_bf16 v[120:123], v[88:91], v[240:243], v[120:123]
    s_add_u32 m0, s69, 32768
    s_nop 0
    buffer_load_dwordx4 v7, s[20:23], s56 offen lds
    s_add_u32 m0, s69, 36864
    s_nop 0
    buffer_load_dwordx4 v8, s[20:23], s56 offen lds
    s_waitcnt vmcnt(12) lgkmcnt(15)
    v_mfma_f32_16x16x32_bf16 v[108:111], v[92:95], v[244:247], v[108:111]
    v_mfma_f32_16x16x32_bf16 v[112:115], v[96:99], v[244:247], v[112:115]
    v_mfma_f32_16x16x32_bf16 v[116:119], v[100:103], v[244:247], v[116:119]
    v_mfma_f32_16x16x32_bf16 v[120:123], v[104:107], v[244:247], v[120:123]
    s_add_u32 m0, s69, 40960
    s_nop 0
    buffer_load_dwordx4 v7, s[20:23], s57 offen lds
    s_add_u32 m0, s69, 45056
    s_nop 0
    buffer_load_dwordx4 v8, s[20:23], s57 offen lds
    s_waitcnt vmcnt(13) lgkmcnt(8)
    v_mfma_f32_16x16x32_bf16 v[108:111], v[22:25], v[248:251], v[108:111]
    v_mfma_f32_16x16x32_bf16 v[112:115], v[26:29], v[248:251], v[112:115]
    v_mfma_f32_16x16x32_bf16 v[116:119], v[30:33], v[248:251], v[116:119]
    v_mfma_f32_16x16x32_bf16 v[120:123], v[34:37], v[248:251], v[120:123]
    s_add_u32 m0, s69, 49152
    s_nop 0
    buffer_load_dwordx4 v7, s[20:23], s58 offen lds
    s_add_u32 m0, s69, 53248
    s_nop 0
    buffer_load_dwordx4 v8, s[20:23], s58 offen lds
    s_waitcnt vmcnt(14) lgkmcnt(0)
    v_mfma_f32_16x16x32_bf16 v[108:111], v[38:41], v[252:255], v[108:111]
    v_mfma_f32_16x16x32_bf16 v[112:115], v[42:45], v[252:255], v[112:115]
    v_mfma_f32_16x16x32_bf16 v[116:119], v[46:49], v[252:255], v[116:119]
    v_mfma_f32_16x16x32_bf16 v[120:123], v[50:53], v[252:255], v[120:123]
    s_add_u32 m0, s69, 57344
    s_nop 0
    buffer_load_dwordx4 v7, s[20:23], s59 offen lds
    s_add_u32 m0, s69, 61440
    s_nop 0
    buffer_load_dwordx4 v8, s[20:23], s59 offen lds
    v_cvt_pk_bf16_f32 v24, v108, v109
    v_cvt_pk_bf16_f32 v25, v110, v111
    v_cvt_pk_bf16_f32 v26, v112, v113
    v_cvt_pk_bf16_f32 v27, v114, v115
    ds_write_b128 v5, v[24:27] offset:0
    v_cvt_pk_bf16_f32 v28, v116, v117
    v_cvt_pk_bf16_f32 v29, v118, v119
    v_cvt_pk_bf16_f32 v30, v120, v121
    v_cvt_pk_bf16_f32 v31, v122, v123
    ds_write_b128 v5, v[28:31] offset:1024
    v_permlane16_swap_b32 v24, v26
    v_permlane16_swap_b32 v25, v27
    v_permlane16_swap_b32 v28, v30
    v_permlane16_swap_b32 v29, v31
    s_cmp_eq_u32 s47, 0
    s_cbranch_scc1 L_slow_10
    buffer_store_dwordx4 v[24:27], v6, s[32:35], s62 offen offset:0
    buffer_store_dwordx4 v[28:31], v6, s[32:35], s62 offen offset:1024
L_back_11:
    v_pk_add_f32 v[2:3], v[108:109], v[110:111]
    v_pk_mul_f32 v[12:13], v[108:109], v[108:109]
    v_pk_fma_f32 v[12:13], v[110:111], v[110:111], v[12:13]
    v_pk_add_f32 v[2:3], v[2:3], v[112:113]
    v_pk_fma_f32 v[12:13], v[112:113], v[112:113], v[12:13]
    v_pk_add_f32 v[2:3], v[2:3], v[114:115]
    v_pk_fma_f32 v[12:13], v[114:115], v[114:115], v[12:13]
    v_pk_add_f32 v[2:3], v[2:3], v[116:117]
    v_pk_fma_f32 v[12:13], v[116:117], v[116:117], v[12:13]
    v_pk_add_f32 v[2:3], v[2:3], v[118:119]
    v_pk_fma_f32 v[12:13], v[118:119], v[118:119], v[12:13]
    v_pk_add_f32 v[2:3], v[2:3], v[120:121]
    v_pk_fma_f32 v[12:13], v[120:121], v[120:121], v[12:13]
    v_pk_add_f32 v[2:3], v[2:3], v[122:123]
    v_pk_fma_f32 v[12:13], v[122:123], v[122:123], v[12:13]
    v_add_f32 v2, v2, v3
    v_add_f32 v12, v12, v13
    s_add_u32 s76, s46, 0
    v_mov_b32 v0, s76
    v_permlane32_swap_b32 v2, v12
    v_add_f32 v2, v2, v12
    v_mov_b32 v12, v2
    s_nop 1
    v_permlane16_swap_b32 v2, v12
    v_add_f32 v2, v2, v12
    s_cmp_eq_u32 s47, 0
    s_cbranch_scc1 L_slow_12
    buffer_store_dword v2, v10, s[32:35], s64 offen
L_back_13:
    s_waitcnt vmcnt(0) lgkmcnt(0)
    s_barrier
    s_cmp_eq_u32 s47, 0
    s_cbranch_scc1 L_slow_14
    buffer_store_dword v0, v9, s[32:35], s67 offen offset:32
L_back_15:
    v_add_u32 v7, 1024, v7
    v_add_u32 v8, 1024, v8
    s_add_u32 m0, s69, 65536
    s_nop 0
    buffer_load_dwordx4 v7, s[20:23], s52 offen lds
    s_add_u32 m0, s69, 69632
    s_nop 0
    buffer_load_dwordx4 v8, s[20:23], s52 offen lds
    s_add_u32 m0, s69, 73728
    s_nop 0
    buffer_load_dwordx4 v7, s[20:23], s53 offen lds
    s_add_u32 m0, s69, 77824
    s_nop 0
    buffer_load_dwordx4 v8, s[20:23], s53 offen lds
    s_add_u32 m0, s69, 81920
    s_nop 0
    buffer_load_dwordx4 v7, s[20:23], s54 offen lds
    s_add_u32 m0, s69, 86016
    s_nop 0
    buffer_load_dwordx4 v8, s[20:23], s54 offen lds
    s_add_u32 m0, s69, 90112
    s_nop 0
    buffer_load_dwordx4 v7, s[20:23], s55 offen lds
    s_add_u32 m0, s69, 94208
    s_nop 0
    buffer_load_dwordx4 v8, s[20:23], s55 offen lds
    s_add_u32 m0, s69, 98304
    s_nop 0
    buffer_load_dwordx4 v7, s[20:23], s56 offen lds
    s_add_u32 m0, s69, 102400
    s_nop 0
    buffer_load_dwordx4 v8, s[20:23], s56 offen lds
    s_add_u32 m0, s69, 106496
    s_nop 0
    buffer_load_dwordx4 v7, s[20:23], s57 offen lds
    s_add_u32 m0, s69, 110592
    s_nop 0
    buffer_load_dwordx4 v8, s[20:23], s57 offen lds
    s_add_u32 m0, s69, 114688
    s_nop 0
    buffer_load_dwordx4 v7, s[20:23], s58 offen lds
    s_add_u32 m0, s69, 118784
    s_nop 0
    buffer_load_dwordx4 v8, s[20:23], s58 offen lds
    s_add_u32 m0, s69, 122880
    s_nop 0
    buffer_load_dwordx4 v7, s[20:23], s59 offen lds
    s_add_u32 m0, s69, 126976
    s_nop 0
    buffer_load_dwordx4 v8, s[20:23], s59 offen lds
    v_mov_b32 v2, 0x3f803f80
    v_mov_b32 v3, 0x3f803f80
    v_mov_b32 v4, 0x3f803f80
    v_mov_b32 v5, 0x3f803f80
    v_bfe_u32 v6, v1, 7, 2
    v_xor_b32 v6, s40, v6
    v_lshrrev_b32 v0, 8, v1
    v_mul_u32_u24 v0, 1024, v0
    v_lshl_add_u32 v0, v6, 5, v0
    v_bfe_u32 v6, v1, 6, 2
    v_lshl_add_u32 v0, v6, 7, v0
    v_bfe_u32 v6, v1, 4, 2
    v_lshl_add_u32 v0, v6, 3, v0
    ds_read_b64_tr_b16 a[192:193], v0 offset:0
    ds_read_b64_tr_b16 a[194:195], v0 offset:512
    ds_read_b64_tr_b16 a[196:197], v0 offset:4096
    ds_read_b64_tr_b16 a[198:199], v0 offset:4608
    ds_read_b64_tr_b16 a[200:201], v0 offset:8192
    ds_read_b64_tr_b16 a[202:203], v0 offset:8704
    ds_read_b64_tr_b16 a[204:205], v0 offset:12288
    ds_read_b64_tr_b16 a[206:207], v0 offset:12800
    ds_read_b64_tr_b16 a[208:209], v0 offset:16384
    ds_read_b64_tr_b16 a[210:211], v0 offset:16896
    ds_read_b64_tr_b16 a[212:213], v0 offset:20480
    ds_read_b64_tr_b16 a[214:215], v0 offset:20992
    ds_read_b64_tr_b16 a[216:217], v0 offset:24576
    ds_read_b64_tr_b16 a[218:219], v0 offset:25088
    ds_read_b64_tr_b16 a[220:221], v0 offset:28672
    ds_read_b64_tr_b16 a[222:223], v0 offset:29184
    ds_read_b64_tr_b16 a[224:225], v0 offset:32768
    ds_read_b64_tr_b16 a[226:227], v0 offset:33280
    ds_read_b64_tr_b16 a[228:229], v0 offset:36864
    ds_read_b64_tr_b16 a[230:231], v0 offset:37376
    ds_read_b64_tr_b16 a[232:233], v0 offset:40960
    ds_read_b64_tr_b16 a[234:235], v0 offset:41472
    ds_read_b64_tr_b16 a[236:237], v0 offset:45056
    ds_read_b64_tr_b16 a[238:239], v0 offset:45568
    ds_read_b64_tr_b16 a[240:241], v0 offset:49152
    ds_read_b64_tr_b16 a[242:243], v0 offset:49664
    ds_read_b64_tr_b16 a[244:245], v0 offset:53248
    ds_read_b64_tr_b16 a[246:247], v0 offset:53760
    ds_read_b64_tr_b16 a[248:249], v0 offset:57344
    ds_read_b64_tr_b16 a[250:251], v0 offset:57856
    ds_read_b64_tr_b16 a[252:253], v0 offset:61440
    ds_read_b64_tr_b16 a[254:255], v0 offset:61952
    s_waitcnt lgkmcnt(0)
    s_barrier
    v_mfma_f32_16x16x32_bf16 v[10:13], a[192:195], v[2:5], 0
    v_mfma_f32_16x16x32_bf16 v[10:13], a[196:199], v[2:5], v[10:13]
    v_mfma_f32_16x16x32_bf16 v[10:13], a[200:203], v[2:5], v[10:13]
    v_mfma_f32_16x16x32_bf16 v[10:13], a[204:207], v[2:5], v[10:13]
    v_mfma_f32_16x16x32_bf16 v[10:13], a[208:211], v[2:5], v[10:13]
    v_mfma_f32_16x16x32_bf16 v[10:13], a[212:215], v[2:5], v[10:13]
    v_mfma_f32_16x16x32_bf16 v[10:13], a[216:219], v[2:5], v[10:13]
    v_mfma_f32_16x16x32_bf16 v[10:13], a[220:223], v[2:5], v[10:13]
    v_mfma_f32_16x16x32_bf16 v[10:13], a[224:227], v[2:5], v[10:13]
    v_mfma_f32_16x16x32_bf16 v[10:13], a[228:231], v[2:5], v[10:13]
    v_mfma_f32_16x16x32_bf16 v[10:13], a[232:235], v[2:5], v[10:13]
    v_mfma_f32_16x16x32_bf16 v[10:13], a[236:239], v[2:5], v[10:13]
    v_mfma_f32_16x16x32_bf16 v[10:13], a[240:243], v[2:5], v[10:13]
    v_mfma_f32_16x16x32_bf16 v[10:13], a[244:247], v[2:5], v[10:13]
    v_mfma_f32_16x16x32_bf16 v[10:13], a[248:251], v[2:5], v[10:13]
    v_mfma_f32_16x16x32_bf16 v[10:13], a[252:255], v[2:5], v[10:13]
    s_mul_i32 s80, s40, 192
    s_add_u32 s80, s80, 157440
    v_lshrrev_b32 v0, 8, v1
    v_lshl_add_u32 v0, v0, 4, s80
    v_bfe_u32 v6, v1, 4, 4
    v_lshl_add_u32 v6, v6, 2, s80
    s_nop 1
    ds_write_b128 v0, v[10:13] offset:64
    v_bfe_u32 v0, v1, 4, 1
    v_cmp_eq_u32 vcc, 0, v0
    v_lshrrev_b32 v6, 8, v1
    v_lshlrev_b32 v6, 2, v6
    v_bfe_u32 v0, v1, 4, 4
    v_sub_u32 v0, v0, v6
    v_cndmask_b32 v10, 0, v2, vcc
    v_cndmask_b32 v12, v2, 0, vcc
    v_cndmask_b32 v11, 0, v2, vcc
    v_cndmask_b32 v13, v2, 0, vcc
    v_cmp_eq_u32 vcc, 0, v0
    v_cmp_eq_u32 s[4:5], 1, v0
    v_mov_b32 v6, 0x3f80
    v_cndmask_b32 v14, 0, v6, vcc
    v_cndmask_b32 v14, v14, 1.0, s[4:5]
    v_cmp_eq_u32 vcc, 2, v0
    v_cmp_eq_u32 s[4:5], 3, v0
    v_mov_b32 v6, 0x3f80
    v_cndmask_b32 v15, 0, v6, vcc
    v_cndmask_b32 v15, v15, 1.0, s[4:5]
    v_lshrrev_b32 v0, 3, v1
    v_lshl_or_b32 v0, v1, 24, v0
    v_and_b32 v0, 0xf0000060, v0
    s_add_u32 s88, s72, 0
    s_add_u32 s89, s73, 0
    s_lshl_b32 s90, s40, 8
    s_add_u32 s81, s90, s89
    s_lshl_b32 s90, s40, 5
    s_add_u32 s82, s90, s89
    s_add_u32 s84, s90, s74
    s_lshr_b32 s90, s40, 1
    s_lshl_b32 s90, s90, 8
    s_and_b32 s83, s40, 1
    s_lshl3_add_u32 s83, s83, s90
    s_add_u32 s83, s83, s74
    s_add_u32 s85, s75, 0
    s_add_u32 s86, s75, 5120
    v_bfe_u32 v21, v1, 7, 2
    v_xor_b32 v21, s40, v21
    v_lshrrev_b32 v17, 8, v1
    v_mul_u32_u24 v17, 1024, v17
    v_lshl_add_u32 v17, v21, 5, v17
    v_bfe_u32 v21, v1, 6, 2
    v_lshl_add_u32 v17, v21, 7, v17
    v_bfe_u32 v21, v1, 4, 2
    v_lshl_add_u32 v17, v21, 3, v17
    v_add_u32 v17, 65536, v17
    s_and_b32 s80, s45, 1
    s_lshl_b32 s80, s80, 11
    v_add_u32 v21, s80, v1
    v_subrev_u32 v30, s80, v1
    v_add_u32 v30, 4096, v30
    s_mov_b32 s80, 155648
    v_bfe_u32 v31, v1, 4, 4
    v_lshl_add_u32 v31, v31, 2, s80
    v_lshrrev_b32 v32, 8, v1
    v_lshl_add_u32 v32, v32, 4, s80
    s_lshl_b32 s80, s40, 6
    v_add_u32 v6, s80, v31
    s_sub_u32 s93, s63, 4096
    v_bfe_u32 v33, v1, 4, 3
    v_lshlrev_b32 v33, 2, v33
    s_nop 2
L_poll_16:
    buffer_load_dword v34, v33, s[32:35], s66 offen offset:32 sc1
    s_sub_u32 s48, s48, 1
    s_max_i32 s48, s48, 0
    s_cmp_lg_u32 s48, 0
    s_cselect_b64 s[94:95], -1, 0
    s_waitcnt vmcnt(0)
    v_cmp_ne_u32 vcc, s76, v34
    s_nop 0
    s_and_b64 vcc, vcc, s[94:95]
    s_cbranch_scc1 L_poll_16
    s_add_u32 m0, s68, 0
    s_nop 0
    buffer_load_dwordx4 v21, s[32:35], s63 offen offset:0 sc1 lds
    buffer_load_dwordx4 v21, s[32:35], s63 offen offset:1024 sc1 lds
    buffer_load_dwordx4 v30, s[32:35], s93 offen offset:2048 sc1 lds
    buffer_load_dwordx4 v30, s[32:35], s93 offen offset:3072 sc1 lds
    buffer_load_dwordx4 v[22:25], v1, s[32:35], s65 offen sc1
    s_add_u32 s92, s63, 16384
    s_add_u32 s93, s63, 12288
    s_add_u32 m0, s68, 16384
    s_nop 0
    buffer_load_dwordx4 v21, s[32:35], s92 offen offset:0 sc1 lds
    buffer_load_dwordx4 v21, s[32:35], s92 offen offset:1024 sc1 lds
    buffer_load_dwordx4 v30, s[32:35], s93 offen offset:2048 sc1 lds
    buffer_load_dwordx4 v30, s[32:35], s93 offen offset:3072 sc1 lds
    s_barrier
    ds_read_b64_tr_b16 v[128:129], v17 offset:0
    ds_read_b64_tr_b16 v[130:131], v17 offset:512
    ds_read_b64_tr_b16 v[132:133], v17 offset:4096
    ds_read_b64_tr_b16 v[134:135], v17 offset:4608
    ds_read_b64_tr_b16 v[136:137], v17 offset:8192
    ds_read_b64_tr_b16 v[138:139], v17 offset:8704
    ds_read_b64_tr_b16 v[140:141], v17 offset:12288
    ds_read_b64_tr_b16 v[142:143], v17 offset:12800
    ds_read_b64_tr_b16 v[144:145], v17 offset:16384
    ds_read_b64_tr_b16 v[146:147], v17 offset:16896
    ds_read_b64_tr_b16 v[148:149], v17 offset:20480
    ds_read_b64_tr_b16 v[150:151], v17 offset:20992
    ds_read_b64_tr_b16 v[152:153], v17 offset:24576
    ds_read_b64_tr_b16 v[154:155], v17 offset:25088
    ds_read_b64_tr_b16 v[156:157], v17 offset:28672
    ds_read_b64_tr_b16 v[158:159], v17 offset:29184
    ds_read_b64_tr_b16 v[160:161], v17 offset:32768
    ds_read_b64_tr_b16 v[162:163], v17 offset:33280
    ds_read_b64_tr_b16 v[164:165], v17 offset:36864
    ds_read_b64_tr_b16 v[166:167], v17 offset:37376
    ds_read_b64_tr_b16 v[168:169], v17 offset:40960
    ds_read_b64_tr_b16 v[170:171], v17 offset:41472
    ds_read_b64_tr_b16 v[172:173], v17 offset:45056
    ds_read_b64_tr_b16 v[174:175], v17 offset:45568
    ds_read_b64_tr_b16 v[176:177], v17 offset:49152
    ds_read_b64_tr_b16 v[178:179], v17 offset:49664
    ds_read_b64_tr_b16 v[180:181], v17 offset:53248
    ds_read_b64_tr_b16 v[182:183], v17 offset:53760
    ds_read_b64_tr_b16 v[184:185], v17 offset:57344
    ds_read_b64_tr_b16 v[186:187], v17 offset:57856
    ds_read_b64_tr_b16 v[188:189], v17 offset:61440
    ds_read_b64_tr_b16 v[190:191], v17 offset:61952
    s_waitcnt lgkmcnt(15)
    v_mfma_f32_16x16x32_bf16 v[34:37], v[2:5], v[128:131], 0
    v_mfma_f32_16x16x32_bf16 v[34:37], v[2:5], v[132:135], v[34:37]
    v_mfma_f32_16x16x32_bf16 v[34:37], v[2:5], v[136:139], v[34:37]
    v_mfma_f32_16x16x32_bf16 v[34:37], v[2:5], v[140:143], v[34:37]
    v_mfma_f32_16x16x32_bf16 v[34:37], v[2:5], v[144:147], v[34:37]
    v_mfma_f32_16x16x32_bf16 v[34:37], v[2:5], v[148:151], v[34:37]
    v_mfma_f32_16x16x32_bf16 v[34:37], v[2:5], v[152:155], v[34:37]
    v_mfma_f32_16x16x32_bf16 v[34:37], v[2:5], v[156:159], v[34:37]
    s_waitcnt lgkmcnt(14)
    v_mfma_f32_16x16x32_bf16 v[34:37], v[2:5], v[160:163], v[34:37]
    s_waitcnt lgkmcnt(12)
    v_mfma_f32_16x16x32_bf16 v[34:37], v[2:5], v[164:167], v[34:37]
    s_waitcnt lgkmcnt(10)
    v_mfma_f32_16x16x32_bf16 v[34:37], v[2:5], v[168:171], v[34:37]
    s_waitcnt lgkmcnt(8)
    v_mfma_f32_16x16x32_bf16 v[34:37], v[2:5], v[172:175], v[34:37]
    s_waitcnt lgkmcnt(6)
    v_mfma_f32_16x16x32_bf16 v[34:37], v[2:5], v[176:179], v[34:37]
    s_waitcnt lgkmcnt(4)
    v_mfma_f32_16x16x32_bf16 v[34:37], v[2:5], v[180:183], v[34:37]
    s_waitcnt lgkmcnt(2)
    v_mfma_f32_16x16x32_bf16 v[34:37], v[2:5], v[184:187], v[34:37]
    s_waitcnt lgkmcnt(0)
    v_mfma_f32_16x16x32_bf16 v[34:37], v[2:5], v[188:191], v[34:37]
    s_mul_i32 s80, s40, 192
    s_add_u32 s80, s80, 157440
    v_lshrrev_b32 v33, 8, v1
    v_lshl_add_u32 v33, v33, 4, s80
    v_bfe_u32 v38, v1, 4, 4
    v_lshl_add_u32 v38, v38, 2, s80
    s_nop 1
    ds_write_b32 v38, v34 offset:128
    s_mul_i32 s80, s40, 192
    s_add_u32 s80, s80, 157440
    v_lshrrev_b32 v33, 8, v1
    v_lshl_add_u32 v33, v33, 4, s80
    v_bfe_u32 v34, v1, 4, 4
    v_lshl_add_u32 v34, v34, 2, s80
    ds_read_b128 v[36:39], v33 offset:64
    ds_read_b32 v40, v34 offset:128
    s_waitcnt vmcnt(5) lgkmcnt(0)
    s_barrier
    ds_read_b128 v[42:45], v1 offset:0
    ds_read_b128 v[46:49], v1 offset:1024
    ds_read_b128 v[50:53], v1 offset:2048
    s_waitcnt lgkmcnt(2)
    v_mfma_f32_16x16x32_bf16 v[96:99], a[192:195], v[42:45], 0
    ds_read_b128 v[58:61], v1 offset:3072
    s_waitcnt vmcnt(4)
    v_add_f32 v22, v22, v24
    v_mfma_f32_16x16x32_bf16 v[100:103], v[42:45], v[128:131], 0
    s_waitcnt lgkmcnt(2)
    v_add_f32 v23, v23, v25
    v_mov_b32 v124, s46
    v_mfma_f32_16x16x32_bf16 v[96:99], a[196:199], v[46:49], v[96:99]
    ds_read_b128 v[42:45], v1 offset:4096
    v_mfma_f32_16x16x32_bf16 v[100:103], v[46:49], v[132:135], v[100:103]
    s_waitcnt lgkmcnt(2)
    v_permlane32_swap_b32 v22, v23
    v_mfma_f32_16x16x32_bf16 v[96:99], a[200:203], v[50:53], v[96:99]
    ds_read_b128 v[46:49], v1 offset:5120
    v_add_f32 v22, v22, v23
    v_mfma_f32_16x16x32_bf16 v[100:103], v[50:53], v[136:139], v[100:103]
    s_lshl_b32 s3, s41, 7
    v_mov_b32 v23, v22
    s_waitcnt lgkmcnt(2)
    v_mfma_f32_16x16x32_bf16 v[96:99], a[204:207], v[58:61], v[96:99]
    ds_read_b128 v[50:53], v1 offset:6144
    v_permlane16_swap_b32 v22, v23
    v_mfma_f32_16x16x32_bf16 v[100:103], v[58:61], v[140:143], v[100:103]
    s_add_u32 s3, s3, 8192
    s_waitcnt lgkmcnt(2)
    v_mfma_f32_16x16x32_bf16 v[96:99], a[208:211], v[42:45], v[96:99]
    ds_read_b128 v[58:61], v1 offset:7168
    v_add_f32 v22, v22, v23
    v_mfma_f32_16x16x32_bf16 v[100:103], v[42:45], v[144:147], v[100:103]
    s_lshl2_add_u32 s91, s43, s3
    v_mov_b32 v23, v22
    s_waitcnt lgkmcnt(2)
    v_mfma_f32_16x16x32_bf16 v[96:99], a[212:215], v[46:49], v[96:99]
    ds_read_b128 v[42:45], v1 offset:8192
    v_permlane32_swap_b32 v22, v23
    v_mfma_f32_16x16x32_bf16 v[100:103], v[46:49], v[148:151], v[100:103]
    v_mul_f32 v22, 0xbb000000, v22
    s_waitcnt lgkmcnt(2)
    v_mfma_f32_16x16x32_bf16 v[96:99], a[216:219], v[50:53], v[96:99]
    ds_read_b128 v[46:49], v1 offset:9216
    v_mul_f32 v23, 0x3b000000, v23
    v_fma_f32 v23, -v22, v22, v23
    v_mfma_f32_16x16x32_bf16 v[100:103], v[50:53], v[152:155], v[100:103]
    buffer_store_dword v124, v9, s[32:35], s91 offen sc1
    v_max_f32 v23, 0, v23
    s_waitcnt lgkmcnt(2)
    v_mfma_f32_16x16x32_bf16 v[96:99], a[220:223], v[58:61], v[96:99]
    ds_read_b128 v[50:53], v1 offset:10240
    v_add_f32 v23, 0x3727c5ac, v23
    v_mfma_f32_16x16x32_bf16 v[100:103], v[58:61], v[156:159], v[100:103]
    s_add_u32 s92, s63, 32768
    v_rsq_f32 v23, v23
    s_waitcnt lgkmcnt(2)
    v_mfma_f32_16x16x32_bf16 v[96:99], a[224:227], v[42:45], v[96:99]
    ds_read_b128 v[58:61], v1 offset:11264
    ds_write_b32 v6, v22 offset:320
    ds_write_b32 v6, v23 offset:0
    v_mfma_f32_16x16x32_bf16 v[100:103], v[42:45], v[160:163], v[100:103]
    s_waitcnt lgkmcnt(4)
    v_mfma_f32_16x16x32_bf16 v[96:99], a[228:231], v[46:49], v[96:99]
    ds_read_b128 v[42:45], v1 offset:12288
    s_add_u32 s93, s63, 28672
    v_mfma_f32_16x16x32_bf16 v[100:103], v[46:49], v[164:167], v[100:103]
    s_waitcnt lgkmcnt(4)
    s_add_u32 m0, s68, 32768
    v_mfma_f32_16x16x32_bf16 v[96:99], a[232:235], v[50:53], v[96:99]
    ds_read_b128 v[46:49], v1 offset:13312
    buffer_load_dwordx4 v21, s[32:35], s92 offen offset:0 sc1 lds
    v_mfma_f32_16x16x32_bf16 v[100:103], v[50:53], v[168:171], v[100:103]
    s_waitcnt lgkmcnt(4)
    v_mfma_f32_16x16x32_bf16 v[96:99], a[236:239], v[58:61], v[96:99]
    ds_read_b128 v[50:53], v1 offset:14336
    buffer_load_dwordx4 v21, s[32:35], s92 offen offset:1024 sc1 lds
    v_mfma_f32_16x16x32_bf16 v[100:103], v[58:61], v[172:175], v[100:103]
    s_waitcnt lgkmcnt(2)
    v_mfma_f32_16x16x32_bf16 v[96:99], a[240:243], v[42:45], v[96:99]
    ds_read_b128 v[58:61], v1 offset:15360
    buffer_load_dwordx4 v30, s[32:35], s93 offen offset:2048 sc1 lds
    v_mfma_f32_16x16x32_bf16 v[100:103], v[42:45], v[176:179], v[100:103]
    s_waitcnt lgkmcnt(2)
    v_mfma_f32_16x16x32_bf16 v[96:99], a[244:247], v[46:49], v[96:99]
    s_waitcnt vmcnt(4)
    s_barrier
    ds_read_b128 v[42:45], v1 offset:16384
    ds_read_b32 v16, v31 offset:320
    ds_read_b32 v6, v31 offset:0
    ds_read_b128 v[26:29], v32 offset:320
    ds_read_b128 v[22:25], v32 offset:0
    v_mfma_f32_16x16x32_bf16 v[100:103], v[46:49], v[180:183], v[100:103]
    s_waitcnt lgkmcnt(6)
    v_mfma_f32_16x16x32_bf16 v[96:99], a[248:251], v[50:53], v[96:99]
    ds_read_b128 v[46:49], v1 offset:17408
    buffer_load_dwordx4 v30, s[32:35], s93 offen offset:3072 sc1 lds
    v_mfma_f32_16x16x32_bf16 v[100:103], v[50:53], v[184:187], v[100:103]
    s_waitcnt lgkmcnt(6)
    v_mfma_f32_16x16x32_bf16 v[96:99], a[252:255], v[58:61], v[96:99]
    ds_read_b128 v[50:53], v1 offset:18432
    v_mfma_f32_16x16x32_bf16 v[100:103], v[58:61], v[188:191], v[100:103]
    s_waitcnt lgkmcnt(6)
    v_mfma_f32_16x16x32_bf16 v[104:107], a[192:195], v[42:45], 0
    ds_read_b128 v[58:61], v1 offset:19456
    v_mfma_f32_16x16x32_bf16 v[108:111], v[42:45], v[128:131], 0
    s_add_u32 s92, s63, 49152
    s_waitcnt lgkmcnt(2)
    v_mfma_f32_16x16x32_bf16 v[104:107], a[196:199], v[46:49], v[104:107]
    ds_read_b128 v[42:45], v1 offset:20480
    v_fma_f32 v96, v16, v36, v96
    v_fma_f32 v97, v16, v37, v97
    v_fma_f32 v98, v16, v38, v98
    v_fma_f32 v99, v16, v39, v99
    v_cvt_pk_bf16_f32 v34, v96, v97
    v_cvt_pk_bf16_f32 v35, v98, v99
    v_mul_f32 v56, 0x3fb8aa3b, v6
    v_mfma_f32_16x16x32_bf16 v[108:111], v[46:49], v[132:135], v[108:111]
    s_waitcnt lgkmcnt(2)
    v_mfma_f32_16x16x16_bf16 v[112:115], v[18:19], v[34:35], 0
    s_add_u32 s93, s63, 45056
    v_fma_f32 v100, v26, v40, v100
    v_fma_f32 v101, v27, v40, v101
    v_mfma_f32_16x16x32_bf16 v[104:107], a[200:203], v[50:53], v[104:107]
    ds_read_b128 v[46:49], v1 offset:21504
    v_fma_f32 v102, v28, v40, v102
    v_mfma_f32_16x16x32_bf16 v[108:111], v[50:53], v[136:139], v[108:111]
    s_waitcnt lgkmcnt(2)
    v_fma_f32 v103, v29, v40, v103
    v_max3_f32 v54, v112, v113, v114
    v_max3_f32 v55, -v112, -v113, -v114
    v_max_f32 v54, v54, v115
    v_max_f32_e64 v55, v55, -v115
    s_add_u32 m0, s68, 49152
    v_mfma_f32_16x16x32_bf16 v[104:107], a[204:207], v[58:61], v[104:107]
    ds_read_b128 v[50:53], v1 offset:22528
    buffer_load_dwordx4 v21, s[32:35], s92 offen offset:0 sc1 lds
    v_permlane32_swap_b32 v54, v55
    v_max_f32 v54, v54, v55
    v_mfma_f32_16x16x32_bf16 v[108:111], v[58:61], v[140:143], v[108:111]
    s_waitcnt lgkmcnt(2)
    v_mov_b32 v55, v54
    v_mul_f32 v100, v22, v100
    v_mfma_f32_16x16x32_bf16 v[104:107], a[208:211], v[42:45], v[104:107]
    ds_read_b128 v[58:61], v1 offset:23552
    v_permlane16_swap_b32 v54, v55
    v_max_f32 v54, v54, v55
    v_mov_b32 v55, v54
    v_mfma_f32_16x16x32_bf16 v[108:111], v[42:45], v[144:147], v[108:111]
    s_waitcnt lgkmcnt(2)
    v_mul_f32 v101, v23, v101
    v_permlane32_swap_b32 v54, v55
    v_mfma_f32_16x16x32_bf16 v[104:107], a[212:215], v[46:49], v[104:107]
    ds_read_b128 v[42:45], v1 offset:24576
    buffer_load_dwordx4 v21, s[32:35], s92 offen offset:1024 sc1 lds
    v_mul_f32_e64 v54, -v54, v56
    v_mul_f32_e64 v55, -v55, v56
    v_mfma_f32_16x16x32_bf16 v[108:111], v[46:49], v[148:151], v[108:111]
    s_waitcnt lgkmcnt(2)
    v_fma_f32 v116, v112, v56, v54
    v_fma_f32 v117, v113, v56, v54
    v_fma_f32 v118, v114, v56, v54
    v_mfma_f32_16x16x32_bf16 v[104:107], a[216:219], v[50:53], v[104:107]
    ds_read_b128 v[46:49], v1 offset:25600
    buffer_load_dwordx4 v30, s[32:35], s93 offen offset:2048 sc1 lds
    v_fma_f32 v119, v115, v56, v54
    v_fma_f32 v120, -v112, v56, v55
    v_mfma_f32_16x16x32_bf16 v[108:111], v[50:53], v[152:155], v[108:111]
    s_waitcnt lgkmcnt(2)
    v_fma_f32 v121, -v113, v56, v55
    v_fma_f32 v122, -v114, v56, v55
    v_mfma_f32_16x16x32_bf16 v[104:107], a[220:223], v[58:61], v[104:107]
    ds_read_b128 v[50:53], v1 offset:26624
    v_fma_f32 v123, -v115, v56, v55
    v_exp_f32 v116, v116
    v_mfma_f32_16x16x32_bf16 v[108:111], v[58:61], v[156:159], v[108:111]
    s_waitcnt lgkmcnt(2)
    v_exp_f32 v117, v117
    v_mfma_f32_16x16x32_bf16 v[104:107], a[224:227], v[42:45], v[104:107]
    ds_read_b128 v[58:61], v1 offset:27648
    buffer_load_dwordx4 v30, s[32:35], s93 offen offset:3072 sc1 lds
    v_exp_f32 v118, v118
    v_mfma_f32_16x16x32_bf16 v[108:111], v[42:45], v[160:163], v[108:111]
    s_waitcnt lgkmcnt(2)
    v_exp_f32 v119, v119
    v_mul_f32 v102, v24, v102
    v_mfma_f32_16x16x32_bf16 v[104:107], a[228:231], v[46:49], v[104:107]
    ds_read_b128 v[42:45], v1 offset:28672
    v_exp_f32 v120, v120
    v_mul_f32 v103, v25, v103
    v_mfma_f32_16x16x32_bf16 v[108:111], v[46:49], v[164:167], v[108:111]
    s_waitcnt lgkmcnt(2)
    v_exp_f32 v121, v121
    v_exp_f32 v122, v122
    v_cvt_pk_bf16_f32 v88, v100, v101
    v_cvt_pk_bf16_f32 v89, v102, v103
    v_mfma_f32_16x16x32_bf16 v[104:107], a[232:235], v[50:53], v[104:107]
    ds_read_b128 v[46:49], v1 offset:29696
    ds_read_b32 v16, v31 offset:384
    ds_read_b32 v6, v31 offset:64
    ds_read_b128 v[26:29], v32 offset:384
    ds_read_b128 v[22:25], v32 offset:64
    v_exp_f32 v123, v123
    v_mfma_f32_16x16x32_bf16 v[108:111], v[50:53], v[168:171], v[108:111]
    s_waitcnt lgkmcnt(6)
    v_cvt_pk_bf16_f32 v92, v116, v117
    v_cvt_pk_bf16_f32 v93, v118, v119
    v_bfe_u32 v124, v1, 4, 5
    v_mfma_f32_16x16x32_bf16 v[104:107], a[236:239], v[58:61], v[104:107]
    ds_read_b128 v[50:53], v1 offset:30720
    v_cvt_pk_bf16_f32 v94, v120, v121
    v_mfma_f32_16x16x32_bf16 v[108:111], v[58:61], v[172:175], v[108:111]
    s_waitcnt lgkmcnt(6)
    v_cvt_pk_bf16_f32 v95, v122, v123
    v_lshlrev_b32 v124, 2, v124
    v_mfma_f32_16x16x32_bf16 v[104:107], a[240:243], v[42:45], v[104:107]
    ds_read_b128 v[58:61], v1 offset:31744
    buffer_load_dword v125, v124, s[32:35], s3 offen offset:0 sc1
    v_mfma_f32_16x16x32_bf16 v[112:115], v[10:13], v[92:95], 0
    v_add_u32 v7, -2048, v7
    v_add_u32 v8, -2048, v8
    v_mfma_f32_16x16x32_bf16 v[108:111], v[42:45], v[176:179], v[108:111]
    s_waitcnt lgkmcnt(6)
    v_mfma_f32_16x16x32_bf16 v[104:107], a[244:247], v[46:49], v[104:107]
    s_waitcnt vmcnt(5)
    s_barrier
    ds_read_b128 v[42:45], v1 offset:32768
    v_mfma_f32_16x16x32_bf16 v[108:111], v[46:49], v[180:183], v[108:111]
    s_waitcnt lgkmcnt(2)
    v_mfma_f32_16x16x32_bf16 v[104:107], a[248:251], v[50:53], v[104:107]
    ds_read_b128 v[46:49], v1 offset:33792
    v_rcp_f32 v54, v112
    v_rcp_f32 v55, v113
    v_mul_f32 v116, v54, v116
    v_mul_f32 v117, v54, v117
    v_mul_f32 v118, v54, v118
    v_mul_f32 v119, v54, v119
    v_mul_f32 v120, v55, v120
    v_mul_f32 v121, v55, v121
    v_mul_f32 v122, v55, v122
    v_mfma_f32_16x16x32_bf16 v[108:111], v[50:53], v[184:187], v[108:111]
    s_waitcnt lgkmcnt(2)
    v_mul_f32 v123, v55, v123
    v_cvt_pk_bf16_f32 v92, v116, v117
    v_mfma_f32_16x16x32_bf16 v[104:107], a[252:255], v[58:61], v[104:107]
    ds_read_b128 v[50:53], v1 offset:34816
    v_cvt_pk_bf16_f32 v93, v118, v119
    v_cvt_pk_bf16_f32 v94, v120, v121
    v_mfma_f32_16x16x32_bf16 v[108:111], v[58:61], v[188:191], v[108:111]
    s_waitcnt lgkmcnt(2)
    v_cvt_pk_bf16_f32 v95, v122, v123
    v_mfma_f32_16x16x16_bf16 v[116:119], v[92:93], v[14:15], 0
    s_add_u32 m0, s69, 65536
    v_mfma_f32_16x16x16_bf16 v[120:123], v[94:95], v[14:15], 0
    buffer_load_dwordx4 v7, s[20:23], s52 offen lds
    v_mfma_f32_16x16x32_bf16 v[96:99], a[192:195], v[42:45], 0
    ds_read_b128 v[58:61], v1 offset:35840
    v_mfma_f32_16x16x32_bf16 v[100:103], v[42:45], v[128:131], 0
    s_waitcnt lgkmcnt(2)
    v_fma_f32 v108, v26, v40, v108
    v_fma_f32 v109, v27, v40, v109
    v_cvt_pk_bf16_f32 v80, v116, v117
    v_cvt_pk_bf16_f32 v81, v118, v119
    v_mfma_f32_16x16x32_bf16 v[96:99], a[196:199], v[46:49], v[96:99]
    ds_read_b128 v[42:45], v1 offset:36864
    v_cvt_pk_bf16_f32 v84, v120, v121
    v_cvt_pk_bf16_f32 v85, v122, v123
    v_fma_f32 v104, v16, v36, v104
    v_fma_f32 v105, v16, v37, v105
    v_fma_f32 v106, v16, v38, v106
    v_fma_f32 v107, v16, v39, v107
    v_cvt_pk_bf16_f32 v34, v104, v105
    v_cvt_pk_bf16_f32 v35, v106, v107
    v_mul_f32 v56, 0x3fb8aa3b, v6
    v_mfma_f32_16x16x32_bf16 v[100:103], v[46:49], v[132:135], v[100:103]
    s_waitcnt lgkmcnt(2)
    v_mfma_f32_16x16x16_bf16 v[112:115], v[18:19], v[34:35], 0
    s_add_u32 m0, s69, 69632
    v_fma_f32 v110, v28, v40, v110
    v_fma_f32 v111, v29, v40, v111
    v_mfma_f32_16x16x32_bf16 v[96:99], a[200:203], v[50:53], v[96:99]
    ds_read_b128 v[46:49], v1 offset:37888
    buffer_load_dwordx4 v8, s[20:23], s52 offen lds
    v_mfma_f32_16x16x32_bf16 v[100:103], v[50:53], v[136:139], v[100:103]
    s_waitcnt lgkmcnt(2)
    v_mul_f32 v108, v22, v108
    v_max3_f32 v54, v112, v113, v114
    v_max3_f32 v55, -v112, -v113, -v114
    v_max_f32 v54, v54, v115
    v_max_f32_e64 v55, v55, -v115
    v_mfma_f32_16x16x32_bf16 v[96:99], a[204:207], v[58:61], v[96:99]
    ds_read_b128 v[50:53], v1 offset:38912
    v_permlane32_swap_b32 v54, v55
    v_max_f32 v54, v54, v55
    v_mov_b32 v55, v54
    v_mfma_f32_16x16x32_bf16 v[100:103], v[58:61], v[140:143], v[100:103]
    s_waitcnt lgkmcnt(2)
    v_mul_f32 v109, v23, v109
    v_permlane16_swap_b32 v54, v55
    v_max_f32 v54, v54, v55
    s_add_u32 m0, s69, 73728
    v_mfma_f32_16x16x32_bf16 v[96:99], a[208:211], v[42:45], v[96:99]
    ds_read_b128 v[58:61], v1 offset:39936
    buffer_load_dwordx4 v7, s[20:23], s53 offen lds
    v_mov_b32 v55, v54
    v_mfma_f32_16x16x32_bf16 v[100:103], v[42:45], v[144:147], v[100:103]
    s_waitcnt lgkmcnt(2)
    v_mul_f32 v110, v24, v110
    v_permlane32_swap_b32 v54, v55
    v_mul_f32_e64 v54, -v54, v56
    v_mul_f32_e64 v55, -v55, v56
    v_mfma_f32_16x16x32_bf16 v[96:99], a[212:215], v[46:49], v[96:99]
    ds_read_b128 v[42:45], v1 offset:40960
    v_fma_f32 v116, v112, v56, v54
    v_fma_f32 v117, v113, v56, v54
    v_fma_f32 v118, v114, v56, v54
    v_mfma_f32_16x16x32_bf16 v[100:103], v[46:49], v[148:151], v[100:103]
    s_waitcnt lgkmcnt(2)
    v_fma_f32 v119, v115, v56, v54
    v_fma_f32 v120, -v112, v56, v55
    s_add_u32 m0, s69, 77824
    v_mfma_f32_16x16x32_bf16 v[96:99], a[216:219], v[50:53], v[96:99]
    ds_read_b128 v[46:49], v1 offset:41984
    buffer_load_dwordx4 v8, s[20:23], s53 offen lds
    v_fma_f32 v121, -v113, v56, v55
    v_fma_f32 v122, -v114, v56, v55
    v_fma_f32 v123, -v115, v56, v55
    v_mfma_f32_16x16x32_bf16 v[100:103], v[50:53], v[152:155], v[100:103]
    s_waitcnt lgkmcnt(2)
    v_exp_f32 v116, v116
    v_mfma_f32_16x16x32_bf16 v[96:99], a[220:223], v[58:61], v[96:99]
    ds_read_b128 v[50:53], v1 offset:43008
    v_exp_f32 v117, v117
    v_exp_f32 v118, v118
    v_mfma_f32_16x16x32_bf16 v[100:103], v[58:61], v[156:159], v[100:103]
    s_waitcnt lgkmcnt(2)
    v_exp_f32 v119, v119
    s_add_u32 m0, s69, 81920
    v_mfma_f32_16x16x32_bf16 v[96:99], a[224:227], v[42:45], v[96:99]
    ds_read_b128 v[58:61], v1 offset:44032
    buffer_load_dwordx4 v7, s[20:23], s54 offen lds
    v_exp_f32 v120, v120
    v_mfma_f32_16x16x32_bf16 v[100:103], v[42:45], v[160:163], v[100:103]
    s_waitcnt lgkmcnt(2)
    v_exp_f32 v121, v121
    v_mfma_f32_16x16x32_bf16 v[96:99], a[228:231], v[46:49], v[96:99]
    ds_read_b128 v[42:45], v1 offset:45056
    v_exp_f32 v122, v122
    v_exp_f32 v123, v123
    v_mul_f32 v111, v25, v111
    v_mfma_f32_16x16x32_bf16 v[100:103], v[46:49], v[164:167], v[100:103]
    s_waitcnt lgkmcnt(2)
    v_cvt_pk_bf16_f32 v92, v116, v117
    v_cvt_pk_bf16_f32 v93, v118, v119
    v_cvt_pk_bf16_f32 v90, v108, v109
    v_cvt_pk_bf16_f32 v91, v110, v111
    s_add_u32 m0, s69, 86016
    v_mfma_f32_16x16x32_bf16 v[96:99], a[232:235], v[50:53], v[96:99]
    ds_read_b128 v[46:49], v1 offset:46080
    ds_read_b32 v16, v31 offset:448
    ds_read_b32 v6, v31 offset:128
    ds_read_b128 v[26:29], v32 offset:448
    ds_read_b128 v[22:25], v32 offset:128
    buffer_load_dwordx4 v8, s[20:23], s54 offen lds
    v_cvt_pk_bf16_f32 v94, v120, v121
    v_cvt_pk_bf16_f32 v95, v122, v123
    v_mfma_f32_16x16x32_bf16 v[100:103], v[50:53], v[168:171], v[100:103]
    s_waitcnt lgkmcnt(6)
    v_mfma_f32_16x16x32_bf16 v[96:99], a[236:239], v[58:61], v[96:99]
    ds_read_b128 v[50:53], v1 offset:47104
    v_mfma_f32_16x16x32_bf16 v[112:115], v[10:13], v[92:95], 0
    s_add_u32 m0, s69, 90112
    v_mfma_f32_16x16x32_bf16 v[100:103], v[58:61], v[172:175], v[100:103]
    s_waitcnt lgkmcnt(6)
    v_mfma_f32_16x16x32_bf16 v[96:99], a[240:243], v[42:45], v[96:99]
    ds_read_b128 v[58:61], v1 offset:48128
    buffer_load_dwordx4 v7, s[20:23], s55 offen lds
    v_mfma_f32_16x16x32_bf16 v[100:103], v[42:45], v[176:179], v[100:103]
    s_waitcnt lgkmcnt(6)
    v_mfma_f32_16x16x32_bf16 v[96:99], a[244:247], v[46:49], v[96:99]
    s_waitcnt vmcnt(8)
    s_barrier
    ds_read_b128 v[42:45], v1 offset:49152
    v_rcp_f32 v54, v112
    v_rcp_f32 v55, v113
    v_mul_f32 v116, v54, v116
    v_mul_f32 v117, v54, v117
    v_mul_f32 v118, v54, v118
    v_mul_f32 v119, v54, v119
    v_mul_f32 v120, v55, v120
    v_mul_f32 v121, v55, v121
    v_mul_f32 v122, v55, v122
    v_mul_f32 v123, v55, v123
    v_cvt_pk_bf16_f32 v92, v116, v117
    v_mfma_f32_16x16x32_bf16 v[100:103], v[46:49], v[180:183], v[100:103]
    s_waitcnt lgkmcnt(2)
    v_cvt_pk_bf16_f32 v93, v118, v119
    v_cvt_pk_bf16_f32 v94, v120, v121
    s_add_u32 m0, s69, 94208
    v_mfma_f32_16x16x32_bf16 v[96:99], a[248:251], v[50:53], v[96:99]
    ds_read_b128 v[46:49], v1 offset:50176
    buffer_load_dwordx4 v8, s[20:23], s55 offen lds
    v_cvt_pk_bf16_f32 v95, v122, v123
    v_mfma_f32_16x16x16_bf16 v[116:119], v[92:93], v[14:15], 0
    s_add_u32 m0, s69, 98304
    v_mfma_f32_16x16x16_bf16 v[120:123], v[94:95], v[14:15], 0
    v_mfma_f32_16x16x32_bf16 v[100:103], v[50:53], v[184:187], v[100:103]
    s_waitcnt lgkmcnt(2)
    v_mfma_f32_16x16x32_bf16 v[96:99], a[252:255], v[58:61], v[96:99]
    ds_read_b128 v[50:53], v1 offset:51200
    v_mfma_f32_16x16x32_bf16 v[100:103], v[58:61], v[188:191], v[100:103]
    s_waitcnt lgkmcnt(2)
    v_mfma_f32_16x16x32_bf16 v[104:107], a[192:195], v[42:45], 0
    ds_read_b128 v[58:61], v1 offset:52224
    buffer_load_dwordx4 v7, s[20:23], s56 offen lds
    v_cvt_pk_bf16_f32 v82, v116, v117
    v_cvt_pk_bf16_f32 v83, v118, v119
    v_cvt_pk_bf16_f32 v86, v120, v121
    v_cvt_pk_bf16_f32 v87, v122, v123
    v_mfma_f32_16x16x32_bf16 v[72:75], v[80:83], v[2:5], 0
    s_add_u32 m0, s69, 102400
    v_mfma_f32_16x16x32_bf16 v[64:67], v[80:83], v[88:91], 0
    v_mfma_f32_16x16x32_bf16 v[76:79], v[84:87], v[2:5], 0
    v_mfma_f32_16x16x32_bf16 v[68:71], v[84:87], v[88:91], 0
    v_fma_f32 v96, v16, v36, v96
    v_fma_f32 v97, v16, v37, v97
    v_fma_f32 v98, v16, v38, v98
    v_mfma_f32_16x16x32_bf16 v[108:111], v[42:45], v[128:131], 0
    s_waitcnt lgkmcnt(2)
    v_fma_f32 v99, v16, v39, v99
    v_cvt_pk_bf16_f32 v34, v96, v97
    v_cvt_pk_bf16_f32 v35, v98, v99
    v_mfma_f32_16x16x32_bf16 v[104:107], a[196:199], v[46:49], v[104:107]
    ds_read_b128 v[42:45], v1 offset:53248
    v_mul_f32 v56, 0x3fb8aa3b, v6
    v_mfma_f32_16x16x16_bf16 v[112:115], v[18:19], v[34:35], 0
    v_fma_f32 v100, v26, v40, v100
    v_fma_f32 v101, v27, v40, v101
    v_mfma_f32_16x16x32_bf16 v[108:111], v[46:49], v[132:135], v[108:111]
    s_waitcnt lgkmcnt(2)
    v_fma_f32 v102, v28, v40, v102
    v_fma_f32 v103, v29, v40, v103
    v_mfma_f32_16x16x32_bf16 v[104:107], a[200:203], v[50:53], v[104:107]
    ds_read_b128 v[46:49], v1 offset:54272
    buffer_load_dwordx4 v8, s[20:23], s56 offen lds
    v_max3_f32 v54, v112, v113, v114
    v_max3_f32 v55, -v112, -v113, -v114
    v_max_f32 v54, v54, v115
    v_max_f32_e64 v55, v55, -v115
    v_mfma_f32_16x16x32_bf16 v[108:111], v[50:53], v[136:139], v[108:111]
    s_waitcnt lgkmcnt(2)
    v_mul_f32 v100, v22, v100
    v_permlane32_swap_b32 v54, v55
    v_max_f32 v54, v54, v55
    v_mfma_f32_16x16x32_bf16 v[104:107], a[204:207], v[58:61], v[104:107]
    ds_read_b128 v[50:53], v1 offset:55296
    v_mov_b32 v55, v54
    v_mfma_f32_16x16x32_bf16 v[108:111], v[58:61], v[140:143], v[108:111]
    s_waitcnt lgkmcnt(2)
    v_mul_f32 v101, v23, v101
    v_permlane16_swap_b32 v54, v55
    v_max_f32 v54, v54, v55
    v_mov_b32 v55, v54
    s_add_u32 m0, s69, 106496
    v_mfma_f32_16x16x32_bf16 v[104:107], a[208:211], v[42:45], v[104:107]
    ds_read_b128 v[58:61], v1 offset:56320
    buffer_load_dwordx4 v7, s[20:23], s57 offen lds
    v_permlane32_swap_b32 v54, v55
    v_mfma_f32_16x16x32_bf16 v[108:111], v[42:45], v[144:147], v[108:111]
    s_waitcnt lgkmcnt(2)
    v_mul_f32_e64 v54, -v54, v56
    v_mul_f32_e64 v55, -v55, v56
    v_fma_f32 v116, v112, v56, v54
    v_mfma_f32_16x16x32_bf16 v[104:107], a[212:215], v[46:49], v[104:107]
    ds_read_b128 v[42:45], v1 offset:57344
    v_fma_f32 v117, v113, v56, v54
    v_fma_f32 v118, v114, v56, v54
    v_fma_f32 v119, v115, v56, v54
    v_mfma_f32_16x16x32_bf16 v[108:111], v[46:49], v[148:151], v[108:111]
    s_waitcnt lgkmcnt(2)
    v_fma_f32 v120, -v112, v56, v55
    v_fma_f32 v121, -v113, v56, v55
    s_add_u32 m0, s69, 110592
    v_mfma_f32_16x16x32_bf16 v[104:107], a[216:219], v[50:53], v[104:107]
    ds_read_b128 v[46:49], v1 offset:58368
    buffer_load_dwordx4 v8, s[20:23], s57 offen lds
    v_fma_f32 v122, -v114, v56, v55
    v_fma_f32 v123, -v115, v56, v55
    v_exp_f32 v116, v116
    v_mfma_f32_16x16x32_bf16 v[108:111], v[50:53], v[152:155], v[108:111]
    s_waitcnt lgkmcnt(2)
    v_exp_f32 v117, v117
    v_mfma_f32_16x16x32_bf16 v[104:107], a[220:223], v[58:61], v[104:107]
    ds_read_b128 v[50:53], v1 offset:59392
    v_exp_f32 v118, v118
    v_mfma_f32_16x16x32_bf16 v[108:111], v[58:61], v[156:159], v[108:111]
    s_waitcnt lgkmcnt(2)
    v_exp_f32 v119, v119
    s_add_u32 m0, s69, 114688
    v_mfma_f32_16x16x32_bf16 v[104:107], a[224:227], v[42:45], v[104:107]
    ds_read_b128 v[58:61], v1 offset:60416
    buffer_load_dwordx4 v7, s[20:23], s58 offen lds
    v_exp_f32 v120, v120
    v_exp_f32 v121, v121
    v_mfma_f32_16x16x32_bf16 v[108:111], v[42:45], v[160:163], v[108:111]
    s_waitcnt lgkmcnt(2)
    v_exp_f32 v122, v122
    v_mul_f32 v102, v24, v102
    v_mfma_f32_16x16x32_bf16 v[104:107], a[228:231], v[46:49], v[104:107]
    ds_read_b128 v[42:45], v1 offset:61440
    v_exp_f32 v123, v123
    v_mul_f32 v103, v25, v103
    v_mfma_f32_16x16x32_bf16 v[108:111], v[46:49], v[164:167], v[108:111]
    s_waitcnt lgkmcnt(2)
    v_cvt_pk_bf16_f32 v92, v116, v117
    v_cvt_pk_bf16_f32 v93, v118, v119
    v_cvt_pk_bf16_f32 v88, v100, v101
    v_cvt_pk_bf16_f32 v89, v102, v103
    s_add_u32 m0, s69, 118784
    v_mfma_f32_16x16x32_bf16 v[104:107], a[232:235], v[50:53], v[104:107]
    ds_read_b128 v[46:49], v1 offset:62464
    ds_read_b32 v16, v31 offset:512
    ds_read_b32 v6, v31 offset:192
    ds_read_b128 v[26:29], v32 offset:512
    ds_read_b128 v[22:25], v32 offset:192
    buffer_load_dwordx4 v8, s[20:23], s58 offen lds
    v_cvt_pk_bf16_f32 v94, v120, v121
    v_cvt_pk_bf16_f32 v95, v122, v123
    v_mfma_f32_16x16x32_bf16 v[108:111], v[50:53], v[168:171], v[108:111]
    s_waitcnt lgkmcnt(6)
    v_mfma_f32_16x16x32_bf16 v[104:107], a[236:239], v[58:61], v[104:107]
    ds_read_b128 v[50:53], v1 offset:63488
    v_mfma_f32_16x16x32_bf16 v[112:115], v[10:13], v[92:95], 0
    s_add_u32 m0, s69, 122880
    v_mfma_f32_16x16x32_bf16 v[108:111], v[58:61], v[172:175], v[108:111]
    s_waitcnt lgkmcnt(6)
    v_mfma_f32_16x16x32_bf16 v[104:107], a[240:243], v[42:45], v[104:107]
    ds_read_b128 v[58:61], v1 offset:64512
    buffer_load_dwordx4 v7, s[20:23], s59 offen lds
    v_mfma_f32_16x16x32_bf16 v[108:111], v[42:45], v[176:179], v[108:111]
    s_waitcnt lgkmcnt(6)
    v_mfma_f32_16x16x32_bf16 v[104:107], a[244:247], v[46:49], v[104:107]
    s_add_u32 m0, s69, 126976
    v_rcp_f32 v54, v112
    v_rcp_f32 v55, v113
    v_mul_f32 v116, v54, v116
    v_mul_f32 v117, v54, v117
    v_mul_f32 v118, v54, v118
    v_mul_f32 v119, v54, v119
    v_mul_f32 v120, v55, v120
    v_mul_f32 v121, v55, v121
    v_mul_f32 v122, v55, v122
    v_mul_f32 v123, v55, v123
    v_cvt_pk_bf16_f32 v92, v116, v117
    v_cvt_pk_bf16_f32 v93, v118, v119
    v_mfma_f32_16x16x32_bf16 v[108:111], v[46:49], v[180:183], v[108:111]
    s_waitcnt lgkmcnt(1)
    v_cvt_pk_bf16_f32 v94, v120, v121
    v_cvt_pk_bf16_f32 v95, v122, v123
    v_mfma_f32_16x16x16_bf16 v[116:119], v[92:93], v[14:15], 0
    buffer_load_dwordx4 v8, s[20:23], s59 offen lds
    v_mfma_f32_16x16x16_bf16 v[120:123], v[94:95], v[14:15], 0
    v_mfma_f32_16x16x32_bf16 v[104:107], a[248:251], v[50:53], v[104:107]
    v_mfma_f32_16x16x32_bf16 v[108:111], v[50:53], v[184:187], v[108:111]
    s_waitcnt lgkmcnt(0)
    v_mfma_f32_16x16x32_bf16 v[104:107], a[252:255], v[58:61], v[104:107]
    v_mfma_f32_16x16x32_bf16 v[108:111], v[58:61], v[188:191], v[108:111]
    s_nop 0
    v_cvt_pk_bf16_f32 v80, v116, v117
    v_cvt_pk_bf16_f32 v81, v118, v119
    v_cvt_pk_bf16_f32 v84, v120, v121
    v_cvt_pk_bf16_f32 v85, v122, v123
    s_nop 1
    v_pk_fma_f32 v[104:105], v[16:17], v[36:37], v[104:105] op_sel_hi:[0,1,1]
    v_pk_fma_f32 v[106:107], v[16:17], v[38:39], v[106:107] op_sel_hi:[0,1,1]
    v_cvt_pk_bf16_f32 v34, v104, v105
    v_cvt_pk_bf16_f32 v35, v106, v107
    v_mul_f32 v56, 0x3fb8aa3b, v6
    v_pk_fma_f32 v[108:109], v[26:27], v[40:41], v[108:109] op_sel_hi:[1,0,1]
    v_mfma_f32_16x16x16_bf16 v[112:115], v[18:19], v[34:35], 0
    v_pk_fma_f32 v[110:111], v[28:29], v[40:41], v[110:111] op_sel_hi:[1,0,1]
    v_pk_mul_f32 v[108:109], v[22:23], v[108:109]
    v_pk_mul_f32 v[110:111], v[24:25], v[110:111]
    v_cvt_pk_bf16_f32 v90, v108, v109
    v_cvt_pk_bf16_f32 v91, v110, v111
    s_nop 2
    v_max3_f32 v54, v112, v113, v114
    v_max3_f32 v55, -v112, -v113, -v114
    v_max_f32 v54, v54, v115
    v_max_f32_e64 v55, v55, -v115
    s_nop 1
    v_permlane32_swap_b32 v54, v55
    v_max_f32 v54, v54, v55
    v_mov_b32 v55, v54
    s_nop 1
    v_permlane16_swap_b32 v54, v55
    v_max_f32 v54, v54, v55
    v_mov_b32 v55, v54
    s_nop 1
    v_permlane32_swap_b32 v54, v55
    v_mul_f32_e64 v54, -v54, v56
    v_mul_f32_e64 v55, -v55, v56
    v_pk_fma_f32 v[116:117], v[112:113], v[56:57], v[54:55] op_sel_hi:[1,0,0]
    v_pk_fma_f32 v[118:119], v[114:115], v[56:57], v[54:55] op_sel_hi:[1,0,0]
    v_pk_fma_f32 v[120:121], v[112:113], v[56:57], v[54:55] op_sel:[0,0,1] op_sel_hi:[1,0,1] neg_lo:[1,0,0] neg_hi:[1,0,0]
    v_pk_fma_f32 v[122:123], v[114:115], v[56:57], v[54:55] op_sel:[0,0,1] op_sel_hi:[1,0,1] neg_lo:[1,0,0] neg_hi:[1,0,0]
    v_exp_f32 v116, v116
    v_exp_f32 v117, v117
    v_exp_f32 v118, v118
    v_exp_f32 v119, v119
    v_exp_f32 v120, v120
    v_exp_f32 v121, v121
    v_exp_f32 v122, v122
    v_exp_f32 v123, v123
    v_cvt_pk_bf16_f32 v92, v116, v117
    v_cvt_pk_bf16_f32 v93, v118, v119
    v_cvt_pk_bf16_f32 v94, v120, v121
    v_cvt_pk_bf16_f32 v95, v122, v123
    s_nop 1
    v_mfma_f32_16x16x32_bf16 v[112:115], v[10:13], v[92:95], 0
    s_nop 7
    v_rcp_f32 v54, v112
    v_rcp_f32 v55, v113
    s_nop 0
    v_pk_mul_f32 v[116:117], v[54:55], v[116:117] op_sel:[0,0] op_sel_hi:[0,1]
    v_pk_mul_f32 v[118:119], v[54:55], v[118:119] op_sel:[0,0] op_sel_hi:[0,1]
    v_pk_mul_f32 v[120:121], v[54:55], v[120:121] op_sel:[1,0] op_sel_hi:[1,1]
    v_pk_mul_f32 v[122:123], v[54:55], v[122:123] op_sel:[1,0] op_sel_hi:[1,1]
    v_cvt_pk_bf16_f32 v92, v116, v117
    v_cvt_pk_bf16_f32 v93, v118, v119
    v_cvt_pk_bf16_f32 v94, v120, v121
    v_cvt_pk_bf16_f32 v95, v122, v123
    v_mfma_f32_16x16x16_bf16 v[116:119], v[92:93], v[14:15], 0
    s_nop 0
    v_mfma_f32_16x16x16_bf16 v[120:123], v[94:95], v[14:15], 0
    s_nop 5
    v_cvt_pk_bf16_f32 v82, v116, v117
    v_cvt_pk_bf16_f32 v83, v118, v119
    v_cvt_pk_bf16_f32 v86, v120, v121
    v_cvt_pk_bf16_f32 v87, v122, v123
    v_mfma_f32_16x16x32_bf16 v[72:75], v[80:83], v[2:5], v[72:75]
    v_mfma_f32_16x16x32_bf16 v[64:67], v[80:83], v[88:91], v[64:67]
    v_mfma_f32_16x16x32_bf16 v[76:79], v[84:87], v[2:5], v[76:79]
    v_mfma_f32_16x16x32_bf16 v[68:71], v[84:87], v[88:91], v[68:71]
    s_waitcnt vmcnt(16)
    v_cmp_ne_u32 vcc, s46, v125
    s_nop 0
    s_cbranch_vccnz L_spin_17
L_ok_18:
    s_nop 1
    v_cvt_pk_bf16_f32 v22, v64, v65
    v_cvt_pk_bf16_f32 v23, v66, v67
    v_cvt_pk_bf16_f32 v24, v68, v69
    v_cvt_pk_bf16_f32 v25, v70, v71
    s_cmp_eq_u32 s47, 0
    s_cbranch_scc1 L_slow_19
    buffer_store_dwordx4 v[72:75], v0, s[32:35], s88 offen offset:1024
    buffer_store_dwordx4 v[76:79], v0, s[32:35], s88 offen offset:1040
    buffer_store_dwordx4 v[22:25], v1, s[32:35], s88 offen
L_back_20:
    v_lshrrev_b32 v14, 8, v1
    v_and_b32 v30, 0xf0, v1
    v_mul_u32_u24 v26, 1152, v14
    v_add_u32 v21, v30, v26
    v_bfe_u32 v33, v1, 4, 3
    v_lshlrev_b32 v28, 2, v33
    v_add_u32 v26, v26, v28
    v_bfe_u32 v15, v1, 7, 1
    v_cmp_eq_u32 s[4:5], 0, v15
    v_mov_b32 v15, 0x3f80
    v_cmp_eq_u32 vcc, 0, v33
    v_cmp_eq_u32 s[6:7], 1, v33
    s_nop 0
    v_cndmask_b32 v80, 0, v15, vcc
    v_cndmask_b32 v80, v80, 1.0, s[6:7]
    v_cndmask_b32 v36, 0, v80, s[4:5]
    v_cndmask_b32 v80, v80, 0, s[4:5]
    v_cmp_eq_u32 vcc, 2, v33
    v_cmp_eq_u32 s[6:7], 3, v33
    s_nop 0
    v_cndmask_b32 v81, 0, v15, vcc
    v_cndmask_b32 v81, v81, 1.0, s[6:7]
    v_cndmask_b32 v37, 0, v81, s[4:5]
    v_cndmask_b32 v81, v81, 0, s[4:5]
    v_cmp_eq_u32 vcc, 4, v33
    v_cmp_eq_u32 s[6:7], 5, v33
    s_nop 0
    v_cndmask_b32 v82, 0, v15, vcc
    v_cndmask_b32 v82, v82, 1.0, s[6:7]
    v_cndmask_b32 v38, 0, v82, s[4:5]
    v_cndmask_b32 v82, v82, 0, s[4:5]
    v_cmp_eq_u32 vcc, 6, v33
    v_cmp_eq_u32 s[6:7], 7, v33
    s_nop 0
    v_cndmask_b32 v83, 0, v15, vcc
    v_cndmask_b32 v83, v83, 1.0, s[6:7]
    v_cndmask_b32 v39, 0, v83, s[4:5]
    v_cndmask_b32 v83, v83, 0, s[4:5]
    v_lshl_add_u32 v27, v14, 9, v30
    v_lshrrev_b32 v15, 1, v14
    v_lshl_add_u32 v27, v15, 30, v27
    v_mul_u32_u24 v29, 1280, v33
    v_lshl_add_u32 v29, v14, 5, v29
    v_bfe_u32 v33, v1, 7, 1
    v_lshl_add_u32 v29, v33, 4, v29
    v_mul_u32_u24 v33, 1280, v14
    v_add_u32 v30, v30, v33
    s_mov_b32 s89, 0x4000
    s_nop 1
L_s1_21:
    buffer_load_dwordx4 v[22:25], v21, s[32:35], s81 offen sc1
    buffer_load_dword v14, v26, s[32:35], s82 offen offset:1024 sc1
    s_sub_u32 s89, s89, 1
    s_cmp_gt_i32 s89, 0
    s_cselect_b64 s[94:95], -1, 0
    s_waitcnt vmcnt(1)
    v_mfma_f32_16x16x32_bf16 v[72:75], v[36:39], v[22:25], 0
    s_waitcnt vmcnt(0)
    v_mov_b32 v15, v14
    s_nop 1
    v_permlane32_swap_b32 v14, v15
    v_add_f32 v14, v14, v15
    v_mov_b32 v15, v14
    s_nop 1
    v_permlane16_swap_b32 v14, v15
    v_add_f32 v14, v14, v15
    v_add_f32 v15, v14, v72
    v_cmp_u_f32 vcc, v15, v15
    v_cvt_pk_bf16_f32 v22, v72, v73
    v_cvt_pk_bf16_f32 v23, v74, v75
    s_and_b64 vcc, vcc, s[94:95]
    s_cbranch_scc1 L_s1_21
    buffer_store_dwordx2 v[22:23], v27, s[32:35], s83 offen sc1
    buffer_store_dword v14, v28, s[32:35], s84 offen offset:1024 sc1
    ds_read_b128 v[42:45], v1 offset:0
    ds_read_b128 v[46:49], v1 offset:1024
    ds_read_b128 v[50:53], v1 offset:2048
    ds_read_b128 v[58:61], v1 offset:3072
    ds_read_b128 v[64:67], v1 offset:4096
    s_barrier
    ds_read_b64_tr_b16 v[192:193], v17 offset:0
    ds_read_b64_tr_b16 v[194:195], v17 offset:512
    ds_read_b64_tr_b16 v[196:197], v17 offset:4096
    ds_read_b64_tr_b16 v[198:199], v17 offset:4608
    ds_read_b64_tr_b16 v[200:201], v17 offset:8192
    ds_read_b64_tr_b16 v[202:203], v17 offset:8704
    ds_read_b64_tr_b16 v[204:205], v17 offset:12288
    ds_read_b64_tr_b16 v[206:207], v17 offset:12800
    ds_read_b64_tr_b16 v[208:209], v17 offset:16384
    ds_read_b64_tr_b16 v[210:211], v17 offset:16896
    ds_read_b64_tr_b16 v[212:213], v17 offset:20480
    ds_read_b64_tr_b16 v[214:215], v17 offset:20992
    ds_read_b64_tr_b16 v[216:217], v17 offset:24576
    ds_read_b64_tr_b16 v[218:219], v17 offset:25088
    ds_read_b64_tr_b16 v[220:221], v17 offset:28672
    ds_read_b64_tr_b16 v[222:223], v17 offset:29184
    ds_read_b64_tr_b16 v[224:225], v17 offset:32768
    ds_read_b64_tr_b16 v[226:227], v17 offset:33280
    ds_read_b64_tr_b16 v[228:229], v17 offset:36864
    ds_read_b64_tr_b16 v[230:231], v17 offset:37376
    ds_read_b64_tr_b16 v[232:233], v17 offset:40960
    ds_read_b64_tr_b16 v[234:235], v17 offset:41472
    ds_read_b64_tr_b16 v[236:237], v17 offset:45056
    ds_read_b64_tr_b16 v[238:239], v17 offset:45568
    ds_read_b64_tr_b16 v[240:241], v17 offset:49152
    ds_read_b64_tr_b16 v[242:243], v17 offset:49664
    ds_read_b64_tr_b16 v[244:245], v17 offset:53248
    ds_read_b64_tr_b16 v[246:247], v17 offset:53760
    ds_read_b64_tr_b16 v[248:249], v17 offset:57344
    ds_read_b64_tr_b16 v[250:251], v17 offset:57856
    ds_read_b64_tr_b16 v[252:253], v17 offset:61440
    ds_read_b64_tr_b16 v[254:255], v17 offset:61952
    s_waitcnt lgkmcnt(15)
    v_mfma_f32_16x16x32_bf16 v[76:79], v[192:195], v[2:5], 0
    v_mfma_f32_16x16x32_bf16 v[76:79], v[196:199], v[2:5], v[76:79]
    v_mfma_f32_16x16x32_bf16 v[76:79], v[200:203], v[2:5], v[76:79]
    v_mfma_f32_16x16x32_bf16 v[76:79], v[204:207], v[2:5], v[76:79]
    v_mfma_f32_16x16x32_bf16 v[76:79], v[208:211], v[2:5], v[76:79]
    v_mfma_f32_16x16x32_bf16 v[76:79], v[212:215], v[2:5], v[76:79]
    v_mfma_f32_16x16x32_bf16 v[76:79], v[216:219], v[2:5], v[76:79]
    v_mfma_f32_16x16x32_bf16 v[76:79], v[220:223], v[2:5], v[76:79]
    s_waitcnt lgkmcnt(14)
    v_mfma_f32_16x16x32_bf16 v[76:79], v[224:227], v[2:5], v[76:79]
    s_waitcnt lgkmcnt(12)
    v_mfma_f32_16x16x32_bf16 v[76:79], v[228:231], v[2:5], v[76:79]
    s_waitcnt lgkmcnt(10)
    v_mfma_f32_16x16x32_bf16 v[76:79], v[232:235], v[2:5], v[76:79]
    s_waitcnt lgkmcnt(8)
    v_mfma_f32_16x16x32_bf16 v[76:79], v[236:239], v[2:5], v[76:79]
    s_waitcnt lgkmcnt(6)
    v_mfma_f32_16x16x32_bf16 v[76:79], v[240:243], v[2:5], v[76:79]
    s_waitcnt lgkmcnt(4)
    v_mfma_f32_16x16x32_bf16 v[76:79], v[244:247], v[2:5], v[76:79]
    s_waitcnt lgkmcnt(2)
    v_mfma_f32_16x16x32_bf16 v[76:79], v[248:251], v[2:5], v[76:79]
    s_waitcnt lgkmcnt(0)
    v_mfma_f32_16x16x32_bf16 v[76:79], v[252:255], v[2:5], v[76:79]
    s_mul_i32 s80, s40, 192
    s_add_u32 s80, s80, 157440
    v_lshrrev_b32 v0, 8, v1
    v_lshl_add_u32 v0, v0, 4, s80
    v_bfe_u32 v14, v1, 4, 4
    v_lshl_add_u32 v14, v14, 2, s80
    s_nop 1
    ds_write_b128 v0, v[76:79] offset:0
    s_mul_i32 s80, s40, 192
    s_add_u32 s80, s80, 157440
    v_lshrrev_b32 v0, 8, v1
    v_lshl_add_u32 v0, v0, 4, s80
    v_bfe_u32 v14, v1, 4, 4
    v_lshl_add_u32 v14, v14, 2, s80
    ds_read_b128 v[76:79], v0 offset:0
    s_waitcnt lgkmcnt(0)
    s_barrier
    v_mfma_f32_16x16x32_bf16 v[96:99], v[192:195], v[42:45], 0
    ds_read_b128 v[68:71], v1 offset:5120
    v_mfma_f32_16x16x32_bf16 v[96:99], v[196:199], v[46:49], v[96:99]
    ds_read_b128 v[42:45], v1 offset:6144
    s_xor_b32 m0, s70, 0
    v_mfma_f32_16x16x32_bf16 v[96:99], v[200:203], v[50:53], v[96:99]
    ds_read_b128 v[46:49], v1 offset:7168
    ds_read_b32 v16, v31 offset:320
    ds_read_b32 v6, v31 offset:0
    s_xor_b32 s92, s71, 0
    v_mfma_f32_16x16x32_bf16 v[96:99], v[204:207], v[58:61], v[96:99]
    ds_read_b128 v[50:53], v1 offset:8192
    buffer_load_dwordx4 v20, s[24:27], s92 offen lds
    s_waitcnt lgkmcnt(5)
    v_mfma_f32_16x16x32_bf16 v[96:99], v[208:211], v[64:67], v[96:99]
    ds_read_b128 v[58:61], v1 offset:9216
    v_mfma_f32_16x16x32_bf16 v[96:99], v[212:215], v[68:71], v[96:99]
    ds_read_b128 v[64:67], v1 offset:10240
    s_xor_b32 m0, s70, 4096
    s_waitcnt lgkmcnt(5)
    v_mfma_f32_16x16x32_bf16 v[96:99], v[216:219], v[42:45], v[96:99]
    ds_read_b128 v[68:71], v1 offset:11264
    s_xor_b32 s92, s71, 32768
    v_mfma_f32_16x16x32_bf16 v[96:99], v[220:223], v[46:49], v[96:99]
    ds_read_b128 v[42:45], v1 offset:12288
    buffer_load_dwordx4 v20, s[24:27], s92 offen lds
    s_waitcnt lgkmcnt(3)
    v_mfma_f32_16x16x32_bf16 v[96:99], v[224:227], v[50:53], v[96:99]
    ds_read_b128 v[46:49], v1 offset:13312
    s_xor_b32 m0, s70, 8192
    v_mfma_f32_16x16x32_bf16 v[96:99], v[228:231], v[58:61], v[96:99]
    ds_read_b128 v[50:53], v1 offset:14336
    s_xor_b32 s92, s71, 65536
    s_waitcnt lgkmcnt(3)
    v_mfma_f32_16x16x32_bf16 v[96:99], v[232:235], v[64:67], v[96:99]
    ds_read_b128 v[58:61], v1 offset:15360
    buffer_load_dwordx4 v20, s[24:27], s92 offen lds
    v_mfma_f32_16x16x32_bf16 v[96:99], v[236:239], v[68:71], v[96:99]
    ds_read_b128 v[64:67], v1 offset:16384
    s_waitcnt lgkmcnt(3)
    v_mfma_f32_16x16x32_bf16 v[96:99], v[240:243], v[42:45], v[96:99]
    ds_read_b128 v[68:71], v1 offset:17408
    s_xor_b32 m0, s70, 12288
    v_mfma_f32_16x16x32_bf16 v[96:99], v[244:247], v[46:49], v[96:99]
    ds_read_b128 v[42:45], v1 offset:18432
    s_xor_b32 s92, s71, 98304
    s_waitcnt lgkmcnt(3)
    v_mfma_f32_16x16x32_bf16 v[96:99], v[248:251], v[50:53], v[96:99]
    ds_read_b128 v[46:49], v1 offset:19456
    buffer_load_dwordx4 v20, s[24:27], s92 offen lds
    v_mfma_f32_16x16x32_bf16 v[96:99], v[252:255], v[58:61], v[96:99]
    ds_read_b128 v[50:53], v1 offset:20480
    s_waitcnt lgkmcnt(3)
    v_mfma_f32_16x16x32_bf16 v[104:107], v[192:195], v[64:67], 0
    ds_read_b128 v[58:61], v1 offset:21504
    s_xor_b32 m0, s70, 16384
    v_mfma_f32_16x16x32_bf16 v[104:107], v[196:199], v[68:71], v[104:107]
    ds_read_b128 v[64:67], v1 offset:22528
    ds_read_b32 v26, v31 offset:384
    s_xor_b32 s92, s71, 131072
    v_fma_f32 v96, v16, v76, v96
    v_fma_f32 v97, v16, v77, v97
    v_fma_f32 v98, v16, v78, v98
    v_fma_f32 v99, v16, v79, v99
    v_cvt_pk_bf16_f32 v34, v96, v97
    s_waitcnt lgkmcnt(4)
    v_mfma_f32_16x16x32_bf16 v[104:107], v[200:203], v[42:45], v[104:107]
    ds_read_b128 v[68:71], v1 offset:23552
    buffer_load_dwordx4 v20, s[24:27], s92 offen lds
    ds_read_b32 v14, v31 offset:64
    v_cvt_pk_bf16_f32 v35, v98, v99
    v_mul_f32 v56, 0x3fb8aa3b, v6
    v_mfma_f32_16x16x32_bf16 v[104:107], v[204:207], v[46:49], v[104:107]
    ds_read_b128 v[42:45], v1 offset:24576
    s_waitcnt lgkmcnt(5)
    v_mfma_f32_16x16x16_bf16 v[112:115], v[18:19], v[34:35], 0
    s_xor_b32 m0, s70, 20480
    v_mfma_f32_16x16x32_bf16 v[104:107], v[208:211], v[50:53], v[104:107]
    ds_read_b128 v[46:49], v1 offset:25600
    v_mfma_f32_16x16x32_bf16 v[104:107], v[212:215], v[58:61], v[104:107]
    ds_read_b128 v[50:53], v1 offset:26624
    s_xor_b32 s92, s71, 163840
    s_waitcnt lgkmcnt(4)
    v_mfma_f32_16x16x32_bf16 v[104:107], v[216:219], v[64:67], v[104:107]
    ds_read_b128 v[58:61], v1 offset:27648
    buffer_load_dwordx4 v20, s[24:27], s92 offen lds
    v_max3_f32 v54, v112, v113, v114
    v_max3_f32 v55, -v112, -v113, -v114
    v_max_f32 v54, v54, v115
    v_max_f32_e64 v55, v55, -v115
    v_mfma_f32_16x16x32_bf16 v[104:107], v[220:223], v[68:71], v[104:107]
    ds_read_b128 v[64:67], v1 offset:28672
    v_permlane32_swap_b32 v54, v55
    v_max_f32 v54, v54, v55
    v_mov_b32 v55, v54
    s_xor_b32 m0, s70, 24576
    s_waitcnt lgkmcnt(3)
    v_mfma_f32_16x16x32_bf16 v[104:107], v[224:227], v[42:45], v[104:107]
    ds_read_b128 v[68:71], v1 offset:29696
    v_permlane16_swap_b32 v54, v55
    s_xor_b32 s92, s71, 196608
    v_mfma_f32_16x16x32_bf16 v[104:107], v[228:231], v[46:49], v[104:107]
    ds_read_b128 v[42:45], v1 offset:30720
    s_waitcnt lgkmcnt(3)
    v_max_f32 v54, v54, v55
    v_mov_b32 v55, v54
    v_mfma_f32_16x16x32_bf16 v[104:107], v[232:235], v[50:53], v[104:107]
    ds_read_b128 v[46:49], v1 offset:31744
    buffer_load_dwordx4 v20, s[24:27], s92 offen lds
    v_permlane32_swap_b32 v54, v55
    v_mfma_f32_16x16x32_bf16 v[104:107], v[236:239], v[58:61], v[104:107]
    ds_read_b128 v[50:53], v1 offset:32768
    v_mul_f32_e64 v54, -v54, v56
    v_mul_f32_e64 v55, -v55, v56
    s_xor_b32 m0, s70, 28672
    s_waitcnt lgkmcnt(3)
    v_mfma_f32_16x16x32_bf16 v[104:107], v[240:243], v[64:67], v[104:107]
    ds_read_b128 v[58:61], v1 offset:33792
    v_fma_f32 v116, v112, v56, v54
    v_fma_f32 v117, v113, v56, v54
    s_xor_b32 s92, s71, 229376
    v_mfma_f32_16x16x32_bf16 v[104:107], v[244:247], v[68:71], v[104:107]
    ds_read_b128 v[64:67], v1 offset:34816
    buffer_load_dwordx4 v20, s[24:27], s92 offen lds
    v_fma_f32 v118, v114, v56, v54
    v_fma_f32 v119, v115, v56, v54
    s_waitcnt lgkmcnt(3)
    v_mfma_f32_16x16x32_bf16 v[104:107], v[248:251], v[42:45], v[104:107]
    ds_read_b128 v[68:71], v1 offset:35840
    v_fma_f32 v120, -v112, v56, v55
    v_fma_f32 v121, -v113, v56, v55
    v_mfma_f32_16x16x32_bf16 v[104:107], v[252:255], v[46:49], v[104:107]
    ds_read_b128 v[42:45], v1 offset:36864
    v_fma_f32 v122, -v114, v56, v55
    v_fma_f32 v123, -v115, v56, v55
    s_xor_b32 m0, s70, 32768
    s_waitcnt lgkmcnt(3)
    v_mfma_f32_16x16x32_bf16 v[100:103], v[192:195], v[50:53], 0
    ds_read_b128 v[46:49], v1 offset:37888
    v_exp_f32 v116, v116
    s_xor_b32 s92, s71, 262144
    v_fma_f32 v104, v26, v76, v104
    v_fma_f32 v105, v26, v77, v105
    v_fma_f32 v106, v26, v78, v106
    v_mfma_f32_16x16x32_bf16 v[100:103], v[196:199], v[58:61], v[100:103]
    ds_read_b128 v[50:53], v1 offset:38912
    buffer_load_dwordx4 v20, s[24:27], s92 offen lds
    v_exp_f32 v117, v117
    v_fma_f32 v107, v26, v79, v107
    v_cvt_pk_bf16_f32 v2, v104, v105
    s_waitcnt lgkmcnt(3)
    v_mfma_f32_16x16x32_bf16 v[100:103], v[200:203], v[64:67], v[100:103]
    ds_read_b128 v[58:61], v1 offset:39936
    v_exp_f32 v118, v118
    v_cvt_pk_bf16_f32 v3, v106, v107
    v_mul_f32 v0, 0x3fb8aa3b, v14
    v_mfma_f32_16x16x32_bf16 v[100:103], v[204:207], v[68:71], v[100:103]
    ds_read_b128 v[64:67], v1 offset:40960
    s_waitcnt lgkmcnt(3)
    v_mfma_f32_16x16x16_bf16 v[84:87], v[18:19], v[2:3], 0
    s_xor_b32 m0, s70, 36864
    v_exp_f32 v119, v119
    v_mfma_f32_16x16x32_bf16 v[100:103], v[208:211], v[42:45], v[100:103]
    ds_read_b128 v[68:71], v1 offset:41984
    v_exp_f32 v120, v120
    s_xor_b32 s92, s71, 294912
    v_mfma_f32_16x16x32_bf16 v[100:103], v[212:215], v[46:49], v[100:103]
    ds_read_b128 v[42:45], v1 offset:43008
    buffer_load_dwordx4 v20, s[24:27], s92 offen lds
    v_exp_f32 v121, v121
    v_max3_f32 v4, v84, v85, v86
    v_max3_f32 v5, -v84, -v85, -v86
    v_max_f32 v4, v4, v87
    v_max_f32_e64 v5, v5, -v87
    s_waitcnt lgkmcnt(3)
    v_mfma_f32_16x16x32_bf16 v[100:103], v[216:219], v[50:53], v[100:103]
    ds_read_b128 v[46:49], v1 offset:44032
    v_exp_f32 v122, v122
    v_permlane32_swap_b32 v4, v5
    s_xor_b32 m0, s70, 40960
    v_mfma_f32_16x16x32_bf16 v[100:103], v[220:223], v[58:61], v[100:103]
    ds_read_b128 v[50:53], v1 offset:45056
    s_waitcnt lgkmcnt(3)
    v_exp_f32 v123, v123
    v_max_f32 v4, v4, v5
    v_mov_b32 v5, v4
    s_xor_b32 s92, s71, 327680
    v_mfma_f32_16x16x32_bf16 v[100:103], v[224:227], v[64:67], v[100:103]
    ds_read_b128 v[58:61], v1 offset:46080
    buffer_load_dwordx4 v20, s[24:27], s92 offen lds
    v_cvt_pk_bf16_f32 v96, v116, v117
    v_cvt_pk_bf16_f32 v97, v118, v119
    v_permlane16_swap_b32 v4, v5
    v_mfma_f32_16x16x32_bf16 v[100:103], v[228:231], v[68:71], v[100:103]
    ds_read_b128 v[64:67], v1 offset:47104
    s_waitcnt lgkmcnt(3)
    v_cvt_pk_bf16_f32 v98, v120, v121
    v_cvt_pk_bf16_f32 v99, v122, v123
    v_max_f32 v4, v4, v5
    v_mov_b32 v5, v4
    v_mfma_f32_16x16x32_bf16 v[112:115], v[10:13], v[96:99], 0
    s_xor_b32 m0, s70, 45056
    v_permlane32_swap_b32 v4, v5
    v_mfma_f32_16x16x32_bf16 v[100:103], v[232:235], v[42:45], v[100:103]
    ds_read_b128 v[68:71], v1 offset:48128
    v_mul_f32_e64 v4, -v4, v0
    v_mfma_f32_16x16x32_bf16 v[100:103], v[236:239], v[46:49], v[100:103]
    ds_read_b128 v[42:45], v1 offset:49152
    s_waitcnt lgkmcnt(3)
    v_mul_f32_e64 v5, -v5, v0
    v_rcp_f32 v55, v113
    s_xor_b32 s92, s71, 360448
    v_mfma_f32_16x16x32_bf16 v[100:103], v[240:243], v[50:53], v[100:103]
    ds_read_b128 v[46:49], v1 offset:50176
    buffer_load_dwordx4 v20, s[24:27], s92 offen lds
    v_mul_f32 v15, 0x358637bd, v112
    v_mul_f32 v55, v112, v55
    v_fma_f32 v88, v84, v0, v4
    v_fma_f32 v89, v85, v0, v4
    v_mfma_f32_16x16x32_bf16 v[100:103], v[244:247], v[58:61], v[100:103]
    ds_read_b128 v[50:53], v1 offset:51200
    v_mul_f32 v120, v55, v120
    v_mul_f32 v121, v55, v121
    v_fma_f32 v90, v86, v0, v4
    v_fma_f32 v91, v87, v0, v4
    s_waitcnt lgkmcnt(3)
    v_mfma_f32_16x16x32_bf16 v[100:103], v[248:251], v[64:67], v[100:103]
    ds_read_b128 v[58:61], v1 offset:52224
    v_mul_f32 v122, v55, v122
    v_mul_f32 v123, v55, v123
    v_fma_f32 v92, -v84, v0, v5
    v_fma_f32 v93, -v85, v0, v5
    s_xor_b32 m0, s70, 49152
    v_mfma_f32_16x16x32_bf16 v[100:103], v[252:255], v[68:71], v[100:103]
    ds_read_b128 v[64:67], v1 offset:53248
    s_waitcnt lgkmcnt(3)
    v_cvt_pk_bf16_f32 v98, v120, v121
    v_cvt_pk_bf16_f32 v99, v122, v123
    v_fma_f32 v94, -v86, v0, v5
    v_fma_f32 v95, -v87, v0, v5
    s_xor_b32 s92, s71, 393216
    ds_read_b32 v16, v31 offset:448
    buffer_load_dwordx4 v20, s[24:27], s92 offen lds
    ds_read_b32 v6, v31 offset:128
    v_mfma_f32_16x16x32_bf16 v[108:111], v[192:195], v[42:45], 0
    ds_read_b128 v[68:71], v1 offset:54272
    v_exp_f32 v88, v88
    v_mfma_f32_16x16x32_bf16 v[108:111], v[196:199], v[46:49], v[108:111]
    ds_read_b128 v[42:45], v1 offset:55296
    s_waitcnt lgkmcnt(5)
    v_exp_f32 v89, v89
    v_mfma_f32_16x16x32_bf16 v[108:111], v[200:203], v[50:53], v[108:111]
    ds_read_b128 v[46:49], v1 offset:56320
    v_exp_f32 v90, v90
    s_xor_b32 m0, s70, 53248
    s_waitcnt lgkmcnt(4)
    v_fma_f32 v100, v16, v76, v100
    v_fma_f32 v101, v16, v77, v101
    v_fma_f32 v102, v16, v78, v102
    v_fma_f32 v103, v16, v79, v103
    v_cvt_pk_bf16_f32 v34, v100, v101
    v_cvt_pk_bf16_f32 v35, v102, v103
    s_waitcnt lgkmcnt(3)
    v_mul_f32 v56, 0x3fb8aa3b, v6
    v_mfma_f32_16x16x32_bf16 v[108:111], v[204:207], v[58:61], v[108:111]
    ds_read_b128 v[50:53], v1 offset:57344
    s_waitcnt lgkmcnt(3)
    v_mfma_f32_16x16x16_bf16 v[112:115], v[18:19], v[34:35], 0
    s_xor_b32 s92, s71, 425984
    v_exp_f32 v91, v91
    v_mfma_f32_16x16x32_bf16 v[108:111], v[208:211], v[64:67], v[108:111]
    ds_read_b128 v[58:61], v1 offset:58368
    buffer_load_dwordx4 v20, s[24:27], s92 offen lds
    v_exp_f32 v92, v92
    v_mfma_f32_16x16x32_bf16 v[108:111], v[212:215], v[68:71], v[108:111]
    ds_read_b128 v[64:67], v1 offset:59392
    s_waitcnt lgkmcnt(3)
    v_max3_f32 v54, v112, v113, v114
    v_max3_f32 v55, -v112, -v113, -v114
    v_max_f32 v54, v54, v115
    v_max_f32_e64 v55, v55, -v115
    v_exp_f32 v93, v93
    s_xor_b32 m0, s70, 57344
    v_mfma_f32_16x16x32_bf16 v[108:111], v[216:219], v[42:45], v[108:111]
    ds_read_b128 v[68:71], v1 offset:60416
    v_permlane32_swap_b32 v54, v55
    v_exp_f32 v94, v94
    s_xor_b32 s92, s71, 458752
    v_mfma_f32_16x16x32_bf16 v[108:111], v[220:223], v[46:49], v[108:111]
    ds_read_b128 v[42:45], v1 offset:61440
    s_waitcnt lgkmcnt(3)
    v_max_f32 v54, v54, v55
    v_mov_b32 v55, v54
    v_exp_f32 v95, v95
    v_mfma_f32_16x16x32_bf16 v[108:111], v[224:227], v[50:53], v[108:111]
    ds_read_b128 v[46:49], v1 offset:62464
    buffer_load_dwordx4 v20, s[24:27], s92 offen lds
    v_permlane16_swap_b32 v54, v55
    v_cvt_pk_bf16_f32 v104, v88, v89
    v_cvt_pk_bf16_f32 v105, v90, v91
    v_mfma_f32_16x16x32_bf16 v[108:111], v[228:231], v[58:61], v[108:111]
    ds_read_b128 v[50:53], v1 offset:63488
    s_waitcnt lgkmcnt(3)
    v_max_f32 v54, v54, v55
    v_mov_b32 v55, v54
    v_cvt_pk_bf16_f32 v106, v92, v93
    v_cvt_pk_bf16_f32 v107, v94, v95
    s_xor_b32 m0, s70, 61440
    v_mfma_f32_16x16x32_bf16 v[108:111], v[232:235], v[64:67], v[108:111]
    ds_read_b128 v[58:61], v1 offset:64512
    v_mfma_f32_16x16x32_bf16 v[84:87], v[10:13], v[104:107], 0
    s_xor_b32 s92, s71, 491520
    v_permlane32_swap_b32 v54, v55
    v_mfma_f32_16x16x32_bf16 v[108:111], v[236:239], v[68:71], v[108:111]
    s_waitcnt lgkmcnt(2)
    v_mul_f32_e64 v54, -v54, v56
    v_mul_f32_e64 v55, -v55, v56
    v_mfma_f32_16x16x32_bf16 v[108:111], v[240:243], v[42:45], v[108:111]
    buffer_load_dwordx4 v20, s[24:27], s92 offen lds
    v_fma_f32 v116, v112, v56, v54
    v_fma_f32 v117, v113, v56, v54
    v_rcp_f32 v5, v85
    v_mul_f32 v17, 0x358637bd, v84
    v_mul_f32 v5, v84, v5
    v_mfma_f32_16x16x32_bf16 v[108:111], v[244:247], v[46:49], v[108:111]
    v_fma_f32 v118, v114, v56, v54
    v_fma_f32 v119, v115, v56, v54
    v_mul_f32 v92, v5, v92
    v_mul_f32 v93, v5, v93
    s_waitcnt lgkmcnt(0)
    v_mfma_f32_16x16x32_bf16 v[108:111], v[248:251], v[50:53], v[108:111]
    v_fma_f32 v120, -v112, v56, v55
    v_fma_f32 v121, -v113, v56, v55
    v_mul_f32 v94, v5, v94
    v_mul_f32 v95, v5, v95
    v_mfma_f32_16x16x32_bf16 v[108:111], v[252:255], v[58:61], v[108:111]
    v_fma_f32 v122, -v114, v56, v55
    v_fma_f32 v123, -v115, v56, v55
    v_cvt_pk_bf16_f32 v106, v92, v93
    v_cvt_pk_bf16_f32 v107, v94, v95
    ds_read_b32 v26, v31 offset:512
    ds_read_b32 v14, v31 offset:192
    v_exp_f32 v116, v116
    v_exp_f32 v117, v117
    v_exp_f32 v118, v118
    v_exp_f32 v119, v119
    v_exp_f32 v120, v120
    v_exp_f32 v121, v121
    v_exp_f32 v122, v122
    v_exp_f32 v123, v123
    v_cvt_pk_bf16_f32 v100, v116, v117
    v_cvt_pk_bf16_f32 v101, v118, v119
    v_cvt_pk_bf16_f32 v102, v120, v121
    v_cvt_pk_bf16_f32 v103, v122, v123
    s_waitcnt lgkmcnt(1)
    v_pk_fma_f32 v[108:109], v[26:27], v[76:77], v[108:109] op_sel_hi:[0,1,1]
    v_pk_fma_f32 v[110:111], v[26:27], v[78:79], v[110:111] op_sel_hi:[0,1,1]
    v_cvt_pk_bf16_f32 v2, v108, v109
    v_cvt_pk_bf16_f32 v3, v110, v111
    s_waitcnt lgkmcnt(0)
    v_mul_f32 v0, 0x3fb8aa3b, v14
    v_mfma_f32_16x16x32_bf16 v[112:115], v[10:13], v[100:103], 0
    v_mfma_f32_16x16x16_bf16 v[84:87], v[18:19], v[2:3], 0
    s_nop 6
    v_rcp_f32 v55, v113
    v_mul_f32 v21, 0x358637bd, v112
    v_mul_f32 v55, v112, v55
    v_mul_f32 v120, v55, v120
    v_mul_f32 v121, v55, v121
    v_mul_f32 v122, v55, v122
    v_mul_f32 v123, v55, v123
    v_cvt_pk_bf16_f32 v102, v120, v121
    v_max3_f32 v4, v84, v85, v86
    v_max3_f32 v5, -v84, -v85, -v86
    v_max_f32 v4, v4, v87
    v_max_f32_e64 v5, v5, -v87
    v_cvt_pk_bf16_f32 v103, v122, v123
    s_nop 0
    v_permlane32_swap_b32 v4, v5
    v_max_f32 v4, v4, v5
    v_mov_b32 v5, v4
    s_nop 1
    v_permlane16_swap_b32 v4, v5
    v_max_f32 v4, v4, v5
    v_mov_b32 v5, v4
    s_nop 1
    v_permlane32_swap_b32 v4, v5
    v_mul_f32_e64 v4, -v4, v0
    v_mul_f32_e64 v5, -v5, v0
    v_pk_fma_f32 v[88:89], v[84:85], v[0:1], v[4:5] op_sel_hi:[1,0,0]
    v_pk_fma_f32 v[90:91], v[86:87], v[0:1], v[4:5] op_sel_hi:[1,0,0]
    v_pk_fma_f32 v[92:93], v[84:85], v[0:1], v[4:5] op_sel:[0,0,1] op_sel_hi:[1,0,1] neg_lo:[1,0,0] neg_hi:[1,0,0]
    v_pk_fma_f32 v[94:95], v[86:87], v[0:1], v[4:5] op_sel:[0,0,1] op_sel_hi:[1,0,1] neg_lo:[1,0,0] neg_hi:[1,0,0]
    v_exp_f32 v88, v88
    v_exp_f32 v89, v89
    v_exp_f32 v90, v90
    v_exp_f32 v91, v91
    v_exp_f32 v92, v92
    v_exp_f32 v93, v93
    v_exp_f32 v94, v94
    v_exp_f32 v95, v95
    v_cvt_pk_bf16_f32 v108, v88, v89
    v_cvt_pk_bf16_f32 v109, v90, v91
    v_cvt_pk_bf16_f32 v110, v92, v93
    v_cvt_pk_bf16_f32 v111, v94, v95
    s_nop 1
    v_mfma_f32_16x16x32_bf16 v[84:87], v[10:13], v[108:111], 0
    s_nop 7
    v_rcp_f32 v5, v85
    v_mul_f32 v27, 0x358637bd, v84
    v_mul_f32 v5, v84, v5
    v_pk_mul_f32 v[92:93], v[4:5], v[92:93] op_sel:[1,0] op_sel_hi:[1,1]
    v_pk_mul_f32 v[94:95], v[4:5], v[94:95] op_sel:[1,0] op_sel_hi:[1,1]
    v_cvt_pk_bf16_f32 v110, v92, v93
    v_cvt_pk_bf16_f32 v111, v94, v95
    buffer_load_dwordx4 v[124:127], v29, s[32:35], s85 offen offset:1024 sc1
    buffer_load_dwordx4 v[42:45], v30, s[32:35], s85 offen offset:0 sc1
    buffer_load_dwordx4 v[46:49], v30, s[32:35], s86 offen offset:0 sc1
    buffer_load_dwordx4 v[50:53], v30, s[32:35], s85 offen offset:256 sc1
    buffer_load_dwordx4 v[58:61], v30, s[32:35], s86 offen offset:256 sc1
    buffer_load_dwordx4 v[64:67], v30, s[32:35], s85 offen offset:512 sc1
    buffer_load_dwordx4 v[68:71], v30, s[32:35], s86 offen offset:512 sc1
    buffer_load_dwordx4 v[22:25], v30, s[32:35], s85 offen offset:768 sc1
    buffer_load_dwordx4 v[72:75], v30, s[32:35], s86 offen offset:768 sc1
    v_and_b32 v6, 0xf0, v1
    v_lshrrev_b32 v14, 9, v1
    v_lshl_or_b32 v6, v14, 8, v6
    v_bfe_u32 v14, v1, 8, 1
    v_lshl_or_b32 v6, v14, 14, v6
    s_mov_b32 s89, 0x4000
L_s2_22:
    s_sub_u32 s89, s89, 1
    s_cmp_gt_i32 s89, 0
    s_cselect_b64 s[94:95], -1, 0
    s_waitcnt vmcnt(7)
    v_mfma_f32_16x16x32_bf16 v[84:87], v[36:39], v[42:45], 0
    v_add_f32_dpp v124, v124, v124 quad_perm:[1,0,3,2] row_mask:0xf bank_mask:0xf
    v_add_f32_dpp v125, v125, v125 quad_perm:[1,0,3,2] row_mask:0xf bank_mask:0xf
    v_add_f32_dpp v126, v126, v126 quad_perm:[1,0,3,2] row_mask:0xf bank_mask:0xf
    s_waitcnt vmcnt(6)
    v_mfma_f32_16x16x32_bf16 v[84:87], v[36:39], v[46:49], v[84:87]
    v_add_f32_dpp v127, v127, v127 quad_perm:[1,0,3,2] row_mask:0xf bank_mask:0xf
    v_add_f32_dpp v124, v124, v124 quad_perm:[2,3,0,1] row_mask:0xf bank_mask:0xf
    v_add_f32_dpp v125, v125, v125 quad_perm:[2,3,0,1] row_mask:0xf bank_mask:0xf
    s_waitcnt vmcnt(5)
    v_mfma_f32_16x16x32_bf16 v[84:87], v[80:83], v[50:53], v[84:87]
    v_add_f32_dpp v126, v126, v126 quad_perm:[2,3,0,1] row_mask:0xf bank_mask:0xf
    v_add_f32_dpp v127, v127, v127 quad_perm:[2,3,0,1] row_mask:0xf bank_mask:0xf
    v_add_f32_dpp v124, v124, v124 row_half_mirror row_mask:0xf bank_mask:0xf
    s_waitcnt vmcnt(4)
    v_mfma_f32_16x16x32_bf16 v[84:87], v[80:83], v[58:61], v[84:87]
    v_add_f32_dpp v125, v125, v125 row_half_mirror row_mask:0xf bank_mask:0xf
    v_add_f32_dpp v126, v126, v126 row_half_mirror row_mask:0xf bank_mask:0xf
    v_add_f32_dpp v127, v127, v127 row_half_mirror row_mask:0xf bank_mask:0xf
    s_waitcnt vmcnt(3)
    v_mfma_f32_16x16x32_bf16 v[88:91], v[36:39], v[64:67], 0
    v_add_f32 v0, v124, v125
    v_add_f32 v0, v0, v126
    s_waitcnt vmcnt(2)
    v_mfma_f32_16x16x32_bf16 v[88:91], v[36:39], v[68:71], v[88:91]
    v_add_f32 v0, v0, v127
    v_cvt_pk_bf16_f32 v124, v124, v125
    v_cvt_pk_bf16_f32 v125, v126, v127
    s_waitcnt vmcnt(1)
    v_mfma_f32_16x16x32_bf16 v[88:91], v[80:83], v[22:25], v[88:91]
    v_mov_b32_dpp v10, v124 row_newbcast:0 row_mask:0xf bank_mask:0xf
    v_mov_b32_dpp v12, v124 row_newbcast:8 row_mask:0xf bank_mask:0xf
    v_mov_b32_dpp v11, v125 row_newbcast:0 row_mask:0xf bank_mask:0xf
    s_waitcnt vmcnt(0)
    v_mfma_f32_16x16x32_bf16 v[88:91], v[80:83], v[72:75], v[88:91]
    v_mov_b32_dpp v13, v125 row_newbcast:8 row_mask:0xf bank_mask:0xf
    v_add_f32 v0, v0, v84
    v_cvt_pk_bf16_f32 v2, v84, v85
    v_cvt_pk_bf16_f32 v3, v86, v87
    s_nop 3
    v_add_f32 v0, v0, v88
    v_cmp_u_f32 vcc, v0, v0
    v_cvt_pk_bf16_f32 v4, v88, v89
    v_cvt_pk_bf16_f32 v5, v90, v91
    s_and_b64 vcc, vcc, s[94:95]
    s_cbranch_scc1 L_s2r_23
    v_mfma_f32_16x16x32_bf16 v[46:49], v[10:13], v[96:99], 0
    v_mfma_f32_16x16x32_bf16 v[58:61], v[10:13], v[104:107], 0
    v_mfma_f32_16x16x32_bf16 v[68:71], v[10:13], v[100:103], 0
    v_mfma_f32_16x16x32_bf16 v[116:119], v[10:13], v[108:111], 0
    v_mfma_f32_16x16x32_bf16 v[42:45], v[2:5], v[96:99], 0
    v_mfma_f32_16x16x32_bf16 v[50:53], v[2:5], v[104:107], 0
    v_mfma_f32_16x16x32_bf16 v[64:67], v[2:5], v[100:103], 0
    v_mfma_f32_16x16x32_bf16 v[112:115], v[2:5], v[108:111], 0
    s_nop 0
    v_add_f32 v46, v15, v46
    v_rcp_f32 v46, v46
    v_add_f32 v58, v17, v58
    v_add_f32 v68, v21, v68
    v_add_f32 v116, v27, v116
    v_rcp_f32 v58, v58
    v_rcp_f32 v68, v68
    v_rcp_f32 v116, v116
    v_pk_mul_f32 v[42:43], v[46:47], v[42:43] op_sel_hi:[0,1]
    v_pk_mul_f32 v[50:51], v[58:59], v[50:51] op_sel_hi:[0,1]
    v_pk_mul_f32 v[64:65], v[68:69], v[64:65] op_sel_hi:[0,1]
    v_pk_mul_f32 v[112:113], v[116:117], v[112:113] op_sel_hi:[0,1]
    v_pk_mul_f32 v[44:45], v[46:47], v[44:45] op_sel_hi:[0,1]
    v_pk_mul_f32 v[52:53], v[58:59], v[52:53] op_sel_hi:[0,1]
    v_pk_mul_f32 v[66:67], v[68:69], v[66:67] op_sel_hi:[0,1]
    v_pk_mul_f32 v[114:115], v[116:117], v[114:115] op_sel_hi:[0,1]
    v_cvt_pk_bf16_f32 v84, v42, v43
    v_cvt_pk_bf16_f32 v86, v50, v51
    v_cvt_pk_bf16_f32 v88, v64, v65
    v_cvt_pk_bf16_f32 v90, v112, v113
    v_cvt_pk_bf16_f32 v85, v44, v45
    v_cvt_pk_bf16_f32 v87, v52, v53
    v_cvt_pk_bf16_f32 v89, v66, v67
    v_cvt_pk_bf16_f32 v91, v114, v115
    v_permlane16_swap_b32 v84, v86
    v_permlane16_swap_b32 v85, v87
    v_permlane16_swap_b32 v88, v90
    v_permlane16_swap_b32 v89, v91
    s_add_u32 s76, s46, 1
    v_mov_b32 v14, s76
    s_add_u32 s81, s60, 32768
    s_cmp_eq_u32 s47, 0
    s_cbranch_scc1 L_slow_24
    buffer_store_dwordx4 v[84:87], v6, s[32:35], s60 offen
    buffer_store_dwordx4 v[88:91], v6, s[32:35], s81 offen
L_back_25:
    s_waitcnt vmcnt(0)
    s_barrier
    s_cmp_eq_u32 s47, 0
    s_cbranch_scc1 L_slow_26
    buffer_store_dword v14, v9, s[32:35], s67 offen offset:0
L_back_27:
    v_bfe_u32 v2, v1, 7, 2
    v_lshrrev_b32 v0, 8, v1
    v_mul_u32_u24 v0, 1024, v0
    v_lshl_add_u32 v0, v2, 5, v0
    v_bfe_u32 v2, v1, 6, 2
    v_lshl_add_u32 v0, v2, 7, v0
    v_bfe_u32 v2, v1, 4, 2
    v_lshl_add_u32 v0, v2, 3, v0
    v_add_u32 v0, 65536, v0
    v_xor_b32 v2, 32, v0
    v_xor_b32 v3, 64, v0
    v_xor_b32 v4, 96, v0
    s_lshl_b32 s80, s40, 11
    s_add_u32 s80, s80, 131072
    v_add_u32 v5, s80, v1
    ds_read_b128 v[64:67], v5 offset:0
    ds_read_b128 v[68:71], v5 offset:1024
    ds_read_b64_tr_b16 v[10:11], v0 offset:0
    ds_read_b64_tr_b16 v[12:13], v0 offset:512
    ds_read_b64_tr_b16 v[14:15], v2 offset:0
    ds_read_b64_tr_b16 v[16:17], v2 offset:512
    ds_read_b64_tr_b16 v[22:23], v3 offset:0
    ds_read_b64_tr_b16 v[24:25], v3 offset:512
    ds_read_b64_tr_b16 v[26:27], v4 offset:0
    ds_read_b64_tr_b16 v[28:29], v4 offset:512
    ds_read_b64_tr_b16 v[30:31], v0 offset:4096
    ds_read_b64_tr_b16 v[32:33], v0 offset:4608
    ds_read_b64_tr_b16 v[34:35], v2 offset:4096
    ds_read_b64_tr_b16 v[36:37], v2 offset:4608
    ds_read_b64_tr_b16 v[38:39], v3 offset:4096
    ds_read_b64_tr_b16 v[40:41], v3 offset:4608
    ds_read_b64_tr_b16 v[42:43], v4 offset:4096
    ds_read_b64_tr_b16 v[44:45], v4 offset:4608
    s_waitcnt lgkmcnt(15)
    v_lshlrev_b32 v46, 16, v64
    v_and_b32 v47, 0xffff0000, v64
    v_lshlrev_b32 v48, 16, v65
    v_and_b32 v49, 0xffff0000, v65
    v_lshlrev_b32 v50, 16, v66
    v_and_b32 v51, 0xffff0000, v66
    v_lshlrev_b32 v52, 16, v67
    v_and_b32 v53, 0xffff0000, v67
    v_lshlrev_b32 v54, 16, v68
    v_and_b32 v55, 0xffff0000, v68
    v_lshlrev_b32 v56, 16, v69
    v_and_b32 v57, 0xffff0000, v69
    v_lshlrev_b32 v58, 16, v70
    v_and_b32 v59, 0xffff0000, v70
    v_lshlrev_b32 v60, 16, v71
    v_and_b32 v61, 0xffff0000, v71
    v_and_b32 v6, 0xf0, v1
    v_lshrrev_b32 v7, 9, v1
    v_lshl_or_b32 v6, v7, 8, v6
    v_bfe_u32 v7, v1, 8, 1
    v_lshl_or_b32 v6, v7, 9, v6
    s_mov_b32 s80, 0xf0
    v_lshrrev_b32 v7, 9, v1
    v_lshlrev_b32 v7, 2, v7
    v_and_or_b32 v7, v1, s80, v7
    s_lshl_b32 s88, s42, 14
    s_lshl_b32 s81, s41, 11
    s_add_u32 s88, s88, s81
    s_add_u32 s88, s88, s50
    s_add_u32 s88, s88, 557056
    s_sub_u32 s89, s64, s65
    s_lshl_b32 s82, s42, 10
    s_add_u32 s89, s89, s82
    s_add_u32 s89, s89, s50
    s_add_u32 s89, s89, 548864
    s_cmp_eq_u32 s40, 3
    s_cselect_b32 s88, s88, 0x40000000
    s_cselect_b32 s89, s89, 0x40000000
    v_bfe_u32 v8, v1, 4, 3
    v_lshlrev_b32 v8, 2, v8
    s_add_u32 s85, s61, 4096
    s_add_u32 s86, s61, 8192
    s_add_u32 s87, s61, 12288
L_poll_28:
    buffer_load_dword v21, v8, s[32:35], s66 offen offset:0 sc1
    s_sub_u32 s48, s48, 1
    s_max_i32 s48, s48, 0
    s_cmp_lg_u32 s48, 0
    s_cselect_b64 s[94:95], -1, 0
    s_waitcnt vmcnt(0)
    v_cmp_ne_u32 vcc, s76, v21
    s_nop 0
    s_and_b64 vcc, vcc, s[94:95]
    s_cbranch_scc1 L_poll_28
    s_barrier
    buffer_load_dwordx4 v[62:65], v1, s[32:35], s61 offen offset:0 sc1
    buffer_load_dwordx4 v[66:69], v1, s[32:35], s61 offen offset:1024 sc1
    buffer_load_dwordx4 v[70:73], v1, s[32:35], s61 offen offset:2048 sc1
    buffer_load_dwordx4 v[74:77], v1, s[32:35], s61 offen offset:3072 sc1
    buffer_load_dwordx4 v[78:81], v1, s[32:35], s85 offen offset:0 sc1
    buffer_load_dwordx4 v[82:85], v1, s[32:35], s85 offen offset:1024 sc1
    buffer_load_dwordx4 v[86:89], v1, s[32:35], s85 offen offset:2048 sc1
    buffer_load_dwordx4 v[90:93], v1, s[32:35], s85 offen offset:3072 sc1
    s_waitcnt vmcnt(7) lgkmcnt(8)
    v_mfma_f32_16x16x32_bf16 v[46:49], v[10:13], v[62:65], v[46:49]
    ds_read_b64_tr_b16 v[10:11], v0 offset:8192
    ds_read_b64_tr_b16 v[12:13], v0 offset:8704
    v_mfma_f32_16x16x32_bf16 v[50:53], v[14:17], v[62:65], v[50:53]
    ds_read_b64_tr_b16 v[14:15], v2 offset:8192
    ds_read_b64_tr_b16 v[16:17], v2 offset:8704
    v_mfma_f32_16x16x32_bf16 v[54:57], v[22:25], v[62:65], v[54:57]
    ds_read_b64_tr_b16 v[22:23], v3 offset:8192
    ds_read_b64_tr_b16 v[24:25], v3 offset:8704
    v_mfma_f32_16x16x32_bf16 v[58:61], v[26:29], v[62:65], v[58:61]
    ds_read_b64_tr_b16 v[26:27], v4 offset:8192
    ds_read_b64_tr_b16 v[28:29], v4 offset:8704
    buffer_load_dwordx4 v[94:97], v1, s[32:35], s86 offen offset:0 sc1
    s_waitcnt vmcnt(7) lgkmcnt(8)
    v_mfma_f32_16x16x32_bf16 v[46:49], v[30:33], v[66:69], v[46:49]
    ds_read_b64_tr_b16 v[30:31], v0 offset:12288
    ds_read_b64_tr_b16 v[32:33], v0 offset:12800
    v_mfma_f32_16x16x32_bf16 v[50:53], v[34:37], v[66:69], v[50:53]
    ds_read_b64_tr_b16 v[34:35], v2 offset:12288
    ds_read_b64_tr_b16 v[36:37], v2 offset:12800
    v_mfma_f32_16x16x32_bf16 v[54:57], v[38:41], v[66:69], v[54:57]
    ds_read_b64_tr_b16 v[38:39], v3 offset:12288
    ds_read_b64_tr_b16 v[40:41], v3 offset:12800
    v_mfma_f32_16x16x32_bf16 v[58:61], v[42:45], v[66:69], v[58:61]
    ds_read_b64_tr_b16 v[42:43], v4 offset:12288
    ds_read_b64_tr_b16 v[44:45], v4 offset:12800
    buffer_load_dwordx4 v[98:101], v1, s[32:35], s86 offen offset:1024 sc1
    s_waitcnt vmcnt(7) lgkmcnt(8)
    v_mfma_f32_16x16x32_bf16 v[46:49], v[10:13], v[70:73], v[46:49]
    ds_read_b64_tr_b16 v[10:11], v0 offset:16384
    ds_read_b64_tr_b16 v[12:13], v0 offset:16896
    v_mfma_f32_16x16x32_bf16 v[50:53], v[14:17], v[70:73], v[50:53]
    ds_read_b64_tr_b16 v[14:15], v2 offset:16384
    ds_read_b64_tr_b16 v[16:17], v2 offset:16896
    v_mfma_f32_16x16x32_bf16 v[54:57], v[22:25], v[70:73], v[54:57]
    ds_read_b64_tr_b16 v[22:23], v3 offset:16384
    ds_read_b64_tr_b16 v[24:25], v3 offset:16896
    v_mfma_f32_16x16x32_bf16 v[58:61], v[26:29], v[70:73], v[58:61]
    ds_read_b64_tr_b16 v[26:27], v4 offset:16384
    ds_read_b64_tr_b16 v[28:29], v4 offset:16896
    buffer_load_dwordx4 v[102:105], v1, s[32:35], s86 offen offset:2048 sc1
    s_waitcnt vmcnt(7) lgkmcnt(8)
    v_mfma_f32_16x16x32_bf16 v[46:49], v[30:33], v[74:77], v[46:49]
    ds_read_b64_tr_b16 v[30:31], v0 offset:20480
    ds_read_b64_tr_b16 v[32:33], v0 offset:20992
    v_mfma_f32_16x16x32_bf16 v[50:53], v[34:37], v[74:77], v[50:53]
    ds_read_b64_tr_b16 v[34:35], v2 offset:20480
    ds_read_b64_tr_b16 v[36:37], v2 offset:20992
    v_mfma_f32_16x16x32_bf16 v[54:57], v[38:41], v[74:77], v[54:57]
    ds_read_b64_tr_b16 v[38:39], v3 offset:20480
    ds_read_b64_tr_b16 v[40:41], v3 offset:20992
    v_mfma_f32_16x16x32_bf16 v[58:61], v[42:45], v[74:77], v[58:61]
    ds_read_b64_tr_b16 v[42:43], v4 offset:20480
    ds_read_b64_tr_b16 v[44:45], v4 offset:20992
    buffer_load_dwordx4 v[106:109], v1, s[32:35], s86 offen offset:3072 sc1
    s_waitcnt vmcnt(7) lgkmcnt(8)
    v_mfma_f32_16x16x32_bf16 v[46:49], v[10:13], v[78:81], v[46:49]
    ds_read_b64_tr_b16 v[10:11], v0 offset:24576
    ds_read_b64_tr_b16 v[12:13], v0 offset:25088
    v_mfma_f32_16x16x32_bf16 v[50:53], v[14:17], v[78:81], v[50:53]
    ds_read_b64_tr_b16 v[14:15], v2 offset:24576
    ds_read_b64_tr_b16 v[16:17], v2 offset:25088
    v_mfma_f32_16x16x32_bf16 v[54:57], v[22:25], v[78:81], v[54:57]
    ds_read_b64_tr_b16 v[22:23], v3 offset:24576
    ds_read_b64_tr_b16 v[24:25], v3 offset:25088
    v_mfma_f32_16x16x32_bf16 v[58:61], v[26:29], v[78:81], v[58:61]
    ds_read_b64_tr_b16 v[26:27], v4 offset:24576
    ds_read_b64_tr_b16 v[28:29], v4 offset:25088
    buffer_load_dwordx4 v[110:113], v1, s[32:35], s87 offen offset:0 sc1
    s_waitcnt vmcnt(7) lgkmcnt(8)
    v_mfma_f32_16x16x32_bf16 v[46:49], v[30:33], v[82:85], v[46:49]
    ds_read_b64_tr_b16 v[30:31], v0 offset:28672
    ds_read_b64_tr_b16 v[32:33], v0 offset:29184
    v_mfma_f32_16x16x32_bf16 v[50:53], v[34:37], v[82:85], v[50:53]
    ds_read_b64_tr_b16 v[34:35], v2 offset:28672
    ds_read_b64_tr_b16 v[36:37], v2 offset:29184
    v_mfma_f32_16x16x32_bf16 v[54:57], v[38:41], v[82:85], v[54:57]
    ds_read_b64_tr_b16 v[38:39], v3 offset:28672
    ds_read_b64_tr_b16 v[40:41], v3 offset:29184
    v_mfma_f32_16x16x32_bf16 v[58:61], v[42:45], v[82:85], v[58:61]
    ds_read_b64_tr_b16 v[42:43], v4 offset:28672
    ds_read_b64_tr_b16 v[44:45], v4 offset:29184
    buffer_load_dwordx4 v[114:117], v1, s[32:35], s87 offen offset:1024 sc1
    s_waitcnt vmcnt(7) lgkmcnt(8)
    v_mfma_f32_16x16x32_bf16 v[46:49], v[10:13], v[86:89], v[46:49]
    ds_read_b64_tr_b16 v[10:11], v0 offset:32768
    ds_read_b64_tr_b16 v[12:13], v0 offset:33280
    v_mfma_f32_16x16x32_bf16 v[50:53], v[14:17], v[86:89], v[50:53]
    ds_read_b64_tr_b16 v[14:15], v2 offset:32768
    ds_read_b64_tr_b16 v[16:17], v2 offset:33280
    v_mfma_f32_16x16x32_bf16 v[54:57], v[22:25], v[86:89], v[54:57]
    ds_read_b64_tr_b16 v[22:23], v3 offset:32768
    ds_read_b64_tr_b16 v[24:25], v3 offset:33280
    v_mfma_f32_16x16x32_bf16 v[58:61], v[26:29], v[86:89], v[58:61]
    ds_read_b64_tr_b16 v[26:27], v4 offset:32768
    ds_read_b64_tr_b16 v[28:29], v4 offset:33280
    buffer_load_dwordx4 v[118:121], v1, s[32:35], s87 offen offset:2048 sc1
    s_waitcnt vmcnt(7) lgkmcnt(8)
    v_mfma_f32_16x16x32_bf16 v[46:49], v[30:33], v[90:93], v[46:49]
    ds_read_b64_tr_b16 v[30:31], v0 offset:36864
    ds_read_b64_tr_b16 v[32:33], v0 offset:37376
    v_mfma_f32_16x16x32_bf16 v[50:53], v[34:37], v[90:93], v[50:53]
    ds_read_b64_tr_b16 v[34:35], v2 offset:36864
    ds_read_b64_tr_b16 v[36:37], v2 offset:37376
    v_mfma_f32_16x16x32_bf16 v[54:57], v[38:41], v[90:93], v[54:57]
    ds_read_b64_tr_b16 v[38:39], v3 offset:36864
    ds_read_b64_tr_b16 v[40:41], v3 offset:37376
    v_mfma_f32_16x16x32_bf16 v[58:61], v[42:45], v[90:93], v[58:61]
    ds_read_b64_tr_b16 v[42:43], v4 offset:36864
    ds_read_b64_tr_b16 v[44:45], v4 offset:37376
    buffer_load_dwordx4 v[122:125], v1, s[32:35], s87 offen offset:3072 sc1
    s_waitcnt vmcnt(7) lgkmcnt(8)
    v_mfma_f32_16x16x32_bf16 v[46:49], v[10:13], v[94:97], v[46:49]
    ds_read_b64_tr_b16 v[10:11], v0 offset:40960
    ds_read_b64_tr_b16 v[12:13], v0 offset:41472
    v_mfma_f32_16x16x32_bf16 v[50:53], v[14:17], v[94:97], v[50:53]
    ds_read_b64_tr_b16 v[14:15], v2 offset:40960
    ds_read_b64_tr_b16 v[16:17], v2 offset:41472
    v_mfma_f32_16x16x32_bf16 v[54:57], v[22:25], v[94:97], v[54:57]
    ds_read_b64_tr_b16 v[22:23], v3 offset:40960
    ds_read_b64_tr_b16 v[24:25], v3 offset:41472
    v_mfma_f32_16x16x32_bf16 v[58:61], v[26:29], v[94:97], v[58:61]
    ds_read_b64_tr_b16 v[26:27], v4 offset:40960
    ds_read_b64_tr_b16 v[28:29], v4 offset:41472
    s_waitcnt vmcnt(6) lgkmcnt(8)
    v_mfma_f32_16x16x32_bf16 v[46:49], v[30:33], v[98:101], v[46:49]
    ds_read_b64_tr_b16 v[30:31], v0 offset:45056
    ds_read_b64_tr_b16 v[32:33], v0 offset:45568
    v_mfma_f32_16x16x32_bf16 v[50:53], v[34:37], v[98:101], v[50:53]
    ds_read_b64_tr_b16 v[34:35], v2 offset:45056
    ds_read_b64_tr_b16 v[36:37], v2 offset:45568
    v_mfma_f32_16x16x32_bf16 v[54:57], v[38:41], v[98:101], v[54:57]
    ds_read_b64_tr_b16 v[38:39], v3 offset:45056
    ds_read_b64_tr_b16 v[40:41], v3 offset:45568
    v_mfma_f32_16x16x32_bf16 v[58:61], v[42:45], v[98:101], v[58:61]
    ds_read_b64_tr_b16 v[42:43], v4 offset:45056
    ds_read_b64_tr_b16 v[44:45], v4 offset:45568
    s_waitcnt vmcnt(5) lgkmcnt(8)
    v_mfma_f32_16x16x32_bf16 v[46:49], v[10:13], v[102:105], v[46:49]
    ds_read_b64_tr_b16 v[10:11], v0 offset:49152
    ds_read_b64_tr_b16 v[12:13], v0 offset:49664
    v_mfma_f32_16x16x32_bf16 v[50:53], v[14:17], v[102:105], v[50:53]
    ds_read_b64_tr_b16 v[14:15], v2 offset:49152
    ds_read_b64_tr_b16 v[16:17], v2 offset:49664
    v_mfma_f32_16x16x32_bf16 v[54:57], v[22:25], v[102:105], v[54:57]
    ds_read_b64_tr_b16 v[22:23], v3 offset:49152
    ds_read_b64_tr_b16 v[24:25], v3 offset:49664
    v_mfma_f32_16x16x32_bf16 v[58:61], v[26:29], v[102:105], v[58:61]
    ds_read_b64_tr_b16 v[26:27], v4 offset:49152
    ds_read_b64_tr_b16 v[28:29], v4 offset:49664
    s_waitcnt vmcnt(4) lgkmcnt(8)
    v_mfma_f32_16x16x32_bf16 v[46:49], v[30:33], v[106:109], v[46:49]
    ds_read_b64_tr_b16 v[30:31], v0 offset:53248
    ds_read_b64_tr_b16 v[32:33], v0 offset:53760
    v_mfma_f32_16x16x32_bf16 v[50:53], v[34:37], v[106:109], v[50:53]
    ds_read_b64_tr_b16 v[34:35], v2 offset:53248
    ds_read_b64_tr_b16 v[36:37], v2 offset:53760
    v_mfma_f32_16x16x32_bf16 v[54:57], v[38:41], v[106:109], v[54:57]
    ds_read_b64_tr_b16 v[38:39], v3 offset:53248
    ds_read_b64_tr_b16 v[40:41], v3 offset:53760
    v_mfma_f32_16x16x32_bf16 v[58:61], v[42:45], v[106:109], v[58:61]
    ds_read_b64_tr_b16 v[42:43], v4 offset:53248
    ds_read_b64_tr_b16 v[44:45], v4 offset:53760
    s_waitcnt vmcnt(3) lgkmcnt(8)
    v_mfma_f32_16x16x32_bf16 v[46:49], v[10:13], v[110:113], v[46:49]
    ds_read_b64_tr_b16 v[10:11], v0 offset:57344
    ds_read_b64_tr_b16 v[12:13], v0 offset:57856
    v_mfma_f32_16x16x32_bf16 v[50:53], v[14:17], v[110:113], v[50:53]
    ds_read_b64_tr_b16 v[14:15], v2 offset:57344
    ds_read_b64_tr_b16 v[16:17], v2 offset:57856
    v_mfma_f32_16x16x32_bf16 v[54:57], v[22:25], v[110:113], v[54:57]
    ds_read_b64_tr_b16 v[22:23], v3 offset:57344
    ds_read_b64_tr_b16 v[24:25], v3 offset:57856
    v_mfma_f32_16x16x32_bf16 v[58:61], v[26:29], v[110:113], v[58:61]
    ds_read_b64_tr_b16 v[26:27], v4 offset:57344
    ds_read_b64_tr_b16 v[28:29], v4 offset:57856
    s_waitcnt vmcnt(2) lgkmcnt(8)
    v_mfma_f32_16x16x32_bf16 v[46:49], v[30:33], v[114:117], v[46:49]
    ds_read_b64_tr_b16 v[30:31], v0 offset:61440
    ds_read_b64_tr_b16 v[32:33], v0 offset:61952
    v_mfma_f32_16x16x32_bf16 v[50:53], v[34:37], v[114:117], v[50:53]
    ds_read_b64_tr_b16 v[34:35], v2 offset:61440
    ds_read_b64_tr_b16 v[36:37], v2 offset:61952
    v_mfma_f32_16x16x32_bf16 v[54:57], v[38:41], v[114:117], v[54:57]
    ds_read_b64_tr_b16 v[38:39], v3 offset:61440
    ds_read_b64_tr_b16 v[40:41], v3 offset:61952
    v_mfma_f32_16x16x32_bf16 v[58:61], v[42:45], v[114:117], v[58:61]
    ds_read_b64_tr_b16 v[42:43], v4 offset:61440
    ds_read_b64_tr_b16 v[44:45], v4 offset:61952
    s_waitcnt vmcnt(1) lgkmcnt(8)
    v_mfma_f32_16x16x32_bf16 v[46:49], v[10:13], v[118:121], v[46:49]
    v_mfma_f32_16x16x32_bf16 v[50:53], v[14:17], v[118:121], v[50:53]
    v_mfma_f32_16x16x32_bf16 v[54:57], v[22:25], v[118:121], v[54:57]
    v_mfma_f32_16x16x32_bf16 v[58:61], v[26:29], v[118:121], v[58:61]
    s_waitcnt vmcnt(0) lgkmcnt(0)
    v_mfma_f32_16x16x32_bf16 v[46:49], v[30:33], v[122:125], v[46:49]
    v_mfma_f32_16x16x32_bf16 v[50:53], v[34:37], v[122:125], v[50:53]
    v_mfma_f32_16x16x32_bf16 v[54:57], v[38:41], v[122:125], v[54:57]
    v_mfma_f32_16x16x32_bf16 v[58:61], v[42:45], v[122:125], v[58:61]
    s_nop 4
    v_cvt_pk_bf16_f32 v24, v46, v47
    v_cvt_pk_bf16_f32 v25, v48, v49
    v_cvt_pk_bf16_f32 v26, v50, v51
    v_cvt_pk_bf16_f32 v27, v52, v53
    ds_write_b128 v5, v[24:27] offset:0
    v_cvt_pk_bf16_f32 v28, v54, v55
    v_cvt_pk_bf16_f32 v29, v56, v57
    v_cvt_pk_bf16_f32 v30, v58, v59
    v_cvt_pk_bf16_f32 v31, v60, v61
    ds_write_b128 v5, v[28:31] offset:1024
    v_permlane16_swap_b32 v24, v26
    v_permlane16_swap_b32 v25, v27
    v_permlane16_swap_b32 v28, v30
    v_permlane16_swap_b32 v29, v31
    s_cmp_eq_u32 s47, 0
    s_cbranch_scc1 L_slow_29
    buffer_store_dwordx4 v[24:27], v6, s[32:35], s62 offen offset:0
    buffer_store_dwordx4 v[28:31], v6, s[32:35], s62 offen offset:1024
L_back_30:
    v_pk_add_f32 v[2:3], v[46:47], v[48:49]
    v_pk_mul_f32 v[10:11], v[46:47], v[46:47]
    v_pk_fma_f32 v[10:11], v[48:49], v[48:49], v[10:11]
    v_pk_add_f32 v[2:3], v[2:3], v[50:51]
    v_pk_fma_f32 v[10:11], v[50:51], v[50:51], v[10:11]
    v_pk_add_f32 v[2:3], v[2:3], v[52:53]
    v_pk_fma_f32 v[10:11], v[52:53], v[52:53], v[10:11]
    v_pk_add_f32 v[2:3], v[2:3], v[54:55]
    v_pk_fma_f32 v[10:11], v[54:55], v[54:55], v[10:11]
    v_pk_add_f32 v[2:3], v[2:3], v[56:57]
    v_pk_fma_f32 v[10:11], v[56:57], v[56:57], v[10:11]
    v_pk_add_f32 v[2:3], v[2:3], v[58:59]
    v_pk_fma_f32 v[10:11], v[58:59], v[58:59], v[10:11]
    v_pk_add_f32 v[2:3], v[2:3], v[60:61]
    v_pk_fma_f32 v[10:11], v[60:61], v[60:61], v[10:11]
    v_add_f32 v2, v2, v3
    v_add_f32 v10, v10, v11
    s_add_u32 s76, s46, 1
    v_mov_b32 v0, s76
    v_permlane32_swap_b32 v2, v10
    v_add_f32 v2, v2, v10
    v_mov_b32 v10, v2
    s_nop 1
    v_permlane16_swap_b32 v2, v10
    v_add_f32 v2, v2, v10
    s_cmp_eq_u32 s47, 0
    s_cbranch_scc1 L_slow_31
    buffer_store_dword v2, v7, s[32:35], s64 offen
L_back_32:
    buffer_store_dwordx4 v[24:27], v6, s[32:35], s88 offen offset:0 sc1
    buffer_store_dwordx4 v[28:31], v6, s[32:35], s88 offen offset:1024 sc1
    buffer_store_dword v2, v7, s[32:35], s89 offen sc1
    s_waitcnt vmcnt(3) lgkmcnt(0)
    s_barrier
    s_cmp_eq_u32 s47, 0
    s_cbranch_scc1 L_slow_33
    buffer_store_dword v0, v9, s[32:35], s67 offen offset:32
L_back_34:
    s_xor_b32 m0, s70, 0
    s_xor_b32 s92, s71, 0
    buffer_load_dwordx4 v20, s[16:19], s92 offen lds
    s_xor_b32 m0, s70, 4096
    s_xor_b32 s92, s71, 32768
    buffer_load_dwordx4 v20, s[16:19], s92 offen lds
    s_xor_b32 m0, s70, 8192
    s_xor_b32 s92, s71, 65536
    buffer_load_dwordx4 v20, s[16:19], s92 offen lds
    s_xor_b32 m0, s70, 12288
    s_xor_b32 s92, s71, 98304
    buffer_load_dwordx4 v20, s[16:19], s92 offen lds
    s_mul_i32 s80, s40, 192
    s_add_u32 s80, s80, 156672
    v_lshrrev_b32 v0, 8, v1
    v_lshl_add_u32 v0, v0, 4, s80
    v_bfe_u32 v2, v1, 4, 4
    v_lshl_add_u32 v2, v2, 2, s80
    ds_read_b128 v[4:7], v0 offset:0
    ds_read_b128 v[10:13], v0 offset:64
    ds_read_b32 v8, v2 offset:128
    v_add_u32 v0, 159744, v1
    ds_read_b128 v[14:17], v0
    ds_read_b128 v[22:25], v0 offset:1024
    v_mov_b32 v26, 0x3f803f80
    v_mov_b32 v27, 0x3f803f80
    v_mov_b32 v28, 0x3f803f80
    v_mov_b32 v29, 0x3f803f80
    v_and_b32 v0, 0xf0, v1
    v_lshrrev_b32 v2, 9, v1
    v_lshl_or_b32 v0, v2, 8, v0
    v_bfe_u32 v2, v1, 8, 1
    v_lshl_or_b32 v0, v2, 14, v0
    s_sub_u32 s80, s43, 1
    s_lshr_b32 s81, s80, 2
    s_and_b32 s80, s80, 3
    s_mul_i32 s81, s81, 1048576
    s_add_u32 s81, s81, 1048576
    s_lshl_b32 s82, s80, 7
    s_add_u32 s82, s82, s81
    s_add_u32 s82, s82, 525312
    s_lshr_b32 s85, s45, 1
    s_xor_b32 s85, s85, s40
    s_lshl_b32 s85, s85, 12
    s_lshl_b32 s83, s80, 14
    s_add_u32 s83, s83, s81
    s_add_u32 s83, s83, s85
    s_add_u32 s83, s83, 557056
    s_lshl_b32 s84, s80, 10
    s_add_u32 s84, s84, s81
    s_add_u32 s84, s84, 548864
    s_add_u32 s80, s66, 32
    s_add_u32 s81, s50, 532480
    s_cmp_eq_u32 s43, 0
    s_cselect_b32 s82, s80, s82
    s_cselect_b32 s83, s63, s83
    s_cselect_b32 s84, s81, s84
    s_cselect_b32 s86, s76, s46
    s_sub_u32 s85, s83, 4096
    v_bfe_u32 v2, v1, 4, 3
    v_lshlrev_b32 v2, 2, v2
    s_cmp_eq_u32 s40, 3
    s_cselect_b32 s80, 0, 0x40000000
    v_mov_b32 v3, 0x40000000
    v_cmp_eq_u32 vcc, 0, v1
    v_mov_b32 v21, s80
    s_nop 0
    v_cndmask_b32 v3, v3, v21, vcc
    v_mov_b32 v21, s46
    s_and_b32 s80, s45, 1
    s_lshl_b32 s80, s80, 11
    v_add_u32 v31, s80, v1
    v_subrev_u32 v33, s80, v1
    v_add_u32 v33, 4096, v33
    s_mov_b32 s80, 155648
    v_bfe_u32 v42, v1, 4, 4
    v_lshl_add_u32 v42, v42, 2, s80
    v_lshrrev_b32 v43, 8, v1
    v_lshl_add_u32 v43, v43, 4, s80
    s_lshl_b32 s80, s40, 6
    v_add_u32 v30, s80, v42
    s_sub_u32 s93, s63, 4096
    v_bfe_u32 v44, v1, 4, 3
    v_lshlrev_b32 v44, 2, v44
    s_nop 2
L_poll_35:
    buffer_load_dword v45, v44, s[32:35], s66 offen offset:32 sc1
    s_sub_u32 s48, s48, 1
    s_max_i32 s48, s48, 0
    s_cmp_lg_u32 s48, 0
    s_cselect_b64 s[94:95], -1, 0
    s_waitcnt vmcnt(0)
    v_cmp_ne_u32 vcc, s76, v45
    s_nop 0
    s_and_b64 vcc, vcc, s[94:95]
    s_cbranch_scc1 L_poll_35
    s_add_u32 m0, s68, 0
    s_nop 0
    buffer_load_dwordx4 v31, s[32:35], s63 offen offset:0 sc1 lds
    buffer_load_dwordx4 v31, s[32:35], s63 offen offset:1024 sc1 lds
    buffer_load_dwordx4 v33, s[32:35], s93 offen offset:2048 sc1 lds
    buffer_load_dwordx4 v33, s[32:35], s93 offen offset:3072 sc1 lds
    buffer_load_dwordx4 v[34:37], v1, s[32:35], s65 offen sc1
    buffer_store_dword v21, v3, s[32:35], s67 offen offset:1024 sc1
    s_add_u32 s92, s63, 16384
    s_add_u32 s93, s63, 12288
    s_add_u32 m0, s68, 16384
    s_nop 0
    buffer_load_dwordx4 v31, s[32:35], s92 offen offset:0 sc1 lds
    buffer_load_dwordx4 v31, s[32:35], s92 offen offset:1024 sc1 lds
    buffer_load_dwordx4 v33, s[32:35], s93 offen offset:2048 sc1 lds
    buffer_load_dwordx4 v33, s[32:35], s93 offen offset:3072 sc1 lds
    s_waitcnt vmcnt(6) lgkmcnt(0)
    s_barrier
    ds_read_b128 v[76:79], v1 offset:0
    ds_read_b128 v[80:83], v1 offset:1024
    ds_read_b128 v[84:87], v1 offset:2048
    s_waitcnt lgkmcnt(2)
    v_mfma_f32_16x16x32_bf16 v[96:99], a[64:67], v[76:79], 0
    ds_read_b128 v[88:91], v1 offset:3072
    s_waitcnt vmcnt(5)
    v_add_f32 v34, v34, v36
    v_mfma_f32_16x16x32_bf16 v[92:95], a[0:3], v[76:79], 0
    s_add_u32 s92, s63, 32768
    v_add_f32 v35, v35, v37
    v_mfma_f32_16x16x32_bf16 v[100:103], v[76:79], a[128:131], 0
    s_waitcnt lgkmcnt(2)
    v_mfma_f32_16x16x32_bf16 v[96:99], a[68:71], v[80:83], v[96:99]
    ds_read_b128 v[76:79], v1 offset:4096
    v_permlane32_swap_b32 v34, v35
    v_mfma_f32_16x16x32_bf16 v[92:95], a[4:7], v[80:83], v[92:95]
    s_add_u32 s93, s63, 28672
    v_add_f32 v34, v34, v35
    v_mov_b32 v35, v34
    v_mfma_f32_16x16x32_bf16 v[100:103], v[80:83], a[132:135], v[100:103]
    s_waitcnt lgkmcnt(2)
    v_mfma_f32_16x16x32_bf16 v[96:99], a[72:75], v[84:87], v[96:99]
    ds_read_b128 v[80:83], v1 offset:5120
    v_mfma_f32_16x16x32_bf16 v[92:95], a[8:11], v[84:87], v[92:95]
    s_add_u32 m0, s68, 32768
    v_permlane16_swap_b32 v34, v35
    v_mfma_f32_16x16x32_bf16 v[100:103], v[84:87], a[136:139], v[100:103]
    s_waitcnt lgkmcnt(2)
    v_add_f32 v34, v34, v35
    v_mov_b32 v35, v34
    v_mfma_f32_16x16x32_bf16 v[96:99], a[76:79], v[88:91], v[96:99]
    ds_read_b128 v[84:87], v1 offset:6144
    v_mfma_f32_16x16x32_bf16 v[92:95], a[12:15], v[88:91], v[92:95]
    v_permlane32_swap_b32 v34, v35
    v_mfma_f32_16x16x32_bf16 v[100:103], v[88:91], a[140:143], v[100:103]
    s_waitcnt lgkmcnt(2)
    v_mul_f32 v34, 0xbb000000, v34
    v_mul_f32 v35, 0x3b000000, v35
    v_mfma_f32_16x16x32_bf16 v[96:99], a[80:83], v[76:79], v[96:99]
    ds_read_b128 v[88:91], v1 offset:7168
    v_fma_f32 v35, -v34, v34, v35
    v_mfma_f32_16x16x32_bf16 v[92:95], a[16:19], v[76:79], v[92:95]
    v_max_f32 v35, 0, v35
    v_add_f32 v35, 0x3727c5ac, v35
    v_mfma_f32_16x16x32_bf16 v[100:103], v[76:79], a[144:147], v[100:103]
    s_waitcnt lgkmcnt(2)
    v_rsq_f32 v35, v35
    v_mfma_f32_16x16x32_bf16 v[96:99], a[84:87], v[80:83], v[96:99]
    ds_read_b128 v[76:79], v1 offset:8192
    ds_write_b32 v30, v34 offset:320
    buffer_load_dwordx4 v31, s[32:35], s92 offen offset:0 sc1 lds
    v_mfma_f32_16x16x32_bf16 v[92:95], a[20:23], v[80:83], v[92:95]
    ds_write_b32 v30, v35 offset:0
    v_mfma_f32_16x16x32_bf16 v[100:103], v[80:83], a[148:151], v[100:103]
    s_waitcnt lgkmcnt(4)
    v_mfma_f32_16x16x32_bf16 v[96:99], a[88:91], v[84:87], v[96:99]
    ds_read_b128 v[80:83], v1 offset:9216
    v_mfma_f32_16x16x32_bf16 v[92:95], a[24:27], v[84:87], v[92:95]
    v_mfma_f32_16x16x32_bf16 v[100:103], v[84:87], a[152:155], v[100:103]
    s_waitcnt lgkmcnt(4)
    v_mfma_f32_16x16x32_bf16 v[96:99], a[92:95], v[88:91], v[96:99]
    ds_read_b128 v[84:87], v1 offset:10240
    buffer_load_dwordx4 v31, s[32:35], s92 offen offset:1024 sc1 lds
    v_mfma_f32_16x16x32_bf16 v[92:95], a[28:31], v[88:91], v[92:95]
    v_mfma_f32_16x16x32_bf16 v[100:103], v[88:91], a[156:159], v[100:103]
    s_waitcnt lgkmcnt(4)
    v_mfma_f32_16x16x32_bf16 v[96:99], a[96:99], v[76:79], v[96:99]
    ds_read_b128 v[88:91], v1 offset:11264
    v_mfma_f32_16x16x32_bf16 v[92:95], a[32:35], v[76:79], v[92:95]
    buffer_load_dwordx4 v33, s[32:35], s93 offen offset:2048 sc1 lds
    v_mfma_f32_16x16x32_bf16 v[100:103], v[76:79], a[160:163], v[100:103]
    s_waitcnt lgkmcnt(2)
    v_mfma_f32_16x16x32_bf16 v[96:99], a[100:103], v[80:83], v[96:99]
    ds_read_b128 v[76:79], v1 offset:12288
    v_mfma_f32_16x16x32_bf16 v[92:95], a[36:39], v[80:83], v[92:95]
    v_mfma_f32_16x16x32_bf16 v[100:103], v[80:83], a[164:167], v[100:103]
    s_waitcnt lgkmcnt(2)
    v_mfma_f32_16x16x32_bf16 v[96:99], a[104:107], v[84:87], v[96:99]
    ds_read_b128 v[80:83], v1 offset:13312
    buffer_load_dwordx4 v33, s[32:35], s93 offen offset:3072 sc1 lds
    v_mfma_f32_16x16x32_bf16 v[92:95], a[40:43], v[84:87], v[92:95]
    v_mfma_f32_16x16x32_bf16 v[100:103], v[84:87], a[168:171], v[100:103]
    s_waitcnt lgkmcnt(2)
    v_mfma_f32_16x16x32_bf16 v[96:99], a[108:111], v[88:91], v[96:99]
    ds_read_b128 v[84:87], v1 offset:14336
    v_mfma_f32_16x16x32_bf16 v[92:95], a[44:47], v[88:91], v[92:95]
    v_mfma_f32_16x16x32_bf16 v[100:103], v[88:91], a[172:175], v[100:103]
    s_waitcnt lgkmcnt(2)
    v_mfma_f32_16x16x32_bf16 v[96:99], a[112:115], v[76:79], v[96:99]
    ds_read_b128 v[88:91], v1 offset:15360
    v_mfma_f32_16x16x32_bf16 v[92:95], a[48:51], v[76:79], v[92:95]
    buffer_load_dword v21, v2, s[32:35], s82 offen offset:0 sc1
    v_mfma_f32_16x16x32_bf16 v[100:103], v[76:79], a[176:179], v[100:103]
    s_waitcnt lgkmcnt(2)
    v_mfma_f32_16x16x32_bf16 v[96:99], a[116:119], v[80:83], v[96:99]
    s_waitcnt vmcnt(5)
    s_barrier
    ds_read_b128 v[76:79], v1 offset:16384
    ds_read_b32 v32, v42 offset:320
    ds_read_b32 v30, v42 offset:0
    ds_read_b128 v[38:41], v43 offset:320
    ds_read_b128 v[34:37], v43 offset:0
    v_mfma_f32_16x16x32_bf16 v[92:95], a[52:55], v[80:83], v[92:95]
    s_add_u32 s92, s63, 49152
    v_mfma_f32_16x16x32_bf16 v[100:103], v[80:83], a[180:183], v[100:103]
    s_waitcnt lgkmcnt(6)
    v_mfma_f32_16x16x32_bf16 v[96:99], a[120:123], v[84:87], v[96:99]
    ds_read_b128 v[80:83], v1 offset:17408
    v_mfma_f32_16x16x32_bf16 v[92:95], a[56:59], v[84:87], v[92:95]
    s_add_u32 s93, s63, 45056
    v_mfma_f32_16x16x32_bf16 v[100:103], v[84:87], a[184:187], v[100:103]
    s_waitcnt lgkmcnt(6)
    v_mfma_f32_16x16x32_bf16 v[96:99], a[124:127], v[88:91], v[96:99]
    ds_read_b128 v[84:87], v1 offset:18432
    v_mfma_f32_16x16x32_bf16 v[92:95], a[60:63], v[88:91], v[92:95]
    s_add_u32 m0, s68, 49152
    v_mfma_f32_16x16x32_bf16 v[100:103], v[88:91], a[188:191], v[100:103]
    s_waitcnt lgkmcnt(6)
    v_mfma_f32_16x16x32_bf16 v[108:111], a[64:67], v[76:79], 0
    ds_read_b128 v[88:91], v1 offset:19456
    v_mfma_f32_16x16x32_bf16 v[104:107], a[0:3], v[76:79], 0
    buffer_load_dwordx4 v31, s[32:35], s92 offen offset:0 sc1 lds
    s_waitcnt lgkmcnt(6)
    v_fma_f32 v96, v32, v10, v96
    v_mfma_f32_16x16x32_bf16 v[112:115], v[76:79], a[128:131], 0
    s_waitcnt lgkmcnt(2)
    v_fma_f32 v97, v32, v11, v97
    v_fma_f32 v98, v32, v12, v98
    v_mfma_f32_16x16x32_bf16 v[108:111], a[68:71], v[80:83], v[108:111]
    ds_read_b128 v[76:79], v1 offset:20480
    v_fma_f32 v99, v32, v13, v99
    v_mfma_f32_16x16x32_bf16 v[104:107], a[4:7], v[80:83], v[104:107]
    v_mul_f32 v96, v30, v96
    v_mul_f32 v97, v30, v97
    v_mfma_f32_16x16x32_bf16 v[112:115], v[80:83], a[132:135], v[112:115]
    s_waitcnt lgkmcnt(2)
    v_mul_f32 v98, v30, v98
    v_mul_f32 v99, v30, v99
    v_mfma_f32_16x16x32_bf16 v[108:111], a[72:75], v[84:87], v[108:111]
    ds_read_b128 v[80:83], v1 offset:21504
    buffer_load_dwordx4 v31, s[32:35], s92 offen offset:1024 sc1 lds
    v_mfma_f32_16x16x32_bf16 v[104:107], a[8:11], v[84:87], v[104:107]
    v_cvt_pk_bf16_f32 v44, v96, v97
    v_cvt_pk_bf16_f32 v45, v98, v99
    v_mfma_f32_16x16x32_bf16 v[112:115], v[84:87], a[136:139], v[112:115]
    s_waitcnt lgkmcnt(2)
    v_fma_f32 v92, v32, v4, v92
    v_fma_f32 v93, v32, v5, v93
    v_mfma_f32_16x16x32_bf16 v[108:111], a[76:79], v[88:91], v[108:111]
    ds_read_b128 v[84:87], v1 offset:22528
    v_fma_f32 v94, v32, v6, v94
    v_mfma_f32_16x16x32_bf16 v[104:107], a[12:15], v[88:91], v[104:107]
    v_fma_f32 v95, v32, v7, v95
    v_cvt_pk_bf16_f32 v60, v92, v93
    v_mfma_f32_16x16x32_bf16 v[112:115], v[88:91], a[140:143], v[112:115]
    s_waitcnt lgkmcnt(2)
    v_cvt_pk_bf16_f32 v61, v94, v95
    v_mul_f32 v64, 0x3eb8aa3b, v30
    v_mfma_f32_16x16x32_bf16 v[108:111], a[80:83], v[76:79], v[108:111]
    ds_read_b128 v[88:91], v1 offset:23552
    buffer_load_dwordx4 v33, s[32:35], s93 offen offset:2048 sc1 lds
    v_mfma_f32_16x16x32_bf16 v[104:107], a[16:19], v[76:79], v[104:107]
    v_fma_f32 v100, v38, v8, v100
    v_fma_f32 v101, v39, v8, v101
    v_mfma_f32_16x16x32_bf16 v[112:115], v[76:79], a[144:147], v[112:115]
    s_waitcnt lgkmcnt(2)
    v_fma_f32 v102, v40, v8, v102
    v_fma_f32 v103, v41, v8, v103
    v_mfma_f32_16x16x32_bf16 v[108:111], a[84:87], v[80:83], v[108:111]
    ds_read_b128 v[76:79], v1 offset:24576
    v_mul_f32 v100, v34, v100
    v_mfma_f32_16x16x32_bf16 v[104:107], a[20:23], v[80:83], v[104:107]
    buffer_load_dwordx4 v33, s[32:35], s93 offen offset:3072 sc1 lds
    v_mul_f32 v101, v35, v101
    v_mfma_f32_16x16x32_bf16 v[112:115], v[80:83], a[148:151], v[112:115]
    s_waitcnt lgkmcnt(2)
    v_mul_f32 v102, v36, v102
    v_mul_f32 v103, v37, v103
    v_mfma_f32_16x16x32_bf16 v[108:111], a[88:91], v[84:87], v[108:111]
    ds_read_b128 v[80:83], v1 offset:25600
    v_cvt_pk_bf16_f32 v52, v100, v101
    v_mfma_f32_16x16x32_bf16 v[104:107], a[24:27], v[84:87], v[104:107]
    s_xor_b32 m0, s70, 16384
    v_cvt_pk_bf16_f32 v53, v102, v103
    v_mfma_f32_16x16x32_bf16 v[112:115], v[84:87], a[152:155], v[112:115]
    s_waitcnt lgkmcnt(2)
    v_mfma_f32_16x16x32_bf16 v[108:111], a[92:95], v[88:91], v[108:111]
    ds_read_b128 v[84:87], v1 offset:26624
    v_mfma_f32_16x16x32_bf16 v[104:107], a[28:31], v[88:91], v[104:107]
    s_xor_b32 s92, s71, 131072
    v_mfma_f32_16x16x32_bf16 v[112:115], v[88:91], a[156:159], v[112:115]
    s_waitcnt lgkmcnt(2)
    v_mfma_f32_16x16x32_bf16 v[108:111], a[96:99], v[76:79], v[108:111]
    ds_read_b128 v[88:91], v1 offset:27648
    v_mfma_f32_16x16x32_bf16 v[104:107], a[32:35], v[76:79], v[104:107]
    v_mfma_f32_16x16x32_bf16 v[112:115], v[76:79], a[160:163], v[112:115]
    s_waitcnt lgkmcnt(2)
    v_mfma_f32_16x16x32_bf16 v[108:111], a[100:103], v[80:83], v[108:111]
    ds_read_b128 v[76:79], v1 offset:28672
    ds_read_b32 v32, v42 offset:384
    buffer_load_dwordx4 v20, s[16:19], s92 offen lds
    v_mfma_f32_16x16x32_bf16 v[104:107], a[36:39], v[80:83], v[104:107]
    s_xor_b32 m0, s70, 20480
    v_mfma_f32_16x16x32_bf16 v[112:115], v[80:83], a[164:167], v[112:115]
    s_waitcnt lgkmcnt(3)
    v_mfma_f32_16x16x32_bf16 v[108:111], a[104:107], v[84:87], v[108:111]
    ds_read_b128 v[80:83], v1 offset:29696
    ds_read_b32 v30, v42 offset:64
    v_mfma_f32_16x16x32_bf16 v[104:107], a[40:43], v[84:87], v[104:107]
    s_xor_b32 s92, s71, 163840
    v_mfma_f32_16x16x32_bf16 v[112:115], v[84:87], a[168:171], v[112:115]
    s_waitcnt lgkmcnt(4)
    v_mfma_f32_16x16x32_bf16 v[108:111], a[108:111], v[88:91], v[108:111]
    ds_read_b128 v[84:87], v1 offset:30720
    ds_read_b128 v[38:41], v43 offset:384
    buffer_load_dwordx4 v20, s[16:19], s92 offen lds
    v_mfma_f32_16x16x32_bf16 v[104:107], a[44:47], v[88:91], v[104:107]
    s_xor_b32 m0, s70, 24576
    v_mfma_f32_16x16x32_bf16 v[112:115], v[88:91], a[172:175], v[112:115]
    s_waitcnt lgkmcnt(5)
    v_mfma_f32_16x16x32_bf16 v[108:111], a[112:115], v[76:79], v[108:111]
    ds_read_b128 v[88:91], v1 offset:31744
    ds_read_b128 v[34:37], v43 offset:64
    v_mfma_f32_16x16x32_bf16 v[104:107], a[48:51], v[76:79], v[104:107]
    s_xor_b32 s92, s71, 196608
    v_mfma_f32_16x16x32_bf16 v[112:115], v[76:79], a[176:179], v[112:115]
    s_waitcnt lgkmcnt(5)
    v_mfma_f32_16x16x32_bf16 v[108:111], a[116:119], v[80:83], v[108:111]
    s_waitcnt vmcnt(7)
    s_barrier
    ds_read_b128 v[76:79], v1 offset:32768
    v_mfma_f32_16x16x32_bf16 v[104:107], a[52:55], v[80:83], v[104:107]
    buffer_load_dwordx4 v20, s[16:19], s92 offen lds
    v_mfma_f32_16x16x32_bf16 v[112:115], v[80:83], a[180:183], v[112:115]
    s_waitcnt lgkmcnt(4)
    v_mfma_f32_16x16x32_bf16 v[108:111], a[120:123], v[84:87], v[108:111]
    ds_read_b128 v[80:83], v1 offset:33792
    v_mfma_f32_16x16x32_bf16 v[104:107], a[56:59], v[84:87], v[104:107]
    v_mfma_f32_16x16x32_bf16 v[112:115], v[84:87], a[184:187], v[112:115]
    s_waitcnt lgkmcnt(3)
    v_mfma_f32_16x16x32_bf16 v[108:111], a[124:127], v[88:91], v[108:111]
    ds_read_b128 v[84:87], v1 offset:34816
    v_mfma_f32_16x16x32_bf16 v[104:107], a[60:63], v[88:91], v[104:107]
    s_waitcnt vmcnt(7)
    v_cmp_ne_u32 vcc, s86, v21
    s_nop 0
    s_cbranch_vccnz L_spin_36
L_ok_37:
    v_mfma_f32_16x16x32_bf16 v[112:115], v[88:91], a[188:191], v[112:115]
    s_waitcnt lgkmcnt(2)
    v_mfma_f32_16x16x32_bf16 v[96:99], a[64:67], v[76:79], 0
    ds_read_b128 v[88:91], v1 offset:35840
    v_fma_f32 v108, v32, v10, v108
    v_fma_f32 v109, v32, v11, v109
    v_mfma_f32_16x16x32_bf16 v[92:95], a[0:3], v[76:79], 0
    v_fma_f32 v110, v32, v12, v110
    v_fma_f32 v111, v32, v13, v111
    v_mfma_f32_16x16x32_bf16 v[100:103], v[76:79], a[128:131], 0
    s_waitcnt lgkmcnt(2)
    v_mul_f32 v108, v30, v108
    v_mul_f32 v109, v30, v109
    v_mfma_f32_16x16x32_bf16 v[96:99], a[68:71], v[80:83], v[96:99]
    ds_read_b128 v[76:79], v1 offset:36864
    v_mul_f32 v110, v30, v110
    v_mfma_f32_16x16x32_bf16 v[92:95], a[4:7], v[80:83], v[92:95]
    v_mul_f32 v111, v30, v111
    v_cvt_pk_bf16_f32 v46, v108, v109
    v_mfma_f32_16x16x32_bf16 v[100:103], v[80:83], a[132:135], v[100:103]
    s_waitcnt lgkmcnt(2)
    v_cvt_pk_bf16_f32 v47, v110, v111
    v_fma_f32 v104, v32, v4, v104
    v_mfma_f32_16x16x32_bf16 v[96:99], a[72:75], v[84:87], v[96:99]
    ds_read_b128 v[80:83], v1 offset:37888
    buffer_load_dwordx4 v[120:123], v1, s[32:35], s84 offen sc1
    v_fma_f32 v105, v32, v5, v105
    v_mfma_f32_16x16x32_bf16 v[92:95], a[8:11], v[84:87], v[92:95]
    s_add_u32 m0, s68, 139264
    v_fma_f32 v106, v32, v6, v106
    v_fma_f32 v107, v32, v7, v107
    v_mfma_f32_16x16x32_bf16 v[100:103], v[84:87], a[136:139], v[100:103]
    s_waitcnt lgkmcnt(2)
    v_cvt_pk_bf16_f32 v62, v104, v105
    v_cvt_pk_bf16_f32 v63, v106, v107
    v_mfma_f32_16x16x32_bf16 v[96:99], a[76:79], v[88:91], v[96:99]
    ds_read_b128 v[84:87], v1 offset:38912
    buffer_load_dwordx4 v31, s[32:35], s83 offen offset:0 sc1 lds
    v_mfma_f32_16x16x32_bf16 v[92:95], a[12:15], v[88:91], v[92:95]
    v_mul_f32 v3, 0x3eb8aa3b, v30
    v_mfma_f32_16x16x16_bf16 v[104:107], v[44:45], v[62:63], v[14:17]
    v_mfma_f32_16x16x16_bf16 v[108:111], v[46:47], v[62:63], v[22:25]
    v_fma_f32 v112, v38, v8, v112
    v_fma_f32 v113, v39, v8, v113
    v_mfma_f32_16x16x32_bf16 v[100:103], v[88:91], a[140:143], v[100:103]
    s_waitcnt lgkmcnt(2)
    v_fma_f32 v114, v40, v8, v114
    v_fma_f32 v115, v41, v8, v115
    v_mfma_f32_16x16x32_bf16 v[96:99], a[80:83], v[76:79], v[96:99]
    ds_read_b128 v[88:91], v1 offset:39936
    buffer_load_dwordx4 v31, s[32:35], s83 offen offset:1024 sc1 lds
    v_mfma_f32_16x16x32_bf16 v[92:95], a[16:19], v[76:79], v[92:95]
    v_max3_f32 v66, v104, v105, v106
    v_max3_f32 v67, v107, v108, v109
    v_mfma_f32_16x16x32_bf16 v[100:103], v[76:79], a[144:147], v[100:103]
    s_waitcnt lgkmcnt(2)
    v_max3_f32 v66, v66, v110, v111
    v_max_f32 v66, v66, v67
    v_mfma_f32_16x16x32_bf16 v[96:99], a[84:87], v[80:83], v[96:99]
    ds_read_b128 v[76:79], v1 offset:40960
    buffer_load_dwordx4 v33, s[32:35], s85 offen offset:2048 sc1 lds
    v_mov_b32 v67, v66
    v_mfma_f32_16x16x32_bf16 v[92:95], a[20:23], v[80:83], v[92:95]
    v_mul_f32 v112, v34, v112
    v_permlane32_swap_b32 v66, v67
    v_mfma_f32_16x16x32_bf16 v[100:103], v[80:83], a[148:151], v[100:103]
    s_waitcnt lgkmcnt(2)
    v_max_f32 v66, v66, v67
    v_mov_b32 v67, v66
    v_mfma_f32_16x16x32_bf16 v[96:99], a[88:91], v[84:87], v[96:99]
    ds_read_b128 v[80:83], v1 offset:41984
    buffer_load_dwordx4 v33, s[32:35], s85 offen offset:3072 sc1 lds
    v_mfma_f32_16x16x32_bf16 v[92:95], a[24:27], v[84:87], v[92:95]
    v_permlane16_swap_b32 v66, v67
    v_mfma_f32_16x16x32_bf16 v[100:103], v[84:87], a[152:155], v[100:103]
    s_waitcnt lgkmcnt(2)
    v_max_f32 v66, v66, v67
    v_mul_f32_e64 v66, -v66, v3
    v_add_u32 v31, 139264, v1
    v_mfma_f32_16x16x32_bf16 v[96:99], a[92:95], v[88:91], v[96:99]
    ds_read_b128 v[84:87], v1 offset:43008
    v_fma_f32 v104, v104, v3, v66
    v_mfma_f32_16x16x32_bf16 v[92:95], a[28:31], v[88:91], v[92:95]
    s_xor_b32 m0, s70, 28672
    v_fma_f32 v105, v105, v3, v66
    v_fma_f32 v106, v106, v3, v66
    v_mfma_f32_16x16x32_bf16 v[100:103], v[88:91], a[156:159], v[100:103]
    s_waitcnt lgkmcnt(2)
    v_fma_f32 v107, v107, v3, v66
    v_fma_f32 v108, v108, v3, v66
    v_mfma_f32_16x16x32_bf16 v[96:99], a[96:99], v[76:79], v[96:99]
    ds_read_b128 v[88:91], v1 offset:44032
    v_fma_f32 v109, v109, v3, v66
    v_mfma_f32_16x16x32_bf16 v[92:95], a[32:35], v[76:79], v[92:95]
    s_xor_b32 s92, s71, 229376
    v_fma_f32 v110, v110, v3, v66
    v_fma_f32 v111, v111, v3, v66
    v_mfma_f32_16x16x32_bf16 v[100:103], v[76:79], a[160:163], v[100:103]
    s_waitcnt lgkmcnt(2)
    v_exp_f32 v104, v104
    v_mul_f32 v113, v35, v113
    v_mfma_f32_16x16x32_bf16 v[96:99], a[100:103], v[80:83], v[96:99]
    ds_read_b128 v[76:79], v1 offset:45056
    buffer_load_dwordx4 v20, s[16:19], s92 offen lds
    v_exp_f32 v105, v105
    v_mul_f32 v114, v36, v114
    v_mfma_f32_16x16x32_bf16 v[92:95], a[36:39], v[80:83], v[92:95]
    s_xor_b32 m0, s70, 32768
    v_exp_f32 v106, v106
    v_mfma_f32_16x16x32_bf16 v[100:103], v[80:83], a[164:167], v[100:103]
    s_waitcnt lgkmcnt(2)
    v_exp_f32 v107, v107
    v_mul_f32 v115, v37, v115
    v_mfma_f32_16x16x32_bf16 v[96:99], a[104:107], v[84:87], v[96:99]
    ds_read_b128 v[80:83], v1 offset:46080
    v_cvt_pk_bf16_f32 v54, v112, v113
    v_mfma_f32_16x16x32_bf16 v[92:95], a[40:43], v[84:87], v[92:95]
    s_xor_b32 s92, s71, 262144
    v_exp_f32 v108, v108
    v_cvt_pk_bf16_f32 v55, v114, v115
    v_mfma_f32_16x16x32_bf16 v[100:103], v[84:87], a[168:171], v[100:103]
    s_waitcnt lgkmcnt(2)
    v_exp_f32 v109, v109
    v_mfma_f32_16x16x32_bf16 v[96:99], a[108:111], v[88:91], v[96:99]
    ds_read_b128 v[84:87], v1 offset:47104
    ds_read_b32 v32, v42 offset:448
    ds_read_b32 v30, v42 offset:128
    ds_read_b128 v[38:41], v43 offset:448
    buffer_load_dwordx4 v20, s[16:19], s92 offen lds
    v_mfma_f32_16x16x32_bf16 v[92:95], a[44:47], v[88:91], v[92:95]
    s_xor_b32 m0, s70, 36864
    v_exp_f32 v110, v110
    v_mfma_f32_16x16x32_bf16 v[100:103], v[88:91], a[172:175], v[100:103]
    s_waitcnt lgkmcnt(5)
    v_exp_f32 v111, v111
    v_mfma_f32_16x16x32_bf16 v[96:99], a[112:115], v[76:79], v[96:99]
    ds_read_b128 v[88:91], v1 offset:48128
    ds_read_b128 v[34:37], v43 offset:128
    v_cvt_pk_bf16_f32 v116, v104, v105
    v_mfma_f32_16x16x32_bf16 v[92:95], a[48:51], v[76:79], v[92:95]
    s_xor_b32 s92, s71, 294912
    v_cvt_pk_bf16_f32 v117, v106, v107
    v_cvt_pk_bf16_f32 v118, v108, v109
    v_mfma_f32_16x16x32_bf16 v[100:103], v[76:79], a[176:179], v[100:103]
    s_waitcnt lgkmcnt(6)
    v_cvt_pk_bf16_f32 v119, v110, v111
    v_mfma_f32_16x16x32_bf16 v[96:99], a[116:119], v[80:83], v[96:99]
    s_waitcnt vmcnt(10)
    s_barrier
    ds_read_b128 v[76:79], v1 offset:49152
    buffer_load_dwordx4 v20, s[16:19], s92 offen lds
    v_mfma_f32_16x16x32_bf16 v[104:107], v[26:29], v[116:119], 0
    s_xor_b32 m0, s70, 40960
    v_mfma_f32_16x16x32_bf16 v[108:111], v[52:55], v[116:119], 0
    s_xor_b32 s92, s71, 327680
    v_mfma_f32_16x16x32_bf16 v[92:95], a[52:55], v[80:83], v[92:95]
    v_mfma_f32_16x16x32_bf16 v[100:103], v[80:83], a[180:183], v[100:103]
    s_waitcnt lgkmcnt(6)
    v_mfma_f32_16x16x32_bf16 v[96:99], a[120:123], v[84:87], v[96:99]
    ds_read_b128 v[80:83], v1 offset:50176
    v_mfma_f32_16x16x32_bf16 v[92:95], a[56:59], v[84:87], v[92:95]
    v_rcp_f32 v66, v104
    v_mfma_f32_16x16x32_bf16 v[100:103], v[84:87], a[184:187], v[100:103]
    s_waitcnt lgkmcnt(3)
    v_mul_f32 v108, v66, v108
    v_mul_f32 v109, v66, v109
    v_mul_f32 v110, v66, v110
    v_mfma_f32_16x16x32_bf16 v[96:99], a[124:127], v[88:91], v[96:99]
    ds_read_b128 v[84:87], v1 offset:51200
    buffer_load_dwordx4 v20, s[16:19], s92 offen lds
    v_mul_f32 v111, v66, v111
    v_cvt_pk_bf16_f32 v70, v108, v109
    v_mfma_f32_16x16x32_bf16 v[92:95], a[60:63], v[88:91], v[92:95]
    s_xor_b32 m0, s70, 45056
    v_cvt_pk_bf16_f32 v71, v110, v111
    v_mfma_f32_16x16x32_bf16 v[100:103], v[88:91], a[188:191], v[100:103]
    s_waitcnt lgkmcnt(2)
    v_fma_f32 v96, v32, v10, v96
    v_fma_f32 v97, v32, v11, v97
    v_mfma_f32_16x16x32_bf16 v[108:111], a[64:67], v[76:79], 0
    ds_read_b128 v[88:91], v1 offset:52224
    v_fma_f32 v98, v32, v12, v98
    v_mfma_f32_16x16x32_bf16 v[104:107], a[0:3], v[76:79], 0
    s_xor_b32 s92, s71, 360448
    v_fma_f32 v99, v32, v13, v99
    v_mul_f32 v96, v30, v96
    v_mfma_f32_16x16x32_bf16 v[112:115], v[76:79], a[128:131], 0
    s_waitcnt lgkmcnt(2)
    v_mul_f32 v97, v30, v97
    v_mul_f32 v98, v30, v98
    v_mfma_f32_16x16x32_bf16 v[108:111], a[68:71], v[80:83], v[108:111]
    ds_read_b128 v[76:79], v1 offset:53248
    buffer_load_dwordx4 v20, s[16:19], s92 offen lds
    v_mfma_f32_16x16x32_bf16 v[104:107], a[4:7], v[80:83], v[104:107]
    s_xor_b32 m0, s70, 49152
    v_mul_f32 v99, v30, v99
    v_cvt_pk_bf16_f32 v48, v96, v97
    v_mfma_f32_16x16x32_bf16 v[112:115], v[80:83], a[132:135], v[112:115]
    s_waitcnt lgkmcnt(2)
    v_cvt_pk_bf16_f32 v49, v98, v99
    v_fma_f32 v92, v32, v4, v92
    v_mfma_f32_16x16x32_bf16 v[108:111], a[72:75], v[84:87], v[108:111]
    ds_read_b128 v[80:83], v1 offset:54272
    v_fma_f32 v93, v32, v5, v93
    v_add_u32 v2, 256, v42
    s_waitcnt vmcnt(9)
    v_add_f32 v120, v120, v122
    v_mfma_f32_16x16x32_bf16 v[104:107], a[8:11], v[84:87], v[104:107]
    s_xor_b32 s92, s71, 393216
    v_fma_f32 v94, v32, v6, v94
    v_fma_f32 v95, v32, v7, v95
    v_add_f32 v121, v121, v123
    v_mfma_f32_16x16x32_bf16 v[112:115], v[84:87], a[136:139], v[112:115]
    s_waitcnt lgkmcnt(2)
    v_cvt_pk_bf16_f32 v62, v92, v93
    v_cvt_pk_bf16_f32 v63, v94, v95
    v_permlane32_swap_b32 v120, v121
    v_mfma_f32_16x16x32_bf16 v[108:111], a[76:79], v[88:91], v[108:111]
    ds_read_b128 v[84:87], v1 offset:55296
    v_mul_f32 v3, 0x3eb8aa3b, v30
    v_mfma_f32_16x16x16_bf16 v[92:95], v[46:47], v[62:63], v[14:17]
    v_mfma_f32_16x16x16_bf16 v[96:99], v[48:49], v[62:63], v[22:25]
    v_fma_f32 v100, v38, v8, v100
    v_fma_f32 v101, v39, v8, v101
    v_mfma_f32_16x16x32_bf16 v[104:107], a[12:15], v[88:91], v[104:107]
    buffer_load_dwordx4 v20, s[16:19], s92 offen lds
    v_fma_f32 v102, v40, v8, v102
    v_add_f32 v120, v120, v121
    v_mfma_f32_16x16x32_bf16 v[112:115], v[88:91], a[140:143], v[112:115]
    s_waitcnt lgkmcnt(2)
    v_max3_f32 v66, v92, v93, v94
    v_max3_f32 v67, v95, v96, v97
    v_mov_b32 v121, v120
    v_mfma_f32_16x16x32_bf16 v[108:111], a[80:83], v[76:79], v[108:111]
    ds_read_b128 v[88:91], v1 offset:56320
    v_max3_f32 v66, v66, v98, v99
    v_permlane16_swap_b32 v120, v121
    v_mfma_f32_16x16x32_bf16 v[104:107], a[16:19], v[76:79], v[104:107]
    s_xor_b32 m0, s70, 53248
    v_max_f32 v66, v66, v67
    v_mov_b32 v67, v66
    v_mfma_f32_16x16x32_bf16 v[112:115], v[76:79], a[144:147], v[112:115]
    s_waitcnt lgkmcnt(2)
    v_fma_f32 v103, v41, v8, v103
    v_mul_f32 v100, v34, v100
    v_add_f32 v120, v120, v121
    v_mfma_f32_16x16x32_bf16 v[108:111], a[84:87], v[80:83], v[108:111]
    ds_read_b128 v[76:79], v1 offset:57344
    v_mul_f32 v101, v35, v101
    v_mov_b32 v121, v120
    v_mfma_f32_16x16x32_bf16 v[104:107], a[20:23], v[80:83], v[104:107]
    s_xor_b32 s92, s71, 425984
    v_permlane32_swap_b32 v66, v67
    v_permlane32_swap_b32 v120, v121
    v_mfma_f32_16x16x32_bf16 v[112:115], v[80:83], a[148:151], v[112:115]
    s_waitcnt lgkmcnt(2)
    v_max_f32 v66, v66, v67
    v_mov_b32 v67, v66
    v_mul_f32 v120, 0xbb000000, v120
    v_mfma_f32_16x16x32_bf16 v[108:111], a[88:91], v[84:87], v[108:111]
    ds_read_b128 v[80:83], v1 offset:58368
    buffer_load_dwordx4 v20, s[16:19], s92 offen lds
    v_mul_f32 v121, 0x3b000000, v121
    v_mfma_f32_16x16x32_bf16 v[104:107], a[24:27], v[84:87], v[104:107]
    s_xor_b32 m0, s70, 57344
    v_permlane16_swap_b32 v66, v67
    v_fma_f32 v121, -v120, v120, v121
    v_mfma_f32_16x16x32_bf16 v[112:115], v[84:87], a[152:155], v[112:115]
    s_waitcnt lgkmcnt(2)
    v_max_f32 v66, v66, v67
    v_mul_f32_e64 v66, -v66, v3
    v_max_f32 v121, 0, v121
    v_mfma_f32_16x16x32_bf16 v[108:111], a[92:95], v[88:91], v[108:111]
    ds_read_b128 v[84:87], v1 offset:59392
    v_fma_f32 v92, v92, v3, v66
    v_add_f32 v121, 0x3727c5ac, v121
    v_mfma_f32_16x16x32_bf16 v[104:107], a[28:31], v[88:91], v[104:107]
    s_xor_b32 s92, s71, 458752
    v_fma_f32 v93, v93, v3, v66
    v_fma_f32 v94, v94, v3, v66
    v_rsq_f32 v121, v121
    v_mfma_f32_16x16x32_bf16 v[112:115], v[88:91], a[156:159], v[112:115]
    s_waitcnt lgkmcnt(2)
    v_fma_f32 v95, v95, v3, v66
    v_fma_f32 v96, v96, v3, v66
    v_mfma_f32_16x16x32_bf16 v[108:111], a[96:99], v[76:79], v[108:111]
    ds_read_b128 v[88:91], v1 offset:60416
    buffer_load_dwordx4 v20, s[16:19], s92 offen lds
    ds_write_b32 v2, v120 offset:320
    ds_write_b32 v2, v121 offset:0
    v_fma_f32 v97, v97, v3, v66
    v_mfma_f32_16x16x32_bf16 v[104:107], a[32:35], v[76:79], v[104:107]
    s_xor_b32 m0, s70, 61440
    v_fma_f32 v98, v98, v3, v66
    v_fma_f32 v99, v99, v3, v66
    v_mfma_f32_16x16x32_bf16 v[112:115], v[76:79], a[160:163], v[112:115]
    s_waitcnt lgkmcnt(4)
    v_exp_f32 v92, v92
    v_mfma_f32_16x16x32_bf16 v[108:111], a[100:103], v[80:83], v[108:111]
    ds_read_b128 v[76:79], v1 offset:61440
    v_exp_f32 v93, v93
    v_mul_f32 v102, v36, v102
    v_mfma_f32_16x16x32_bf16 v[104:107], a[36:39], v[80:83], v[104:107]
    s_xor_b32 s92, s71, 491520
    v_exp_f32 v94, v94
    v_mfma_f32_16x16x32_bf16 v[112:115], v[80:83], a[164:167], v[112:115]
    s_waitcnt lgkmcnt(4)
    v_exp_f32 v95, v95
    v_mul_f32 v103, v37, v103
    v_mfma_f32_16x16x32_bf16 v[108:111], a[104:107], v[84:87], v[108:111]
    ds_read_b128 v[80:83], v1 offset:62464
    buffer_load_dwordx4 v20, s[16:19], s92 offen lds
    v_cvt_pk_bf16_f32 v56, v100, v101
    v_mfma_f32_16x16x32_bf16 v[104:107], a[40:43], v[84:87], v[104:107]
    v_exp_f32 v96, v96
    v_cvt_pk_bf16_f32 v57, v102, v103
    v_mfma_f32_16x16x32_bf16 v[112:115], v[84:87], a[168:171], v[112:115]
    s_waitcnt lgkmcnt(4)
    v_exp_f32 v97, v97
    v_mfma_f32_16x16x32_bf16 v[108:111], a[108:111], v[88:91], v[108:111]
    ds_read_b128 v[84:87], v1 offset:63488
    ds_read_b32 v32, v42 offset:512
    ds_read_b32 v30, v42 offset:192
    ds_read_b128 v[38:41], v43 offset:512
    v_mfma_f32_16x16x32_bf16 v[104:107], a[44:47], v[88:91], v[104:107]
    v_exp_f32 v98, v98
    v_mfma_f32_16x16x32_bf16 v[112:115], v[88:91], a[172:175], v[112:115]
    s_waitcnt lgkmcnt(5)
    v_exp_f32 v99, v99
    v_mfma_f32_16x16x32_bf16 v[108:111], a[112:115], v[76:79], v[108:111]
    ds_read_b128 v[88:91], v1 offset:64512
    ds_read_b128 v[34:37], v43 offset:192
    v_cvt_pk_bf16_f32 v116, v92, v93
    v_mfma_f32_16x16x32_bf16 v[104:107], a[48:51], v[76:79], v[104:107]
    v_cvt_pk_bf16_f32 v117, v94, v95
    v_cvt_pk_bf16_f32 v118, v96, v97
    v_mfma_f32_16x16x32_bf16 v[112:115], v[76:79], a[176:179], v[112:115]
    s_waitcnt lgkmcnt(6)
    v_cvt_pk_bf16_f32 v119, v98, v99
    v_mfma_f32_16x16x32_bf16 v[108:111], a[116:119], v[80:83], v[108:111]
    s_waitcnt vmcnt(9)
    s_barrier
    ds_read_b128 v[76:79], v31 offset:0
    v_mfma_f32_16x16x32_bf16 v[92:95], v[26:29], v[116:119], 0
    v_mfma_f32_16x16x32_bf16 v[96:99], v[54:57], v[116:119], 0
    v_mfma_f32_16x16x32_bf16 v[104:107], a[52:55], v[80:83], v[104:107]
    v_mfma_f32_16x16x32_bf16 v[112:115], v[80:83], a[180:183], v[112:115]
    s_waitcnt lgkmcnt(6)
    v_mfma_f32_16x16x32_bf16 v[108:111], a[120:123], v[84:87], v[108:111]
    ds_read_b128 v[80:83], v31 offset:1024
    v_mfma_f32_16x16x32_bf16 v[104:107], a[56:59], v[84:87], v[104:107]
    v_mfma_f32_16x16x32_bf16 v[112:115], v[84:87], a[184:187], v[112:115]
    s_waitcnt lgkmcnt(3)
    v_mfma_f32_16x16x32_bf16 v[108:111], a[124:127], v[88:91], v[108:111]
    ds_read_b128 v[84:87], v31 offset:2048
    v_rcp_f32 v66, v92
    v_mfma_f32_16x16x32_bf16 v[104:107], a[60:63], v[88:91], v[104:107]
    v_mul_f32 v96, v66, v96
    v_mul_f32 v97, v66, v97
    v_mul_f32 v98, v66, v98
    v_mul_f32 v99, v66, v99
    v_cvt_pk_bf16_f32 v72, v96, v97
    v_cvt_pk_bf16_f32 v73, v98, v99
    v_mfma_f32_16x16x32_bf16 v[112:115], v[88:91], a[188:191], v[112:115]
    s_waitcnt lgkmcnt(2)
    v_fma_f32 v108, v32, v10, v108
    v_fma_f32 v109, v32, v11, v109
    v_mfma_f32_16x16x32_bf16 v[96:99], a[64:67], v[76:79], 0
    ds_read_b128 v[88:91], v31 offset:3072
    v_fma_f32 v110, v32, v12, v110
    v_mfma_f32_16x16x32_bf16 v[100:103], v[76:79], a[128:131], 0
    s_waitcnt lgkmcnt(2)
    v_fma_f32 v111, v32, v13, v111
    v_mul_f32 v108, v30, v108
    v_mul_f32 v109, v30, v109
    v_mfma_f32_16x16x32_bf16 v[96:99], a[68:71], v[80:83], v[96:99]
    ds_read_b128 v[76:79], v31 offset:4096
    v_mul_f32 v110, v30, v110
    v_mul_f32 v111, v30, v111
    v_mfma_f32_16x16x32_bf16 v[100:103], v[80:83], a[132:135], v[100:103]
    s_waitcnt lgkmcnt(2)
    v_cvt_pk_bf16_f32 v46, v108, v109
    v_cvt_pk_bf16_f32 v47, v110, v111
    v_fma_f32 v104, v32, v4, v104
    v_mfma_f32_16x16x32_bf16 v[96:99], a[72:75], v[84:87], v[96:99]
    ds_read_b128 v[80:83], v31 offset:5120
    v_fma_f32 v105, v32, v5, v105
    v_fma_f32 v106, v32, v6, v106
    v_mfma_f32_16x16x32_bf16 v[100:103], v[84:87], a[136:139], v[100:103]
    s_waitcnt lgkmcnt(2)
    v_fma_f32 v107, v32, v7, v107
    v_cvt_pk_bf16_f32 v62, v104, v105
    v_cvt_pk_bf16_f32 v63, v106, v107
    v_mfma_f32_16x16x32_bf16 v[96:99], a[76:79], v[88:91], v[96:99]
    ds_read_b128 v[84:87], v31 offset:6144
    v_mul_f32 v3, 0x3eb8aa3b, v30
    v_mfma_f32_16x16x16_bf16 v[104:107], v[48:49], v[62:63], v[14:17]
    v_mfma_f32_16x16x16_bf16 v[108:111], v[46:47], v[62:63], v[22:25]
    v_fma_f32 v112, v38, v8, v112
    v_fma_f32 v113, v39, v8, v113
    v_mfma_f32_16x16x32_bf16 v[100:103], v[88:91], a[140:143], v[100:103]
    s_waitcnt lgkmcnt(2)
    v_fma_f32 v114, v40, v8, v114
    v_fma_f32 v115, v41, v8, v115
    v_mfma_f32_16x16x32_bf16 v[96:99], a[80:83], v[76:79], v[96:99]
    ds_read_b128 v[88:91], v31 offset:7168
    v_max3_f32 v66, v104, v105, v106
    v_max3_f32 v67, v107, v108, v109
    v_mfma_f32_16x16x32_bf16 v[100:103], v[76:79], a[144:147], v[100:103]
    s_waitcnt lgkmcnt(2)
    v_max3_f32 v66, v66, v110, v111
    v_max_f32 v66, v66, v67
    v_mov_b32 v67, v66
    v_mfma_f32_16x16x32_bf16 v[96:99], a[84:87], v[80:83], v[96:99]
    ds_read_b128 v[76:79], v31 offset:8192
    v_permlane32_swap_b32 v66, v67
    v_mfma_f32_16x16x32_bf16 v[100:103], v[80:83], a[148:151], v[100:103]
    s_waitcnt lgkmcnt(2)
    v_max_f32 v66, v66, v67
    v_mov_b32 v67, v66
    v_mfma_f32_16x16x32_bf16 v[96:99], a[88:91], v[84:87], v[96:99]
    ds_read_b128 v[80:83], v31 offset:9216
    v_permlane16_swap_b32 v66, v67
    v_max_f32 v66, v66, v67
    v_mfma_f32_16x16x32_bf16 v[100:103], v[84:87], a[152:155], v[100:103]
    s_waitcnt lgkmcnt(2)
    v_mul_f32_e64 v66, -v66, v3
    v_fma_f32 v104, v104, v3, v66
    v_fma_f32 v105, v105, v3, v66
    v_mfma_f32_16x16x32_bf16 v[96:99], a[92:95], v[88:91], v[96:99]
    ds_read_b128 v[84:87], v31 offset:10240
    v_fma_f32 v106, v106, v3, v66
    v_fma_f32 v107, v107, v3, v66
    v_mfma_f32_16x16x32_bf16 v[100:103], v[88:91], a[156:159], v[100:103]
    s_waitcnt lgkmcnt(2)
    v_fma_f32 v108, v108, v3, v66
    v_fma_f32 v109, v109, v3, v66
    v_fma_f32 v110, v110, v3, v66
    v_mfma_f32_16x16x32_bf16 v[96:99], a[96:99], v[76:79], v[96:99]
    ds_read_b128 v[88:91], v31 offset:11264
    v_fma_f32 v111, v111, v3, v66
    v_exp_f32 v104, v104
    v_mfma_f32_16x16x32_bf16 v[100:103], v[76:79], a[160:163], v[100:103]
    s_waitcnt lgkmcnt(2)
    v_exp_f32 v105, v105
    v_mfma_f32_16x16x32_bf16 v[96:99], a[100:103], v[80:83], v[96:99]
    ds_read_b128 v[76:79], v31 offset:12288
    v_exp_f32 v106, v106
    v_mfma_f32_16x16x32_bf16 v[100:103], v[80:83], a[164:167], v[100:103]
    s_waitcnt lgkmcnt(2)
    v_exp_f32 v107, v107
    v_exp_f32 v108, v108
    v_mfma_f32_16x16x32_bf16 v[96:99], a[104:107], v[84:87], v[96:99]
    ds_read_b128 v[80:83], v31 offset:13312
    v_exp_f32 v109, v109
    v_mfma_f32_16x16x32_bf16 v[100:103], v[84:87], a[168:171], v[100:103]
    s_waitcnt lgkmcnt(2)
    v_exp_f32 v110, v110
    v_mul_f32 v112, v34, v112
    v_mfma_f32_16x16x32_bf16 v[96:99], a[108:111], v[88:91], v[96:99]
    ds_read_b128 v[84:87], v31 offset:14336
    v_exp_f32 v111, v111
    v_mul_f32 v113, v35, v113
    v_mul_f32 v114, v36, v114
    v_mfma_f32_16x16x32_bf16 v[100:103], v[88:91], a[172:175], v[100:103]
    s_waitcnt lgkmcnt(2)
    v_cvt_pk_bf16_f32 v116, v104, v105
    v_cvt_pk_bf16_f32 v117, v106, v107
    v_cvt_pk_bf16_f32 v118, v108, v109
    v_mul_f32 v115, v37, v115
    v_cvt_pk_bf16_f32 v58, v112, v113
    v_cvt_pk_bf16_f32 v59, v114, v115
    v_mfma_f32_16x16x32_bf16 v[96:99], a[112:115], v[76:79], v[96:99]
    ds_read_b128 v[88:91], v31 offset:15360
    ds_read_b32 v32, v42 offset:576
    ds_read_b32 v30, v42 offset:256
    ds_read_b128 v[38:41], v43 offset:576
    ds_read_b128 v[34:37], v43 offset:256
    v_cvt_pk_bf16_f32 v119, v110, v111
    v_mfma_f32_16x16x32_bf16 v[100:103], v[76:79], a[176:179], v[100:103]
    s_waitcnt lgkmcnt(6)
    v_mfma_f32_16x16x32_bf16 v[96:99], a[116:119], v[80:83], v[96:99]
    v_mfma_f32_16x16x32_bf16 v[104:107], v[26:29], v[116:119], 0
    v_mfma_f32_16x16x32_bf16 v[108:111], v[56:59], v[116:119], 0
    v_mfma_f32_16x16x32_bf16 v[100:103], v[80:83], a[180:183], v[100:103]
    s_waitcnt lgkmcnt(5)
    v_mfma_f32_16x16x32_bf16 v[96:99], a[120:123], v[84:87], v[96:99]
    s_waitcnt vmcnt(0)
    s_barrier
    v_mfma_f32_16x16x32_bf16 v[100:103], v[84:87], a[184:187], v[100:103]
    s_waitcnt lgkmcnt(4)
    v_mfma_f32_16x16x32_bf16 v[96:99], a[124:127], v[88:91], v[96:99]
    v_mfma_f32_16x16x32_bf16 v[100:103], v[88:91], a[188:191], v[100:103]
    v_rcp_f32 v66, v104
    s_nop 0
    v_mul_f32 v108, v66, v108
    v_mul_f32 v109, v66, v109
    v_mul_f32 v110, v66, v110
    v_mul_f32 v111, v66, v111
    v_cvt_pk_bf16_f32 v74, v108, v109
    v_cvt_pk_bf16_f32 v75, v110, v111
    s_nop 0
    v_permlane16_swap_b32 v72, v74
    s_waitcnt lgkmcnt(1)
    v_pk_fma_f32 v[100:101], v[38:39], v[8:9], v[100:101] op_sel_hi:[1,0,1]
    v_permlane16_swap_b32 v73, v75
    v_pk_fma_f32 v[96:97], v[32:33], v[10:11], v[96:97] op_sel_hi:[0,1,1]
    v_pk_fma_f32 v[98:99], v[32:33], v[12:13], v[98:99] op_sel_hi:[0,1,1]
    v_pk_mul_f32 v[96:97], v[30:31], v[96:97] op_sel_hi:[0,1]
    v_pk_mul_f32 v[98:99], v[30:31], v[98:99] op_sel_hi:[0,1]
    v_cvt_pk_bf16_f32 v48, v96, v97
    v_cvt_pk_bf16_f32 v49, v98, v99
    v_min_f32 v14, s77, v14
    v_min_f32 v15, s77, v15
    v_min_f32 v16, s77, v16
    v_min_f32 v17, s77, v17
    v_pk_fma_f32 v[102:103], v[40:41], v[8:9], v[102:103] op_sel_hi:[1,0,1]
    s_waitcnt lgkmcnt(0)
    v_pk_mul_f32 v[100:101], v[34:35], v[100:101]
    v_mfma_f32_16x16x16_bf16 v[92:95], v[48:49], v[60:61], v[14:17]
    v_pk_mul_f32 v[102:103], v[36:37], v[102:103]
    v_cvt_pk_bf16_f32 v50, v100, v101
    v_mfma_f32_16x16x16_bf16 v[96:99], v[44:45], v[60:61], v[22:25]
    v_cvt_pk_bf16_f32 v51, v102, v103
    s_nop 3
    v_max3_f32 v66, v92, v93, v94
    s_nop 1
    v_max3_f32 v67, v95, v96, v97
    v_max3_f32 v66, v66, v98, v99
    v_max_f32 v66, v66, v67
    v_mov_b32 v67, v66
    s_nop 1
    v_permlane32_swap_b32 v66, v67
    v_max_f32 v66, v66, v67
    v_mov_b32 v67, v66
    s_nop 1
    v_permlane16_swap_b32 v66, v67
    v_max_f32 v66, v66, v67
    v_mul_f32_e64 v66, -v66, v64
    v_pk_fma_f32 v[92:93], v[92:93], v[64:65], v[66:67] op_sel_hi:[1,0,0]
    v_pk_fma_f32 v[94:95], v[94:95], v[64:65], v[66:67] op_sel_hi:[1,0,0]
    v_pk_fma_f32 v[96:97], v[96:97], v[64:65], v[66:67] op_sel_hi:[1,0,0]
    v_pk_fma_f32 v[98:99], v[98:99], v[64:65], v[66:67] op_sel_hi:[1,0,0]
    v_exp_f32 v92, v92
    v_exp_f32 v93, v93
    v_exp_f32 v94, v94
    v_exp_f32 v95, v95
    v_exp_f32 v96, v96
    v_exp_f32 v97, v97
    v_exp_f32 v98, v98
    v_exp_f32 v99, v99
    v_cvt_pk_bf16_f32 v116, v92, v93
    v_cvt_pk_bf16_f32 v117, v94, v95
    v_cvt_pk_bf16_f32 v118, v96, v97
    v_cvt_pk_bf16_f32 v119, v98, v99
    s_nop 1
    v_mfma_f32_16x16x32_bf16 v[92:95], v[26:29], v[116:119], 0
    v_mfma_f32_16x16x32_bf16 v[96:99], v[50:53], v[116:119], 0
    s_nop 6
    v_rcp_f32 v66, v92
    s_nop 0
    v_pk_mul_f32 v[96:97], v[66:67], v[96:97] op_sel_hi:[0,1]
    v_pk_mul_f32 v[98:99], v[66:67], v[98:99] op_sel_hi:[0,1]
    v_cvt_pk_bf16_f32 v68, v96, v97
    v_cvt_pk_bf16_f32 v69, v98, v99
    s_nop 0
    v_permlane16_swap_b32 v68, v70
    v_permlane16_swap_b32 v69, v71
    s_add_u32 s76, s46, 2
    v_mov_b32 v2, s76
    s_add_u32 s81, s60, 32768
    s_cmp_eq_u32 s47, 0
    s_cbranch_scc1 L_slow_38
    buffer_store_dwordx4 v[68:71], v0, s[32:35], s60 offen
    buffer_store_dwordx4 v[72:75], v0, s[32:35], s81 offen
L_back_39:
    v_bfe_u32 v31, v1, 7, 2
    v_lshrrev_b32 v21, 8, v1
    v_mul_u32_u24 v21, 1024, v21
    v_lshl_add_u32 v21, v31, 5, v21
    v_bfe_u32 v31, v1, 6, 2
    v_lshl_add_u32 v21, v31, 7, v21
    v_bfe_u32 v31, v1, 4, 2
    v_lshl_add_u32 v21, v31, 3, v21
    v_add_u32 v21, 65536, v21
    v_xor_b32 v31, 32, v21
    v_xor_b32 v33, 64, v21
    v_xor_b32 v65, 96, v21
    ds_read_b64_tr_b16 a[0:1], v21 offset:0
    ds_read_b64_tr_b16 a[2:3], v21 offset:512
    ds_read_b64_tr_b16 a[4:5], v31 offset:0
    ds_read_b64_tr_b16 a[6:7], v31 offset:512
    ds_read_b64_tr_b16 a[8:9], v33 offset:0
    ds_read_b64_tr_b16 a[10:11], v33 offset:512
    ds_read_b64_tr_b16 a[12:13], v65 offset:0
    ds_read_b64_tr_b16 a[14:15], v65 offset:512
    ds_read_b64_tr_b16 a[16:17], v21 offset:4096
    ds_read_b64_tr_b16 a[18:19], v21 offset:4608
    ds_read_b64_tr_b16 a[20:21], v31 offset:4096
    ds_read_b64_tr_b16 a[22:23], v31 offset:4608
    ds_read_b64_tr_b16 a[24:25], v33 offset:4096
    ds_read_b64_tr_b16 a[26:27], v33 offset:4608
    ds_read_b64_tr_b16 a[28:29], v65 offset:4096
    ds_read_b64_tr_b16 a[30:31], v65 offset:4608
    ds_read_b64_tr_b16 a[32:33], v21 offset:8192
    ds_read_b64_tr_b16 a[34:35], v21 offset:8704
    ds_read_b64_tr_b16 a[36:37], v31 offset:8192
    ds_read_b64_tr_b16 a[38:39], v31 offset:8704
    ds_read_b64_tr_b16 a[40:41], v33 offset:8192
    ds_read_b64_tr_b16 a[42:43], v33 offset:8704
    ds_read_b64_tr_b16 a[44:45], v65 offset:8192
    ds_read_b64_tr_b16 a[46:47], v65 offset:8704
    ds_read_b64_tr_b16 a[48:49], v21 offset:12288
    ds_read_b64_tr_b16 a[50:51], v21 offset:12800
    ds_read_b64_tr_b16 a[52:53], v31 offset:12288
    ds_read_b64_tr_b16 a[54:55], v31 offset:12800
    ds_read_b64_tr_b16 a[56:57], v33 offset:12288
    ds_read_b64_tr_b16 a[58:59], v33 offset:12800
    ds_read_b64_tr_b16 a[60:61], v65 offset:12288
    ds_read_b64_tr_b16 a[62:63], v65 offset:12800
    ds_read_b64_tr_b16 a[64:65], v21 offset:16384
    ds_read_b64_tr_b16 a[66:67], v21 offset:16896
    ds_read_b64_tr_b16 a[68:69], v31 offset:16384
    ds_read_b64_tr_b16 a[70:71], v31 offset:16896
    ds_read_b64_tr_b16 a[72:73], v33 offset:16384
    ds_read_b64_tr_b16 a[74:75], v33 offset:16896
    ds_read_b64_tr_b16 a[76:77], v65 offset:16384
    ds_read_b64_tr_b16 a[78:79], v65 offset:16896
    ds_read_b64_tr_b16 a[80:81], v21 offset:20480
    ds_read_b64_tr_b16 a[82:83], v21 offset:20992
    ds_read_b64_tr_b16 a[84:85], v31 offset:20480
    ds_read_b64_tr_b16 a[86:87], v31 offset:20992
    ds_read_b64_tr_b16 a[88:89], v33 offset:20480
    ds_read_b64_tr_b16 a[90:91], v33 offset:20992
    ds_read_b64_tr_b16 a[92:93], v65 offset:20480
    ds_read_b64_tr_b16 a[94:95], v65 offset:20992
    s_waitcnt vmcnt(0)
    s_barrier
    s_cmp_eq_u32 s47, 0
    s_cbranch_scc1 L_slow_40
    buffer_store_dword v2, v9, s[32:35], s67 offen offset:0
L_back_41:
    s_lshl_b32 s80, s40, 11
    s_add_u32 s80, s80, 131072
    v_add_u32 v0, s80, v1
    ds_read_b128 v[116:119], v0 offset:0
    ds_read_b128 v[120:123], v0 offset:1024
    ds_read_b64_tr_b16 a[96:97], v21 offset:24576
    ds_read_b64_tr_b16 a[98:99], v21 offset:25088
    ds_read_b64_tr_b16 a[100:101], v31 offset:24576
    ds_read_b64_tr_b16 a[102:103], v31 offset:25088
    ds_read_b64_tr_b16 a[104:105], v33 offset:24576
    ds_read_b64_tr_b16 a[106:107], v33 offset:25088
    ds_read_b64_tr_b16 a[108:109], v65 offset:24576
    ds_read_b64_tr_b16 a[110:111], v65 offset:25088
    ds_read_b64_tr_b16 a[112:113], v21 offset:28672
    ds_read_b64_tr_b16 a[114:115], v21 offset:29184
    ds_read_b64_tr_b16 a[116:117], v31 offset:28672
    ds_read_b64_tr_b16 a[118:119], v31 offset:29184
    ds_read_b64_tr_b16 a[120:121], v33 offset:28672
    ds_read_b64_tr_b16 a[122:123], v33 offset:29184
    ds_read_b64_tr_b16 a[124:125], v65 offset:28672
    ds_read_b64_tr_b16 a[126:127], v65 offset:29184
    s_waitcnt lgkmcnt(15)
    v_lshlrev_b32 v98, 16, v116
    v_and_b32 v99, 0xffff0000, v116
    v_lshlrev_b32 v100, 16, v117
    v_and_b32 v101, 0xffff0000, v117
    v_lshlrev_b32 v102, 16, v118
    v_and_b32 v103, 0xffff0000, v118
    v_lshlrev_b32 v104, 16, v119
    v_and_b32 v105, 0xffff0000, v119
    v_lshlrev_b32 v106, 16, v120
    v_and_b32 v107, 0xffff0000, v120
    v_lshlrev_b32 v108, 16, v121
    v_and_b32 v109, 0xffff0000, v121
    v_lshlrev_b32 v110, 16, v122
    v_and_b32 v111, 0xffff0000, v122
    v_lshlrev_b32 v112, 16, v123
    v_and_b32 v113, 0xffff0000, v123
    v_and_b32 v6, 0xf0, v1
    v_lshrrev_b32 v7, 9, v1
    v_lshl_or_b32 v6, v7, 8, v6
    v_bfe_u32 v7, v1, 8, 1
    v_lshl_or_b32 v6, v7, 9, v6
    s_mov_b32 s80, 0xf0
    v_lshrrev_b32 v7, 9, v1
    v_lshlrev_b32 v7, 2, v7
    v_and_or_b32 v7, v1, s80, v7
    v_bfe_u32 v8, v1, 4, 3
    v_lshlrev_b32 v8, 2, v8
    s_add_u32 s85, s61, 4096
    s_add_u32 s86, s61, 8192
    s_add_u32 s87, s61, 12288
L_poll_42:
    buffer_load_dword v30, v8, s[32:35], s66 offen offset:0 sc1
    s_sub_u32 s48, s48, 1
    s_max_i32 s48, s48, 0
    s_cmp_lg_u32 s48, 0
    s_cselect_b64 s[94:95], -1, 0
    s_waitcnt vmcnt(0)
    v_cmp_ne_u32 vcc, s76, v30
    s_nop 0
    s_and_b64 vcc, vcc, s[94:95]
    s_cbranch_scc1 L_poll_42
    s_barrier
    buffer_load_dwordx4 a[128:131], v1, s[32:35], s61 offen offset:0 sc1
    buffer_load_dwordx4 a[132:135], v1, s[32:35], s61 offen offset:1024 sc1
    buffer_load_dwordx4 a[136:139], v1, s[32:35], s61 offen offset:2048 sc1
    buffer_load_dwordx4 a[140:143], v1, s[32:35], s61 offen offset:3072 sc1
    buffer_load_dwordx4 a[144:147], v1, s[32:35], s85 offen offset:0 sc1
    buffer_load_dwordx4 a[148:151], v1, s[32:35], s85 offen offset:1024 sc1
    buffer_load_dwordx4 a[152:155], v1, s[32:35], s85 offen offset:2048 sc1
    buffer_load_dwordx4 a[156:159], v1, s[32:35], s85 offen offset:3072 sc1
    ds_read_b64_tr_b16 v[2:3], v21 offset:32768
    ds_read_b64_tr_b16 v[4:5], v21 offset:33280
    ds_read_b64_tr_b16 v[10:11], v31 offset:32768
    ds_read_b64_tr_b16 v[12:13], v31 offset:33280
    ds_read_b64_tr_b16 v[14:15], v33 offset:32768
    ds_read_b64_tr_b16 v[16:17], v33 offset:33280
    ds_read_b64_tr_b16 v[22:23], v65 offset:32768
    ds_read_b64_tr_b16 v[24:25], v65 offset:33280
    ds_read_b64_tr_b16 v[26:27], v21 offset:36864
    ds_read_b64_tr_b16 v[28:29], v21 offset:37376
    ds_read_b64_tr_b16 v[34:35], v31 offset:36864
    ds_read_b64_tr_b16 v[36:37], v31 offset:37376
    ds_read_b64_tr_b16 v[38:39], v33 offset:36864
    ds_read_b64_tr_b16 v[40:41], v33 offset:37376
    ds_read_b64_tr_b16 v[42:43], v65 offset:36864
    ds_read_b64_tr_b16 v[44:45], v65 offset:37376
    ds_read_b64_tr_b16 v[46:47], v21 offset:40960
    ds_read_b64_tr_b16 v[48:49], v21 offset:41472
    ds_read_b64_tr_b16 v[50:51], v31 offset:40960
    ds_read_b64_tr_b16 v[52:53], v31 offset:41472
    ds_read_b64_tr_b16 v[54:55], v33 offset:40960
    ds_read_b64_tr_b16 v[56:57], v33 offset:41472
    ds_read_b64_tr_b16 v[58:59], v65 offset:40960
    ds_read_b64_tr_b16 v[60:61], v65 offset:41472
    ds_read_b64_tr_b16 v[66:67], v21 offset:45056
    ds_read_b64_tr_b16 v[68:69], v21 offset:45568
    ds_read_b64_tr_b16 v[70:71], v31 offset:45056
    ds_read_b64_tr_b16 v[72:73], v31 offset:45568
    ds_read_b64_tr_b16 v[74:75], v33 offset:45056
    ds_read_b64_tr_b16 v[76:77], v33 offset:45568
    ds_read_b64_tr_b16 v[78:79], v65 offset:45056
    ds_read_b64_tr_b16 v[80:81], v65 offset:45568
    ds_read_b64_tr_b16 v[82:83], v21 offset:49152
    ds_read_b64_tr_b16 v[84:85], v21 offset:49664
    ds_read_b64_tr_b16 v[86:87], v31 offset:49152
    ds_read_b64_tr_b16 v[88:89], v31 offset:49664
    ds_read_b64_tr_b16 v[90:91], v33 offset:49152
    ds_read_b64_tr_b16 v[92:93], v33 offset:49664
    ds_read_b64_tr_b16 v[94:95], v65 offset:49152
    ds_read_b64_tr_b16 v[96:97], v65 offset:49664
    s_waitcnt vmcnt(7)
    v_mfma_f32_16x16x32_bf16 v[98:101], a[0:3], a[128:131], v[98:101]
    v_mfma_f32_16x16x32_bf16 v[102:105], a[4:7], a[128:131], v[102:105]
    v_mfma_f32_16x16x32_bf16 v[106:109], a[8:11], a[128:131], v[106:109]
    v_mfma_f32_16x16x32_bf16 v[110:113], a[12:15], a[128:131], v[110:113]
    buffer_load_dwordx4 a[160:163], v1, s[32:35], s86 offen offset:0 sc1
    s_waitcnt vmcnt(7)
    v_mfma_f32_16x16x32_bf16 v[98:101], a[16:19], a[132:135], v[98:101]
    v_mfma_f32_16x16x32_bf16 v[102:105], a[20:23], a[132:135], v[102:105]
    v_mfma_f32_16x16x32_bf16 v[106:109], a[24:27], a[132:135], v[106:109]
    v_mfma_f32_16x16x32_bf16 v[110:113], a[28:31], a[132:135], v[110:113]
    buffer_load_dwordx4 a[164:167], v1, s[32:35], s86 offen offset:1024 sc1
    s_waitcnt vmcnt(7)
    v_mfma_f32_16x16x32_bf16 v[98:101], a[32:35], a[136:139], v[98:101]
    v_mfma_f32_16x16x32_bf16 v[102:105], a[36:39], a[136:139], v[102:105]
    v_mfma_f32_16x16x32_bf16 v[106:109], a[40:43], a[136:139], v[106:109]
    v_mfma_f32_16x16x32_bf16 v[110:113], a[44:47], a[136:139], v[110:113]
    buffer_load_dwordx4 a[168:171], v1, s[32:35], s86 offen offset:2048 sc1
    s_waitcnt vmcnt(7)
    v_mfma_f32_16x16x32_bf16 v[98:101], a[48:51], a[140:143], v[98:101]
    v_mfma_f32_16x16x32_bf16 v[102:105], a[52:55], a[140:143], v[102:105]
    v_mfma_f32_16x16x32_bf16 v[106:109], a[56:59], a[140:143], v[106:109]
    v_mfma_f32_16x16x32_bf16 v[110:113], a[60:63], a[140:143], v[110:113]
    buffer_load_dwordx4 a[172:175], v1, s[32:35], s86 offen offset:3072 sc1
    s_waitcnt vmcnt(7)
    v_mfma_f32_16x16x32_bf16 v[98:101], a[64:67], a[144:147], v[98:101]
    v_mfma_f32_16x16x32_bf16 v[102:105], a[68:71], a[144:147], v[102:105]
    v_mfma_f32_16x16x32_bf16 v[106:109], a[72:75], a[144:147], v[106:109]
    v_mfma_f32_16x16x32_bf16 v[110:113], a[76:79], a[144:147], v[110:113]
    buffer_load_dwordx4 a[176:179], v1, s[32:35], s87 offen offset:0 sc1
    s_waitcnt vmcnt(7)
    v_mfma_f32_16x16x32_bf16 v[98:101], a[80:83], a[148:151], v[98:101]
    v_mfma_f32_16x16x32_bf16 v[102:105], a[84:87], a[148:151], v[102:105]
    v_mfma_f32_16x16x32_bf16 v[106:109], a[88:91], a[148:151], v[106:109]
    v_mfma_f32_16x16x32_bf16 v[110:113], a[92:95], a[148:151], v[110:113]
    buffer_load_dwordx4 a[180:183], v1, s[32:35], s87 offen offset:1024 sc1
    s_waitcnt vmcnt(7) lgkmcnt(15)
    v_mfma_f32_16x16x32_bf16 v[98:101], a[96:99], a[152:155], v[98:101]
    v_mfma_f32_16x16x32_bf16 v[102:105], a[100:103], a[152:155], v[102:105]
    v_mfma_f32_16x16x32_bf16 v[106:109], a[104:107], a[152:155], v[106:109]
    v_mfma_f32_16x16x32_bf16 v[110:113], a[108:111], a[152:155], v[110:113]
    buffer_load_dwordx4 a[184:187], v1, s[32:35], s87 offen offset:2048 sc1
    s_waitcnt vmcnt(7)
    v_mfma_f32_16x16x32_bf16 v[98:101], a[112:115], a[156:159], v[98:101]
    v_mfma_f32_16x16x32_bf16 v[102:105], a[116:119], a[156:159], v[102:105]
    v_mfma_f32_16x16x32_bf16 v[106:109], a[120:123], a[156:159], v[106:109]
    v_mfma_f32_16x16x32_bf16 v[110:113], a[124:127], a[156:159], v[110:113]
    buffer_load_dwordx4 a[188:191], v1, s[32:35], s87 offen offset:3072 sc1
    s_waitcnt vmcnt(7)
    v_mfma_f32_16x16x32_bf16 v[98:101], v[2:5], a[160:163], v[98:101]
    ds_read_b64_tr_b16 v[2:3], v21 offset:53248
    ds_read_b64_tr_b16 v[4:5], v21 offset:53760
    v_mfma_f32_16x16x32_bf16 v[102:105], v[10:13], a[160:163], v[102:105]
    ds_read_b64_tr_b16 v[10:11], v31 offset:53248
    ds_read_b64_tr_b16 v[12:13], v31 offset:53760
    v_mfma_f32_16x16x32_bf16 v[106:109], v[14:17], a[160:163], v[106:109]
    ds_read_b64_tr_b16 v[14:15], v33 offset:53248
    ds_read_b64_tr_b16 v[16:17], v33 offset:53760
    v_mfma_f32_16x16x32_bf16 v[110:113], v[22:25], a[160:163], v[110:113]
    ds_read_b64_tr_b16 v[22:23], v65 offset:53248
    ds_read_b64_tr_b16 v[24:25], v65 offset:53760
    s_waitcnt vmcnt(6)
    v_mfma_f32_16x16x32_bf16 v[98:101], v[26:29], a[164:167], v[98:101]
    ds_read_b64_tr_b16 v[26:27], v21 offset:57344
    ds_read_b64_tr_b16 v[28:29], v21 offset:57856
    v_mfma_f32_16x16x32_bf16 v[102:105], v[34:37], a[164:167], v[102:105]
    ds_read_b64_tr_b16 v[34:35], v31 offset:57344
    ds_read_b64_tr_b16 v[36:37], v31 offset:57856
    v_mfma_f32_16x16x32_bf16 v[106:109], v[38:41], a[164:167], v[106:109]
    ds_read_b64_tr_b16 v[38:39], v33 offset:57344
    ds_read_b64_tr_b16 v[40:41], v33 offset:57856
    v_mfma_f32_16x16x32_bf16 v[110:113], v[42:45], a[164:167], v[110:113]
    ds_read_b64_tr_b16 v[42:43], v65 offset:57344
    ds_read_b64_tr_b16 v[44:45], v65 offset:57856
    s_waitcnt vmcnt(5)
    v_mfma_f32_16x16x32_bf16 v[98:101], v[46:49], a[168:171], v[98:101]
    ds_read_b64_tr_b16 v[46:47], v21 offset:61440
    ds_read_b64_tr_b16 v[48:49], v21 offset:61952
    v_mfma_f32_16x16x32_bf16 v[102:105], v[50:53], a[168:171], v[102:105]
    ds_read_b64_tr_b16 v[50:51], v31 offset:61440
    ds_read_b64_tr_b16 v[52:53], v31 offset:61952
    v_mfma_f32_16x16x32_bf16 v[106:109], v[54:57], a[168:171], v[106:109]
    ds_read_b64_tr_b16 v[54:55], v33 offset:61440
    ds_read_b64_tr_b16 v[56:57], v33 offset:61952
    v_mfma_f32_16x16x32_bf16 v[110:113], v[58:61], a[168:171], v[110:113]
    ds_read_b64_tr_b16 v[58:59], v65 offset:61440
    ds_read_b64_tr_b16 v[60:61], v65 offset:61952
    s_waitcnt vmcnt(4) lgkmcnt(15)
    v_mfma_f32_16x16x32_bf16 v[98:101], v[66:69], a[172:175], v[98:101]
    v_mfma_f32_16x16x32_bf16 v[102:105], v[70:73], a[172:175], v[102:105]
    v_mfma_f32_16x16x32_bf16 v[106:109], v[74:77], a[172:175], v[106:109]
    v_mfma_f32_16x16x32_bf16 v[110:113], v[78:81], a[172:175], v[110:113]
    s_waitcnt vmcnt(3)
    v_mfma_f32_16x16x32_bf16 v[98:101], v[82:85], a[176:179], v[98:101]
    v_mfma_f32_16x16x32_bf16 v[102:105], v[86:89], a[176:179], v[102:105]
    v_mfma_f32_16x16x32_bf16 v[106:109], v[90:93], a[176:179], v[106:109]
    v_mfma_f32_16x16x32_bf16 v[110:113], v[94:97], a[176:179], v[110:113]
    s_waitcnt vmcnt(2)
    v_mfma_f32_16x16x32_bf16 v[98:101], v[2:5], a[180:183], v[98:101]
    v_mfma_f32_16x16x32_bf16 v[102:105], v[10:13], a[180:183], v[102:105]
    v_mfma_f32_16x16x32_bf16 v[106:109], v[14:17], a[180:183], v[106:109]
    v_mfma_f32_16x16x32_bf16 v[110:113], v[22:25], a[180:183], v[110:113]
    s_waitcnt vmcnt(1) lgkmcnt(8)
    v_mfma_f32_16x16x32_bf16 v[98:101], v[26:29], a[184:187], v[98:101]
    v_mfma_f32_16x16x32_bf16 v[102:105], v[34:37], a[184:187], v[102:105]
    v_mfma_f32_16x16x32_bf16 v[106:109], v[38:41], a[184:187], v[106:109]
    v_mfma_f32_16x16x32_bf16 v[110:113], v[42:45], a[184:187], v[110:113]
    s_waitcnt vmcnt(0) lgkmcnt(0)
    v_mfma_f32_16x16x32_bf16 v[98:101], v[46:49], a[188:191], v[98:101]
    v_mfma_f32_16x16x32_bf16 v[102:105], v[50:53], a[188:191], v[102:105]
    v_mfma_f32_16x16x32_bf16 v[106:109], v[54:57], a[188:191], v[106:109]
    v_mfma_f32_16x16x32_bf16 v[110:113], v[58:61], a[188:191], v[110:113]
    s_nop 4
    v_cvt_pk_bf16_f32 v24, v98, v99
    v_cvt_pk_bf16_f32 v25, v100, v101
    v_cvt_pk_bf16_f32 v26, v102, v103
    v_cvt_pk_bf16_f32 v27, v104, v105
    ds_write_b128 v0, v[24:27] offset:0
    v_cvt_pk_bf16_f32 v28, v106, v107
    v_cvt_pk_bf16_f32 v29, v108, v109
    v_cvt_pk_bf16_f32 v30, v110, v111
    v_cvt_pk_bf16_f32 v31, v112, v113
    ds_write_b128 v0, v[28:31] offset:1024
    v_permlane16_swap_b32 v24, v26
    v_permlane16_swap_b32 v25, v27
    v_permlane16_swap_b32 v28, v30
    v_permlane16_swap_b32 v29, v31
    s_cmp_eq_u32 s47, 0
    s_cbranch_scc1 L_slow_43
    buffer_store_dwordx4 v[24:27], v6, s[32:35], s62 offen offset:0
    buffer_store_dwordx4 v[28:31], v6, s[32:35], s62 offen offset:1024
L_back_44:
    v_pk_add_f32 v[2:3], v[98:99], v[100:101]
    v_pk_mul_f32 v[4:5], v[98:99], v[98:99]
    v_pk_fma_f32 v[4:5], v[100:101], v[100:101], v[4:5]
    v_pk_add_f32 v[2:3], v[2:3], v[102:103]
    v_pk_fma_f32 v[4:5], v[102:103], v[102:103], v[4:5]
    v_pk_add_f32 v[2:3], v[2:3], v[104:105]
    v_pk_fma_f32 v[4:5], v[104:105], v[104:105], v[4:5]
    v_pk_add_f32 v[2:3], v[2:3], v[106:107]
    v_pk_fma_f32 v[4:5], v[106:107], v[106:107], v[4:5]
    v_pk_add_f32 v[2:3], v[2:3], v[108:109]
    v_pk_fma_f32 v[4:5], v[108:109], v[108:109], v[4:5]
    v_pk_add_f32 v[2:3], v[2:3], v[110:111]
    v_pk_fma_f32 v[4:5], v[110:111], v[110:111], v[4:5]
    v_pk_add_f32 v[2:3], v[2:3], v[112:113]
    v_pk_fma_f32 v[4:5], v[112:113], v[112:113], v[4:5]
    v_add_f32 v2, v2, v3
    v_add_f32 v4, v4, v5
    s_add_u32 s76, s46, 2
    v_mov_b32 v8, s76
    v_permlane32_swap_b32 v2, v4
    v_add_f32 v2, v2, v4
    v_mov_b32 v4, v2
    s_nop 1
    v_permlane16_swap_b32 v2, v4
    v_add_f32 v2, v2, v4
    s_cmp_eq_u32 s47, 0
    s_cbranch_scc1 L_slow_45
    buffer_store_dword v2, v7, s[32:35], s64 offen
L_back_46:
    s_waitcnt vmcnt(0) lgkmcnt(0)
    s_barrier
    s_cmp_eq_u32 s47, 0
    s_cbranch_scc1 L_slow_47
    buffer_store_dword v8, v9, s[32:35], s67 offen offset:32
L_back_48:
    s_xor_b32 m0, s70, 0
    s_xor_b32 s92, s71, 0
    buffer_load_dwordx4 v20, s[24:27], s92 offen lds
    s_xor_b32 m0, s70, 4096
    s_xor_b32 s92, s71, 32768
    buffer_load_dwordx4 v20, s[24:27], s92 offen lds
    s_xor_b32 m0, s70, 8192
    s_xor_b32 s92, s71, 65536
    buffer_load_dwordx4 v20, s[24:27], s92 offen lds
    s_xor_b32 m0, s70, 12288
    s_xor_b32 s92, s71, 98304
    buffer_load_dwordx4 v20, s[24:27], s92 offen lds
    v_mov_b32 v2, 0x3f803f80
    v_mov_b32 v3, 0x3f803f80
    v_mov_b32 v4, 0x3f803f80
    v_mov_b32 v5, 0x3f803f80
    s_mul_i32 s80, s40, 192
    s_add_u32 s80, s80, 157440
    v_lshrrev_b32 v0, 8, v1
    v_lshl_add_u32 v0, v0, 4, s80
    v_bfe_u32 v6, v1, 4, 4
    v_lshl_add_u32 v6, v6, 2, s80
    ds_read_b128 v[10:13], v0 offset:64
    ds_read_b32 v8, v6 offset:128
    v_bfe_u32 v0, v1, 4, 1
    v_cmp_eq_u32 vcc, 0, v0
    v_lshrrev_b32 v21, 8, v1
    v_lshlrev_b32 v21, 2, v21
    v_bfe_u32 v0, v1, 4, 4
    v_sub_u32 v0, v0, v21
    v_cndmask_b32 v14, 0, v2, vcc
    v_cndmask_b32 v16, v2, 0, vcc
    v_cndmask_b32 v15, 0, v2, vcc
    v_cndmask_b32 v17, v2, 0, vcc
    v_cmp_eq_u32 vcc, 0, v0
    v_cmp_eq_u32 s[4:5], 1, v0
    v_mov_b32 v21, 0x3f80
    v_cndmask_b32 v6, 0, v21, vcc
    v_cndmask_b32 v6, v6, 1.0, s[4:5]
    v_cmp_eq_u32 vcc, 2, v0
    v_cmp_eq_u32 s[4:5], 3, v0
    v_mov_b32 v21, 0x3f80
    v_cndmask_b32 v7, 0, v21, vcc
    v_cndmask_b32 v7, v7, 1.0, s[4:5]
    v_lshrrev_b32 v0, 3, v1
    v_lshl_or_b32 v0, v1, 24, v0
    v_and_b32 v0, 0xf0000060, v0
    s_add_u32 s88, s72, 4608
    s_add_u32 s89, s73, 4608
    s_lshl_b32 s90, s40, 8
    s_add_u32 s81, s90, s89
    s_lshl_b32 s90, s40, 5
    s_add_u32 s82, s90, s89
    s_add_u32 s84, s90, s74
    s_lshr_b32 s90, s40, 1
    s_lshl_b32 s90, s90, 8
    s_and_b32 s83, s40, 1
    s_lshl3_add_u32 s83, s83, s90
    s_add_u32 s83, s83, s74
    s_add_u32 s83, s83, 327680
    s_add_u32 s84, s84, 327680
    s_add_u32 s85, s75, 327680
    s_add_u32 s86, s75, 332800
    s_and_b32 s80, s45, 1
    s_lshl_b32 s80, s80, 11
    v_add_u32 v21, s80, v1
    v_subrev_u32 v23, s80, v1
    v_add_u32 v23, 4096, v23
    s_mov_b32 s80, 155648
    v_bfe_u32 v25, v1, 4, 4
    v_lshl_add_u32 v25, v25, 2, s80
    v_lshrrev_b32 v34, 8, v1
    v_lshl_add_u32 v34, v34, 4, s80
    s_lshl_b32 s80, s40, 6
    v_add_u32 v22, s80, v25
    s_sub_u32 s93, s63, 4096
    v_bfe_u32 v35, v1, 4, 3
    v_lshlrev_b32 v35, 2, v35
    s_nop 2
L_poll_49:
    buffer_load_dword v36, v35, s[32:35], s66 offen offset:32 sc1
    s_sub_u32 s48, s48, 1
    s_max_i32 s48, s48, 0
    s_cmp_lg_u32 s48, 0
    s_cselect_b64 s[94:95], -1, 0
    s_waitcnt vmcnt(0)
    v_cmp_ne_u32 vcc, s76, v36
    s_nop 0
    s_and_b64 vcc, vcc, s[94:95]
    s_cbranch_scc1 L_poll_49
    s_add_u32 m0, s68, 0
    s_nop 0
    buffer_load_dwordx4 v21, s[32:35], s63 offen offset:0 sc1 lds
    buffer_load_dwordx4 v21, s[32:35], s63 offen offset:1024 sc1 lds
    buffer_load_dwordx4 v23, s[32:35], s93 offen offset:2048 sc1 lds
    buffer_load_dwordx4 v23, s[32:35], s93 offen offset:3072 sc1 lds
    buffer_load_dwordx4 v[26:29], v1, s[32:35], s65 offen sc1
    s_add_u32 s92, s63, 16384
    s_add_u32 s93, s63, 12288
    s_add_u32 m0, s68, 16384
    s_nop 0
    buffer_load_dwordx4 v21, s[32:35], s92 offen offset:0 sc1 lds
    buffer_load_dwordx4 v21, s[32:35], s92 offen offset:1024 sc1 lds
    buffer_load_dwordx4 v23, s[32:35], s93 offen offset:2048 sc1 lds
    buffer_load_dwordx4 v23, s[32:35], s93 offen offset:3072 sc1 lds
    s_waitcnt vmcnt(5) lgkmcnt(0)
    s_barrier
    ds_read_b128 v[36:39], v1 offset:0
    ds_read_b128 v[40:43], v1 offset:1024
    ds_read_b128 v[44:47], v1 offset:2048
    s_waitcnt lgkmcnt(2)
    v_mfma_f32_16x16x32_bf16 v[84:87], a[192:195], v[36:39], 0
    ds_read_b128 v[48:51], v1 offset:3072
    s_waitcnt vmcnt(4)
    v_add_f32 v26, v26, v28
    v_mfma_f32_16x16x32_bf16 v[88:91], v[36:39], v[128:131], 0
    s_waitcnt lgkmcnt(2)
    v_add_f32 v27, v27, v29
    v_mfma_f32_16x16x32_bf16 v[84:87], a[196:199], v[40:43], v[84:87]
    ds_read_b128 v[36:39], v1 offset:4096
    v_mfma_f32_16x16x32_bf16 v[88:91], v[40:43], v[132:135], v[88:91]
    s_waitcnt lgkmcnt(2)
    v_permlane32_swap_b32 v26, v27
    v_mfma_f32_16x16x32_bf16 v[84:87], a[200:203], v[44:47], v[84:87]
    ds_read_b128 v[40:43], v1 offset:5120
    v_add_f32 v26, v26, v27
    v_mfma_f32_16x16x32_bf16 v[88:91], v[44:47], v[136:139], v[88:91]
    s_add_u32 s92, s63, 32768
    v_mov_b32 v27, v26
    s_waitcnt lgkmcnt(2)
    v_mfma_f32_16x16x32_bf16 v[84:87], a[204:207], v[48:51], v[84:87]
    ds_read_b128 v[44:47], v1 offset:6144
    v_permlane16_swap_b32 v26, v27
    v_mfma_f32_16x16x32_bf16 v[88:91], v[48:51], v[140:143], v[88:91]
    s_add_u32 s93, s63, 28672
    s_waitcnt lgkmcnt(2)
    v_mfma_f32_16x16x32_bf16 v[84:87], a[208:211], v[36:39], v[84:87]
    ds_read_b128 v[48:51], v1 offset:7168
    v_add_f32 v26, v26, v27
    v_mfma_f32_16x16x32_bf16 v[88:91], v[36:39], v[144:147], v[88:91]
    s_add_u32 m0, s68, 32768
    v_mov_b32 v27, v26
    s_waitcnt lgkmcnt(2)
    v_mfma_f32_16x16x32_bf16 v[84:87], a[212:215], v[40:43], v[84:87]
    ds_read_b128 v[36:39], v1 offset:8192
    v_permlane32_swap_b32 v26, v27
    v_mfma_f32_16x16x32_bf16 v[88:91], v[40:43], v[148:151], v[88:91]
    v_mul_f32 v26, 0xbb000000, v26
    s_waitcnt lgkmcnt(2)
    v_mfma_f32_16x16x32_bf16 v[84:87], a[216:219], v[44:47], v[84:87]
    ds_read_b128 v[40:43], v1 offset:9216
    v_mul_f32 v27, 0x3b000000, v27
    v_fma_f32 v27, -v26, v26, v27
    v_mfma_f32_16x16x32_bf16 v[88:91], v[44:47], v[152:155], v[88:91]
    buffer_load_dwordx4 v21, s[32:35], s92 offen offset:0 sc1 lds
    v_max_f32 v27, 0, v27
    s_waitcnt lgkmcnt(2)
    v_mfma_f32_16x16x32_bf16 v[84:87], a[220:223], v[48:51], v[84:87]
    ds_read_b128 v[44:47], v1 offset:10240
    v_add_f32 v27, 0x3727c5ac, v27
    v_mfma_f32_16x16x32_bf16 v[88:91], v[48:51], v[156:159], v[88:91]
    v_rsq_f32 v27, v27
    s_waitcnt lgkmcnt(2)
    v_mfma_f32_16x16x32_bf16 v[84:87], a[224:227], v[36:39], v[84:87]
    ds_read_b128 v[48:51], v1 offset:11264
    ds_write_b32 v22, v26 offset:320
    ds_write_b32 v22, v27 offset:0
    v_mfma_f32_16x16x32_bf16 v[88:91], v[36:39], v[160:163], v[88:91]
    s_waitcnt lgkmcnt(4)
    v_mfma_f32_16x16x32_bf16 v[84:87], a[228:231], v[40:43], v[84:87]
    ds_read_b128 v[36:39], v1 offset:12288
    buffer_load_dwordx4 v21, s[32:35], s92 offen offset:1024 sc1 lds
    v_mfma_f32_16x16x32_bf16 v[88:91], v[40:43], v[164:167], v[88:91]
    s_waitcnt lgkmcnt(4)
    v_mfma_f32_16x16x32_bf16 v[84:87], a[232:235], v[44:47], v[84:87]
    ds_read_b128 v[40:43], v1 offset:13312
    v_mfma_f32_16x16x32_bf16 v[88:91], v[44:47], v[168:171], v[88:91]
    s_waitcnt lgkmcnt(4)
    v_mfma_f32_16x16x32_bf16 v[84:87], a[236:239], v[48:51], v[84:87]
    ds_read_b128 v[44:47], v1 offset:14336
    buffer_load_dwordx4 v23, s[32:35], s93 offen offset:2048 sc1 lds
    v_mfma_f32_16x16x32_bf16 v[88:91], v[48:51], v[172:175], v[88:91]
    s_waitcnt lgkmcnt(2)
    v_mfma_f32_16x16x32_bf16 v[84:87], a[240:243], v[36:39], v[84:87]
    ds_read_b128 v[48:51], v1 offset:15360
    v_mfma_f32_16x16x32_bf16 v[88:91], v[36:39], v[176:179], v[88:91]
    buffer_load_dwordx4 v23, s[32:35], s93 offen offset:3072 sc1 lds
    s_waitcnt lgkmcnt(2)
    v_mfma_f32_16x16x32_bf16 v[84:87], a[244:247], v[40:43], v[84:87]
    s_waitcnt vmcnt(4)
    s_barrier
    ds_read_b128 v[36:39], v1 offset:16384
    ds_read_b32 v24, v25 offset:320
    ds_read_b32 v22, v25 offset:0
    ds_read_b128 v[30:33], v34 offset:320
    ds_read_b128 v[26:29], v34 offset:0
    v_mfma_f32_16x16x32_bf16 v[88:91], v[40:43], v[180:183], v[88:91]
    s_waitcnt lgkmcnt(6)
    v_mfma_f32_16x16x32_bf16 v[84:87], a[248:251], v[44:47], v[84:87]
    ds_read_b128 v[40:43], v1 offset:17408
    v_mfma_f32_16x16x32_bf16 v[88:91], v[44:47], v[184:187], v[88:91]
    s_waitcnt lgkmcnt(6)
    v_mfma_f32_16x16x32_bf16 v[84:87], a[252:255], v[48:51], v[84:87]
    ds_read_b128 v[44:47], v1 offset:18432
    v_mfma_f32_16x16x32_bf16 v[88:91], v[48:51], v[188:191], v[88:91]
    s_waitcnt lgkmcnt(6)
    v_mfma_f32_16x16x32_bf16 v[92:95], a[192:195], v[36:39], 0
    ds_read_b128 v[48:51], v1 offset:19456
    v_mfma_f32_16x16x32_bf16 v[96:99], v[36:39], v[128:131], 0
    s_add_u32 s92, s63, 49152
    s_waitcnt lgkmcnt(2)
    v_mfma_f32_16x16x32_bf16 v[92:95], a[196:199], v[40:43], v[92:95]
    ds_read_b128 v[36:39], v1 offset:20480
    v_fma_f32 v84, v24, v10, v84
    v_fma_f32 v85, v24, v11, v85
    v_fma_f32 v86, v24, v12, v86
    v_fma_f32 v87, v24, v13, v87
    v_cvt_pk_bf16_f32 v100, v84, v85
    v_cvt_pk_bf16_f32 v101, v86, v87
    v_mul_f32 v108, 0x3fb8aa3b, v22
    v_mfma_f32_16x16x32_bf16 v[96:99], v[40:43], v[132:135], v[96:99]
    s_waitcnt lgkmcnt(2)
    v_mfma_f32_16x16x16_bf16 v[102:105], v[18:19], v[100:101], 0
    s_add_u32 s93, s63, 45056
    v_fma_f32 v88, v30, v8, v88
    v_fma_f32 v89, v31, v8, v89
    v_mfma_f32_16x16x32_bf16 v[92:95], a[200:203], v[44:47], v[92:95]
    ds_read_b128 v[40:43], v1 offset:21504
    v_fma_f32 v90, v32, v8, v90
    v_mfma_f32_16x16x32_bf16 v[96:99], v[44:47], v[136:139], v[96:99]
    s_waitcnt lgkmcnt(2)
    v_fma_f32 v91, v33, v8, v91
    v_max3_f32 v106, v102, v103, v104
    v_max3_f32 v107, -v102, -v103, -v104
    v_max_f32 v106, v106, v105
    v_max_f32_e64 v107, v107, -v105
    s_add_u32 m0, s68, 49152
    v_mfma_f32_16x16x32_bf16 v[92:95], a[204:207], v[48:51], v[92:95]
    ds_read_b128 v[44:47], v1 offset:22528
    buffer_load_dwordx4 v21, s[32:35], s92 offen offset:0 sc1 lds
    v_permlane32_swap_b32 v106, v107
    v_max_f32 v106, v106, v107
    v_mfma_f32_16x16x32_bf16 v[96:99], v[48:51], v[140:143], v[96:99]
    s_waitcnt lgkmcnt(2)
    v_mov_b32 v107, v106
    v_mul_f32 v88, v26, v88
    v_mfma_f32_16x16x32_bf16 v[92:95], a[208:211], v[36:39], v[92:95]
    ds_read_b128 v[48:51], v1 offset:23552
    v_permlane16_swap_b32 v106, v107
    v_max_f32 v106, v106, v107
    v_mov_b32 v107, v106
    v_mfma_f32_16x16x32_bf16 v[96:99], v[36:39], v[144:147], v[96:99]
    s_waitcnt lgkmcnt(2)
    v_mul_f32 v89, v27, v89
    v_permlane32_swap_b32 v106, v107
    v_mfma_f32_16x16x32_bf16 v[92:95], a[212:215], v[40:43], v[92:95]
    ds_read_b128 v[36:39], v1 offset:24576
    buffer_load_dwordx4 v21, s[32:35], s92 offen offset:1024 sc1 lds
    v_mul_f32_e64 v106, -v106, v108
    v_mul_f32_e64 v107, -v107, v108
    v_mfma_f32_16x16x32_bf16 v[96:99], v[40:43], v[148:151], v[96:99]
    s_waitcnt lgkmcnt(2)
    v_fma_f32 v110, v102, v108, v106
    v_fma_f32 v111, v103, v108, v106
    v_fma_f32 v112, v104, v108, v106
    v_mfma_f32_16x16x32_bf16 v[92:95], a[216:219], v[44:47], v[92:95]
    ds_read_b128 v[40:43], v1 offset:25600
    buffer_load_dwordx4 v23, s[32:35], s93 offen offset:2048 sc1 lds
    v_fma_f32 v113, v105, v108, v106
    v_fma_f32 v114, -v102, v108, v107
    v_mfma_f32_16x16x32_bf16 v[96:99], v[44:47], v[152:155], v[96:99]
    s_waitcnt lgkmcnt(2)
    v_fma_f32 v115, -v103, v108, v107
    v_fma_f32 v116, -v104, v108, v107
    v_mfma_f32_16x16x32_bf16 v[92:95], a[220:223], v[48:51], v[92:95]
    ds_read_b128 v[44:47], v1 offset:26624
    v_fma_f32 v117, -v105, v108, v107
    v_exp_f32 v110, v110
    v_mfma_f32_16x16x32_bf16 v[96:99], v[48:51], v[156:159], v[96:99]
    s_waitcnt lgkmcnt(2)
    v_exp_f32 v111, v111
    v_mfma_f32_16x16x32_bf16 v[92:95], a[224:227], v[36:39], v[92:95]
    ds_read_b128 v[48:51], v1 offset:27648
    buffer_load_dwordx4 v23, s[32:35], s93 offen offset:3072 sc1 lds
    v_exp_f32 v112, v112
    v_mfma_f32_16x16x32_bf16 v[96:99], v[36:39], v[160:163], v[96:99]
    s_waitcnt lgkmcnt(2)
    v_exp_f32 v113, v113
    v_mul_f32 v90, v28, v90
    v_mfma_f32_16x16x32_bf16 v[92:95], a[228:231], v[40:43], v[92:95]
    ds_read_b128 v[36:39], v1 offset:28672
    v_exp_f32 v114, v114
    v_mul_f32 v91, v29, v91
    v_mfma_f32_16x16x32_bf16 v[96:99], v[40:43], v[164:167], v[96:99]
    s_waitcnt lgkmcnt(2)
    v_exp_f32 v115, v115
    v_exp_f32 v116, v116
    v_cvt_pk_bf16_f32 v76, v88, v89
    v_cvt_pk_bf16_f32 v77, v90, v91
    v_mfma_f32_16x16x32_bf16 v[92:95], a[232:235], v[44:47], v[92:95]
    ds_read_b128 v[40:43], v1 offset:29696
    ds_read_b32 v24, v25 offset:384
    ds_read_b32 v22, v25 offset:64
    ds_read_b128 v[30:33], v34 offset:384
    ds_read_b128 v[26:29], v34 offset:64
    v_exp_f32 v117, v117
    v_mfma_f32_16x16x32_bf16 v[96:99], v[44:47], v[168:171], v[96:99]
    s_waitcnt lgkmcnt(6)
    v_cvt_pk_bf16_f32 v80, v110, v111
    v_cvt_pk_bf16_f32 v81, v112, v113
    v_mfma_f32_16x16x32_bf16 v[92:95], a[236:239], v[48:51], v[92:95]
    ds_read_b128 v[44:47], v1 offset:30720
    v_cvt_pk_bf16_f32 v82, v114, v115
    v_mfma_f32_16x16x32_bf16 v[96:99], v[48:51], v[172:175], v[96:99]
    s_waitcnt lgkmcnt(6)
    v_cvt_pk_bf16_f32 v83, v116, v117
    s_xor_b32 m0, s70, 16384
    v_mfma_f32_16x16x32_bf16 v[92:95], a[240:243], v[36:39], v[92:95]
    ds_read_b128 v[48:51], v1 offset:31744
    v_mfma_f32_16x16x32_bf16 v[102:105], v[14:17], v[80:83], 0
    s_xor_b32 s92, s71, 131072
    v_mfma_f32_16x16x32_bf16 v[96:99], v[36:39], v[176:179], v[96:99]
    s_waitcnt lgkmcnt(6)
    v_mfma_f32_16x16x32_bf16 v[92:95], a[244:247], v[40:43], v[92:95]
    s_waitcnt vmcnt(4)
    s_barrier
    ds_read_b128 v[36:39], v1 offset:32768
    buffer_load_dwordx4 v20, s[24:27], s92 offen lds
    v_mfma_f32_16x16x32_bf16 v[96:99], v[40:43], v[180:183], v[96:99]
    s_waitcnt lgkmcnt(2)
    v_mfma_f32_16x16x32_bf16 v[92:95], a[248:251], v[44:47], v[92:95]
    ds_read_b128 v[40:43], v1 offset:33792
    v_rcp_f32 v106, v102
    v_rcp_f32 v107, v103
    v_mul_f32 v110, v106, v110
    v_mul_f32 v111, v106, v111
    v_mul_f32 v112, v106, v112
    v_mul_f32 v113, v106, v113
    v_mul_f32 v114, v107, v114
    v_mul_f32 v115, v107, v115
    v_mul_f32 v116, v107, v116
    s_xor_b32 m0, s70, 20480
    v_mfma_f32_16x16x32_bf16 v[96:99], v[44:47], v[184:187], v[96:99]
    s_waitcnt lgkmcnt(2)
    v_mul_f32 v117, v107, v117
    v_cvt_pk_bf16_f32 v80, v110, v111
    v_mfma_f32_16x16x32_bf16 v[92:95], a[252:255], v[48:51], v[92:95]
    ds_read_b128 v[44:47], v1 offset:34816
    v_cvt_pk_bf16_f32 v81, v112, v113
    v_cvt_pk_bf16_f32 v82, v114, v115
    s_xor_b32 s92, s71, 163840
    v_mfma_f32_16x16x32_bf16 v[96:99], v[48:51], v[188:191], v[96:99]
    s_waitcnt lgkmcnt(2)
    v_cvt_pk_bf16_f32 v83, v116, v117
    v_mfma_f32_16x16x16_bf16 v[110:113], v[80:81], v[6:7], 0
    buffer_load_dwordx4 v20, s[24:27], s92 offen lds
    v_mfma_f32_16x16x16_bf16 v[114:117], v[82:83], v[6:7], 0
    s_xor_b32 m0, s70, 24576
    v_mfma_f32_16x16x32_bf16 v[84:87], a[192:195], v[36:39], 0
    ds_read_b128 v[48:51], v1 offset:35840
    v_mfma_f32_16x16x32_bf16 v[88:91], v[36:39], v[128:131], 0
    s_waitcnt lgkmcnt(2)
    v_fma_f32 v96, v30, v8, v96
    v_fma_f32 v97, v31, v8, v97
    v_cvt_pk_bf16_f32 v68, v110, v111
    v_cvt_pk_bf16_f32 v69, v112, v113
    v_mfma_f32_16x16x32_bf16 v[84:87], a[196:199], v[40:43], v[84:87]
    ds_read_b128 v[36:39], v1 offset:36864
    v_cvt_pk_bf16_f32 v72, v114, v115
    v_cvt_pk_bf16_f32 v73, v116, v117
    v_fma_f32 v92, v24, v10, v92
    v_fma_f32 v93, v24, v11, v93
    v_fma_f32 v94, v24, v12, v94
    v_fma_f32 v95, v24, v13, v95
    v_cvt_pk_bf16_f32 v100, v92, v93
    v_cvt_pk_bf16_f32 v101, v94, v95
    v_mul_f32 v108, 0x3fb8aa3b, v22
    v_mfma_f32_16x16x32_bf16 v[88:91], v[40:43], v[132:135], v[88:91]
    s_waitcnt lgkmcnt(2)
    v_mfma_f32_16x16x16_bf16 v[102:105], v[18:19], v[100:101], 0
    s_xor_b32 s92, s71, 196608
    v_fma_f32 v98, v32, v8, v98
    v_fma_f32 v99, v33, v8, v99
    v_mfma_f32_16x16x32_bf16 v[84:87], a[200:203], v[44:47], v[84:87]
    ds_read_b128 v[40:43], v1 offset:37888
    buffer_load_dwordx4 v20, s[24:27], s92 offen lds
    v_mfma_f32_16x16x32_bf16 v[88:91], v[44:47], v[136:139], v[88:91]
    s_waitcnt lgkmcnt(2)
    v_mul_f32 v96, v26, v96
    v_max3_f32 v106, v102, v103, v104
    v_max3_f32 v107, -v102, -v103, -v104
    v_max_f32 v106, v106, v105
    v_max_f32_e64 v107, v107, -v105
    v_mfma_f32_16x16x32_bf16 v[84:87], a[204:207], v[48:51], v[84:87]
    ds_read_b128 v[44:47], v1 offset:38912
    v_permlane32_swap_b32 v106, v107
    v_max_f32 v106, v106, v107
    v_mov_b32 v107, v106
    v_mfma_f32_16x16x32_bf16 v[88:91], v[48:51], v[140:143], v[88:91]
    s_waitcnt lgkmcnt(2)
    v_mul_f32 v97, v27, v97
    v_permlane16_swap_b32 v106, v107
    v_max_f32 v106, v106, v107
    s_xor_b32 m0, s70, 28672
    v_mfma_f32_16x16x32_bf16 v[84:87], a[208:211], v[36:39], v[84:87]
    ds_read_b128 v[48:51], v1 offset:39936
    v_mov_b32 v107, v106
    v_mfma_f32_16x16x32_bf16 v[88:91], v[36:39], v[144:147], v[88:91]
    s_waitcnt lgkmcnt(2)
    v_mul_f32 v98, v28, v98
    v_permlane32_swap_b32 v106, v107
    v_mul_f32_e64 v106, -v106, v108
    v_mul_f32_e64 v107, -v107, v108
    s_xor_b32 s92, s71, 229376
    v_mfma_f32_16x16x32_bf16 v[84:87], a[212:215], v[40:43], v[84:87]
    ds_read_b128 v[36:39], v1 offset:40960
    buffer_load_dwordx4 v20, s[24:27], s92 offen lds
    v_fma_f32 v110, v102, v108, v106
    v_fma_f32 v111, v103, v108, v106
    v_fma_f32 v112, v104, v108, v106
    v_mfma_f32_16x16x32_bf16 v[88:91], v[40:43], v[148:151], v[88:91]
    s_waitcnt lgkmcnt(2)
    v_fma_f32 v113, v105, v108, v106
    v_fma_f32 v114, -v102, v108, v107
    v_mfma_f32_16x16x32_bf16 v[84:87], a[216:219], v[44:47], v[84:87]
    ds_read_b128 v[40:43], v1 offset:41984
    v_fma_f32 v115, -v103, v108, v107
    v_fma_f32 v116, -v104, v108, v107
    v_fma_f32 v117, -v105, v108, v107
    v_mfma_f32_16x16x32_bf16 v[88:91], v[44:47], v[152:155], v[88:91]
    s_waitcnt lgkmcnt(2)
    v_exp_f32 v110, v110
    s_xor_b32 m0, s70, 32768
    v_mfma_f32_16x16x32_bf16 v[84:87], a[220:223], v[48:51], v[84:87]
    ds_read_b128 v[44:47], v1 offset:43008
    v_exp_f32 v111, v111
    v_exp_f32 v112, v112
    s_xor_b32 s92, s71, 262144
    v_mfma_f32_16x16x32_bf16 v[88:91], v[48:51], v[156:159], v[88:91]
    s_waitcnt lgkmcnt(2)
    v_exp_f32 v113, v113
    v_mfma_f32_16x16x32_bf16 v[84:87], a[224:227], v[36:39], v[84:87]
    ds_read_b128 v[48:51], v1 offset:44032
    buffer_load_dwordx4 v20, s[24:27], s92 offen lds
    v_exp_f32 v114, v114
    v_mfma_f32_16x16x32_bf16 v[88:91], v[36:39], v[160:163], v[88:91]
    s_waitcnt lgkmcnt(2)
    v_exp_f32 v115, v115
    v_mfma_f32_16x16x32_bf16 v[84:87], a[228:231], v[40:43], v[84:87]
    ds_read_b128 v[36:39], v1 offset:45056
    v_exp_f32 v116, v116
    v_exp_f32 v117, v117
    v_mul_f32 v99, v29, v99
    s_xor_b32 m0, s70, 36864
    v_mfma_f32_16x16x32_bf16 v[88:91], v[40:43], v[164:167], v[88:91]
    s_waitcnt lgkmcnt(2)
    v_cvt_pk_bf16_f32 v80, v110, v111
    v_cvt_pk_bf16_f32 v81, v112, v113
    v_cvt_pk_bf16_f32 v78, v96, v97
    v_cvt_pk_bf16_f32 v79, v98, v99
    v_mfma_f32_16x16x32_bf16 v[84:87], a[232:235], v[44:47], v[84:87]
    ds_read_b128 v[40:43], v1 offset:46080
    ds_read_b32 v24, v25 offset:448
    ds_read_b32 v22, v25 offset:128
    ds_read_b128 v[30:33], v34 offset:448
    ds_read_b128 v[26:29], v34 offset:128
    v_cvt_pk_bf16_f32 v82, v114, v115
    v_cvt_pk_bf16_f32 v83, v116, v117
    s_xor_b32 s92, s71, 294912
    v_mfma_f32_16x16x32_bf16 v[88:91], v[44:47], v[168:171], v[88:91]
    s_waitcnt lgkmcnt(6)
    v_mfma_f32_16x16x32_bf16 v[102:105], v[14:17], v[80:83], 0
    buffer_load_dwordx4 v20, s[24:27], s92 offen lds
    v_mfma_f32_16x16x32_bf16 v[84:87], a[236:239], v[48:51], v[84:87]
    ds_read_b128 v[44:47], v1 offset:47104
    v_mfma_f32_16x16x32_bf16 v[88:91], v[48:51], v[172:175], v[88:91]
    s_waitcnt lgkmcnt(6)
    v_mfma_f32_16x16x32_bf16 v[84:87], a[240:243], v[36:39], v[84:87]
    ds_read_b128 v[48:51], v1 offset:48128
    s_xor_b32 m0, s70, 40960
    v_mfma_f32_16x16x32_bf16 v[88:91], v[36:39], v[176:179], v[88:91]
    s_waitcnt lgkmcnt(6)
    v_rcp_f32 v106, v102
    v_rcp_f32 v107, v103
    v_mul_f32 v110, v106, v110
    v_mul_f32 v111, v106, v111
    v_mul_f32 v112, v106, v112
    v_mul_f32 v113, v106, v113
    v_mul_f32 v114, v107, v114
    v_mul_f32 v115, v107, v115
    s_xor_b32 s92, s71, 327680
    v_mfma_f32_16x16x32_bf16 v[84:87], a[244:247], v[40:43], v[84:87]
    s_waitcnt vmcnt(6)
    s_barrier
    ds_read_b128 v[36:39], v1 offset:49152
    buffer_load_dwordx4 v20, s[24:27], s92 offen lds
    v_mul_f32 v116, v107, v116
    v_mul_f32 v117, v107, v117
    v_cvt_pk_bf16_f32 v80, v110, v111
    v_mfma_f32_16x16x32_bf16 v[88:91], v[40:43], v[180:183], v[88:91]
    s_waitcnt lgkmcnt(2)
    v_cvt_pk_bf16_f32 v81, v112, v113
    v_cvt_pk_bf16_f32 v82, v114, v115
    v_mfma_f32_16x16x32_bf16 v[84:87], a[248:251], v[44:47], v[84:87]
    ds_read_b128 v[40:43], v1 offset:50176
    v_cvt_pk_bf16_f32 v83, v116, v117
    v_mfma_f32_16x16x16_bf16 v[110:113], v[80:81], v[6:7], 0
    s_xor_b32 m0, s70, 45056
    v_mfma_f32_16x16x16_bf16 v[114:117], v[82:83], v[6:7], 0
    s_xor_b32 s92, s71, 360448
    v_mfma_f32_16x16x32_bf16 v[88:91], v[44:47], v[184:187], v[88:91]
    s_waitcnt lgkmcnt(2)
    v_mfma_f32_16x16x32_bf16 v[84:87], a[252:255], v[48:51], v[84:87]
    ds_read_b128 v[44:47], v1 offset:51200
    v_mfma_f32_16x16x32_bf16 v[88:91], v[48:51], v[188:191], v[88:91]
    s_waitcnt lgkmcnt(2)
    v_mfma_f32_16x16x32_bf16 v[92:95], a[192:195], v[36:39], 0
    ds_read_b128 v[48:51], v1 offset:52224
    buffer_load_dwordx4 v20, s[24:27], s92 offen lds
    v_cvt_pk_bf16_f32 v70, v110, v111
    v_cvt_pk_bf16_f32 v71, v112, v113
    v_cvt_pk_bf16_f32 v74, v114, v115
    v_cvt_pk_bf16_f32 v75, v116, v117
    v_mfma_f32_16x16x32_bf16 v[60:63], v[68:71], v[2:5], 0
    s_xor_b32 m0, s70, 49152
    v_mfma_f32_16x16x32_bf16 v[52:55], v[68:71], v[76:79], 0
    s_xor_b32 s92, s71, 393216
    v_mfma_f32_16x16x32_bf16 v[64:67], v[72:75], v[2:5], 0
    v_mfma_f32_16x16x32_bf16 v[56:59], v[72:75], v[76:79], 0
    v_fma_f32 v84, v24, v10, v84
    v_fma_f32 v85, v24, v11, v85
    v_fma_f32 v86, v24, v12, v86
    v_mfma_f32_16x16x32_bf16 v[96:99], v[36:39], v[128:131], 0
    s_waitcnt lgkmcnt(2)
    v_fma_f32 v87, v24, v13, v87
    v_cvt_pk_bf16_f32 v100, v84, v85
    v_cvt_pk_bf16_f32 v101, v86, v87
    v_mfma_f32_16x16x32_bf16 v[92:95], a[196:199], v[40:43], v[92:95]
    ds_read_b128 v[36:39], v1 offset:53248
    v_mul_f32 v108, 0x3fb8aa3b, v22
    v_mfma_f32_16x16x16_bf16 v[102:105], v[18:19], v[100:101], 0
    v_fma_f32 v88, v30, v8, v88
    v_fma_f32 v89, v31, v8, v89
    v_mfma_f32_16x16x32_bf16 v[96:99], v[40:43], v[132:135], v[96:99]
    s_waitcnt lgkmcnt(2)
    v_fma_f32 v90, v32, v8, v90
    v_fma_f32 v91, v33, v8, v91
    v_mfma_f32_16x16x32_bf16 v[92:95], a[200:203], v[44:47], v[92:95]
    ds_read_b128 v[40:43], v1 offset:54272
    buffer_load_dwordx4 v20, s[24:27], s92 offen lds
    v_max3_f32 v106, v102, v103, v104
    v_max3_f32 v107, -v102, -v103, -v104
    v_max_f32 v106, v106, v105
    v_max_f32_e64 v107, v107, -v105
    v_mfma_f32_16x16x32_bf16 v[96:99], v[44:47], v[136:139], v[96:99]
    s_waitcnt lgkmcnt(2)
    v_mul_f32 v88, v26, v88
    v_permlane32_swap_b32 v106, v107
    v_max_f32 v106, v106, v107
    v_mfma_f32_16x16x32_bf16 v[92:95], a[204:207], v[48:51], v[92:95]
    ds_read_b128 v[44:47], v1 offset:55296
    v_mov_b32 v107, v106
    v_mfma_f32_16x16x32_bf16 v[96:99], v[48:51], v[140:143], v[96:99]
    s_waitcnt lgkmcnt(2)
    v_mul_f32 v89, v27, v89
    v_permlane16_swap_b32 v106, v107
    v_max_f32 v106, v106, v107
    v_mov_b32 v107, v106
    v_mfma_f32_16x16x32_bf16 v[92:95], a[208:211], v[36:39], v[92:95]
    ds_read_b128 v[48:51], v1 offset:56320
    v_permlane32_swap_b32 v106, v107
    s_xor_b32 m0, s70, 53248
    v_mfma_f32_16x16x32_bf16 v[96:99], v[36:39], v[144:147], v[96:99]
    s_waitcnt lgkmcnt(2)
    v_mul_f32_e64 v106, -v106, v108
    v_mul_f32_e64 v107, -v107, v108
    v_fma_f32 v110, v102, v108, v106
    v_mfma_f32_16x16x32_bf16 v[92:95], a[212:215], v[40:43], v[92:95]
    ds_read_b128 v[36:39], v1 offset:57344
    v_fma_f32 v111, v103, v108, v106
    v_fma_f32 v112, v104, v108, v106
    v_fma_f32 v113, v105, v108, v106
    s_xor_b32 s92, s71, 425984
    v_mfma_f32_16x16x32_bf16 v[96:99], v[40:43], v[148:151], v[96:99]
    s_waitcnt lgkmcnt(2)
    v_fma_f32 v114, -v102, v108, v107
    v_fma_f32 v115, -v103, v108, v107
    v_mfma_f32_16x16x32_bf16 v[92:95], a[216:219], v[44:47], v[92:95]
    ds_read_b128 v[40:43], v1 offset:58368
    buffer_load_dwordx4 v20, s[24:27], s92 offen lds
    v_fma_f32 v116, -v104, v108, v107
    v_fma_f32 v117, -v105, v108, v107
    v_exp_f32 v110, v110
    v_mfma_f32_16x16x32_bf16 v[96:99], v[44:47], v[152:155], v[96:99]
    s_waitcnt lgkmcnt(2)
    v_exp_f32 v111, v111
    v_mfma_f32_16x16x32_bf16 v[92:95], a[220:223], v[48:51], v[92:95]
    ds_read_b128 v[44:47], v1 offset:59392
    v_exp_f32 v112, v112
    s_xor_b32 m0, s70, 57344
    v_mfma_f32_16x16x32_bf16 v[96:99], v[48:51], v[156:159], v[96:99]
    s_waitcnt lgkmcnt(2)
    v_exp_f32 v113, v113
    s_xor_b32 s92, s71, 458752
    v_mfma_f32_16x16x32_bf16 v[92:95], a[224:227], v[36:39], v[92:95]
    ds_read_b128 v[48:51], v1 offset:60416
    buffer_load_dwordx4 v20, s[24:27], s92 offen lds
    v_exp_f32 v114, v114
    v_exp_f32 v115, v115
    v_mfma_f32_16x16x32_bf16 v[96:99], v[36:39], v[160:163], v[96:99]
    s_waitcnt lgkmcnt(2)
    v_exp_f32 v116, v116
    v_mul_f32 v90, v28, v90
    v_mfma_f32_16x16x32_bf16 v[92:95], a[228:231], v[40:43], v[92:95]
    ds_read_b128 v[36:39], v1 offset:61440
    v_exp_f32 v117, v117
    v_mul_f32 v91, v29, v91
    v_mfma_f32_16x16x32_bf16 v[96:99], v[40:43], v[164:167], v[96:99]
    s_waitcnt lgkmcnt(2)
    v_cvt_pk_bf16_f32 v80, v110, v111
    v_cvt_pk_bf16_f32 v81, v112, v113
    v_cvt_pk_bf16_f32 v76, v88, v89
    v_cvt_pk_bf16_f32 v77, v90, v91
    s_xor_b32 m0, s70, 61440
    v_mfma_f32_16x16x32_bf16 v[92:95], a[232:235], v[44:47], v[92:95]
    ds_read_b128 v[40:43], v1 offset:62464
    ds_read_b32 v24, v25 offset:512
    ds_read_b32 v22, v25 offset:192
    ds_read_b128 v[30:33], v34 offset:512
    ds_read_b128 v[26:29], v34 offset:192
    v_cvt_pk_bf16_f32 v82, v114, v115
    v_cvt_pk_bf16_f32 v83, v116, v117
    v_mfma_f32_16x16x32_bf16 v[96:99], v[44:47], v[168:171], v[96:99]
    s_waitcnt lgkmcnt(6)
    s_xor_b32 s92, s71, 491520
    v_mfma_f32_16x16x32_bf16 v[102:105], v[14:17], v[80:83], 0
    buffer_load_dwordx4 v20, s[24:27], s92 offen lds
    v_mfma_f32_16x16x32_bf16 v[92:95], a[236:239], v[48:51], v[92:95]
    ds_read_b128 v[44:47], v1 offset:63488
    v_mfma_f32_16x16x32_bf16 v[96:99], v[48:51], v[172:175], v[96:99]
    s_waitcnt lgkmcnt(6)
    v_mfma_f32_16x16x32_bf16 v[92:95], a[240:243], v[36:39], v[92:95]
    ds_read_b128 v[48:51], v1 offset:64512
    v_mfma_f32_16x16x32_bf16 v[96:99], v[36:39], v[176:179], v[96:99]
    s_waitcnt lgkmcnt(6)
    v_mfma_f32_16x16x32_bf16 v[92:95], a[244:247], v[40:43], v[92:95]
    v_rcp_f32 v106, v102
    v_rcp_f32 v107, v103
    v_mul_f32 v110, v106, v110
    v_mul_f32 v111, v106, v111
    v_mul_f32 v112, v106, v112
    v_mul_f32 v113, v106, v113
    v_mul_f32 v114, v107, v114
    v_mul_f32 v115, v107, v115
    v_mul_f32 v116, v107, v116
    v_mul_f32 v117, v107, v117
    v_cvt_pk_bf16_f32 v80, v110, v111
    v_cvt_pk_bf16_f32 v81, v112, v113
    v_mfma_f32_16x16x32_bf16 v[96:99], v[40:43], v[180:183], v[96:99]
    s_waitcnt lgkmcnt(1)
    v_cvt_pk_bf16_f32 v82, v114, v115
    v_cvt_pk_bf16_f32 v83, v116, v117
    v_mfma_f32_16x16x16_bf16 v[110:113], v[80:81], v[6:7], 0
    v_mfma_f32_16x16x32_bf16 v[92:95], a[248:251], v[44:47], v[92:95]
    v_mfma_f32_16x16x16_bf16 v[114:117], v[82:83], v[6:7], 0
    v_mfma_f32_16x16x32_bf16 v[96:99], v[44:47], v[184:187], v[96:99]
    s_waitcnt lgkmcnt(0)
    v_mfma_f32_16x16x32_bf16 v[92:95], a[252:255], v[48:51], v[92:95]
    v_mfma_f32_16x16x32_bf16 v[96:99], v[48:51], v[188:191], v[96:99]
    s_nop 1
    v_cvt_pk_bf16_f32 v68, v110, v111
    v_cvt_pk_bf16_f32 v69, v112, v113
    v_cvt_pk_bf16_f32 v72, v114, v115
    v_cvt_pk_bf16_f32 v73, v116, v117
    s_nop 0
    v_pk_fma_f32 v[92:93], v[24:25], v[10:11], v[92:93] op_sel_hi:[0,1,1]
    v_pk_fma_f32 v[94:95], v[24:25], v[12:13], v[94:95] op_sel_hi:[0,1,1]
    v_cvt_pk_bf16_f32 v100, v92, v93
    v_cvt_pk_bf16_f32 v101, v94, v95
    v_mul_f32 v108, 0x3fb8aa3b, v22
    v_pk_fma_f32 v[96:97], v[30:31], v[8:9], v[96:97] op_sel_hi:[1,0,1]
    v_mfma_f32_16x16x16_bf16 v[102:105], v[18:19], v[100:101], 0
    v_pk_fma_f32 v[98:99], v[32:33], v[8:9], v[98:99] op_sel_hi:[1,0,1]
    v_pk_mul_f32 v[96:97], v[26:27], v[96:97]
    v_pk_mul_f32 v[98:99], v[28:29], v[98:99]
    v_cvt_pk_bf16_f32 v78, v96, v97
    v_cvt_pk_bf16_f32 v79, v98, v99
    s_nop 2
    v_max3_f32 v106, v102, v103, v104
    v_max3_f32 v107, -v102, -v103, -v104
    v_max_f32 v106, v106, v105
    v_max_f32_e64 v107, v107, -v105
    s_nop 1
    v_permlane32_swap_b32 v106, v107
    v_max_f32 v106, v106, v107
    v_mov_b32 v107, v106
    s_nop 1
    v_permlane16_swap_b32 v106, v107
    v_max_f32 v106, v106, v107
    v_mov_b32 v107, v106
    s_nop 1
    v_permlane32_swap_b32 v106, v107
    v_mul_f32_e64 v106, -v106, v108
    v_mul_f32_e64 v107, -v107, v108
    v_pk_fma_f32 v[110:111], v[102:103], v[108:109], v[106:107] op_sel_hi:[1,0,0]
    v_pk_fma_f32 v[112:113], v[104:105], v[108:109], v[106:107] op_sel_hi:[1,0,0]
    v_pk_fma_f32 v[114:115], v[102:103], v[108:109], v[106:107] op_sel:[0,0,1] op_sel_hi:[1,0,1] neg_lo:[1,0,0] neg_hi:[1,0,0]
    v_pk_fma_f32 v[116:117], v[104:105], v[108:109], v[106:107] op_sel:[0,0,1] op_sel_hi:[1,0,1] neg_lo:[1,0,0] neg_hi:[1,0,0]
    v_exp_f32 v110, v110
    v_exp_f32 v111, v111
    v_exp_f32 v112, v112
    v_exp_f32 v113, v113
    v_exp_f32 v114, v114
    v_exp_f32 v115, v115
    v_exp_f32 v116, v116
    v_exp_f32 v117, v117
    v_cvt_pk_bf16_f32 v80, v110, v111
    v_cvt_pk_bf16_f32 v81, v112, v113
    v_cvt_pk_bf16_f32 v82, v114, v115
    v_cvt_pk_bf16_f32 v83, v116, v117
    s_nop 1
    v_mfma_f32_16x16x32_bf16 v[102:105], v[14:17], v[80:83], 0
    s_nop 7
    v_rcp_f32 v106, v102
    v_rcp_f32 v107, v103
    s_nop 0
    v_pk_mul_f32 v[110:111], v[106:107], v[110:111] op_sel:[0,0] op_sel_hi:[0,1]
    v_pk_mul_f32 v[112:113], v[106:107], v[112:113] op_sel:[0,0] op_sel_hi:[0,1]
    v_pk_mul_f32 v[114:115], v[106:107], v[114:115] op_sel:[1,0] op_sel_hi:[1,1]
    v_pk_mul_f32 v[116:117], v[106:107], v[116:117] op_sel:[1,0] op_sel_hi:[1,1]
    v_cvt_pk_bf16_f32 v80, v110, v111
    v_cvt_pk_bf16_f32 v81, v112, v113
    v_cvt_pk_bf16_f32 v82, v114, v115
    v_cvt_pk_bf16_f32 v83, v116, v117
    v_mfma_f32_16x16x16_bf16 v[110:113], v[80:81], v[6:7], 0
    s_nop 0
    v_mfma_f32_16x16x16_bf16 v[114:117], v[82:83], v[6:7], 0
    s_nop 5
    v_cvt_pk_bf16_f32 v70, v110, v111
    v_cvt_pk_bf16_f32 v71, v112, v113
    v_cvt_pk_bf16_f32 v74, v114, v115
    v_cvt_pk_bf16_f32 v75, v116, v117
    v_mfma_f32_16x16x32_bf16 v[60:63], v[68:71], v[2:5], v[60:63]
    v_mfma_f32_16x16x32_bf16 v[52:55], v[68:71], v[76:79], v[52:55]
    v_mfma_f32_16x16x32_bf16 v[64:67], v[72:75], v[2:5], v[64:67]
    v_mfma_f32_16x16x32_bf16 v[56:59], v[72:75], v[76:79], v[56:59]
    s_nop 5
    v_cvt_pk_bf16_f32 v10, v52, v53
    v_cvt_pk_bf16_f32 v11, v54, v55
    v_cvt_pk_bf16_f32 v12, v56, v57
    v_cvt_pk_bf16_f32 v13, v58, v59
    s_cmp_eq_u32 s47, 0
    s_cbranch_scc1 L_slow_50
    buffer_store_dwordx4 v[60:63], v0, s[32:35], s88 offen offset:1024
    buffer_store_dwordx4 v[64:67], v0, s[32:35], s88 offen offset:1040
    buffer_store_dwordx4 v[10:13], v1, s[32:35], s88 offen
L_back_51:
    v_lshrrev_b32 v6, 8, v1
    v_and_b32 v28, 0xf0, v1
    v_mul_u32_u24 v21, 1152, v6
    v_add_u32 v8, v28, v21
    v_bfe_u32 v29, v1, 4, 3
    v_lshlrev_b32 v26, 2, v29
    v_add_u32 v21, v21, v26
    v_bfe_u32 v7, v1, 7, 1
    v_cmp_eq_u32 s[4:5], 0, v7
    v_mov_b32 v7, 0x3f80
    v_cmp_eq_u32 vcc, 0, v29
    v_cmp_eq_u32 s[6:7], 1, v29
    s_nop 0
    v_cndmask_b32 v68, 0, v7, vcc
    v_cndmask_b32 v68, v68, 1.0, s[6:7]
    v_cndmask_b32 v30, 0, v68, s[4:5]
    v_cndmask_b32 v68, v68, 0, s[4:5]
    v_cmp_eq_u32 vcc, 2, v29
    v_cmp_eq_u32 s[6:7], 3, v29
    s_nop 0
    v_cndmask_b32 v69, 0, v7, vcc
    v_cndmask_b32 v69, v69, 1.0, s[6:7]
    v_cndmask_b32 v31, 0, v69, s[4:5]
    v_cndmask_b32 v69, v69, 0, s[4:5]
    v_cmp_eq_u32 vcc, 4, v29
    v_cmp_eq_u32 s[6:7], 5, v29
    s_nop 0
    v_cndmask_b32 v70, 0, v7, vcc
    v_cndmask_b32 v70, v70, 1.0, s[6:7]
    v_cndmask_b32 v32, 0, v70, s[4:5]
    v_cndmask_b32 v70, v70, 0, s[4:5]
    v_cmp_eq_u32 vcc, 6, v29
    v_cmp_eq_u32 s[6:7], 7, v29
    s_nop 0
    v_cndmask_b32 v71, 0, v7, vcc
    v_cndmask_b32 v71, v71, 1.0, s[6:7]
    v_cndmask_b32 v33, 0, v71, s[4:5]
    v_cndmask_b32 v71, v71, 0, s[4:5]
    v_lshl_add_u32 v23, v6, 9, v28
    v_lshrrev_b32 v7, 1, v6
    v_lshl_add_u32 v23, v7, 30, v23
    v_mul_u32_u24 v27, 1280, v29
    v_lshl_add_u32 v27, v6, 5, v27
    v_bfe_u32 v29, v1, 7, 1
    v_lshl_add_u32 v27, v29, 4, v27
    v_mul_u32_u24 v29, 1280, v6
    v_add_u32 v28, v28, v29
    s_mul_i32 s80, s40, 192
    s_add_u32 s80, s80, 157440
    v_lshrrev_b32 v0, 8, v1
    v_lshl_add_u32 v0, v0, 4, s80
    v_bfe_u32 v35, v1, 4, 4
    v_lshl_add_u32 v35, v35, 2, s80
    ds_read_b128 v[52:55], v0 offset:0
    s_mov_b32 s89, 0x4000
    s_nop 0
L_s1_52:
    buffer_load_dwordx4 v[10:13], v8, s[32:35], s81 offen sc1
    buffer_load_dword v6, v21, s[32:35], s82 offen offset:1024 sc1
    s_sub_u32 s89, s89, 1
    s_cmp_gt_i32 s89, 0
    s_cselect_b64 s[94:95], -1, 0
    s_waitcnt vmcnt(1)
    v_mfma_f32_16x16x32_bf16 v[64:67], v[30:33], v[10:13], 0
    s_waitcnt vmcnt(0)
    v_mov_b32 v7, v6
    s_nop 1
    v_permlane32_swap_b32 v6, v7
    v_add_f32 v6, v6, v7
    v_mov_b32 v7, v6
    s_nop 1
    v_permlane16_swap_b32 v6, v7
    v_add_f32 v6, v6, v7
    v_add_f32 v7, v6, v64
    v_cmp_u_f32 vcc, v7, v7
    v_cvt_pk_bf16_f32 v10, v64, v65
    v_cvt_pk_bf16_f32 v11, v66, v67
    s_and_b64 vcc, vcc, s[94:95]
    s_cbranch_scc1 L_s1_52
    buffer_store_dwordx2 v[10:11], v23, s[32:35], s83 offen sc1
    buffer_store_dword v6, v26, s[32:35], s84 offen offset:1024 sc1
    ds_read_b128 v[36:39], v1 offset:0
    ds_read_b128 v[40:43], v1 offset:1024
    ds_read_b128 v[44:47], v1 offset:2048
    ds_read_b128 v[48:51], v1 offset:3072
    ds_read_b128 v[56:59], v1 offset:4096
    s_barrier
    s_waitcnt lgkmcnt(4)
    v_mfma_f32_16x16x32_bf16 v[84:87], v[192:195], v[36:39], 0
    ds_read_b128 v[60:63], v1 offset:5120
    s_waitcnt lgkmcnt(4)
    v_mfma_f32_16x16x32_bf16 v[84:87], v[196:199], v[40:43], v[84:87]
    ds_read_b128 v[36:39], v1 offset:6144
    s_waitcnt lgkmcnt(3)
    v_mfma_f32_16x16x32_bf16 v[84:87], v[200:203], v[44:47], v[84:87]
    ds_read_b128 v[40:43], v1 offset:7168
    ds_read_b32 v24, v25 offset:320
    ds_read_b32 v22, v25 offset:0
    v_mfma_f32_16x16x32_bf16 v[84:87], v[204:207], v[48:51], v[84:87]
    ds_read_b128 v[44:47], v1 offset:8192
    s_waitcnt lgkmcnt(5)
    v_mfma_f32_16x16x32_bf16 v[84:87], v[208:211], v[56:59], v[84:87]
    ds_read_b128 v[48:51], v1 offset:9216
    v_mfma_f32_16x16x32_bf16 v[84:87], v[212:215], v[60:63], v[84:87]
    ds_read_b128 v[56:59], v1 offset:10240
    s_waitcnt lgkmcnt(5)
    v_mfma_f32_16x16x32_bf16 v[84:87], v[216:219], v[36:39], v[84:87]
    ds_read_b128 v[60:63], v1 offset:11264
    v_mfma_f32_16x16x32_bf16 v[84:87], v[220:223], v[40:43], v[84:87]
    ds_read_b128 v[36:39], v1 offset:12288
    s_waitcnt lgkmcnt(3)
    v_mfma_f32_16x16x32_bf16 v[84:87], v[224:227], v[44:47], v[84:87]
    ds_read_b128 v[40:43], v1 offset:13312
    v_mfma_f32_16x16x32_bf16 v[84:87], v[228:231], v[48:51], v[84:87]
    ds_read_b128 v[44:47], v1 offset:14336
    s_waitcnt lgkmcnt(3)
    v_mfma_f32_16x16x32_bf16 v[84:87], v[232:235], v[56:59], v[84:87]
    ds_read_b128 v[48:51], v1 offset:15360
    v_mfma_f32_16x16x32_bf16 v[84:87], v[236:239], v[60:63], v[84:87]
    ds_read_b128 v[56:59], v1 offset:16384
    s_waitcnt lgkmcnt(3)
    v_mfma_f32_16x16x32_bf16 v[84:87], v[240:243], v[36:39], v[84:87]
    ds_read_b128 v[60:63], v1 offset:17408
    v_mfma_f32_16x16x32_bf16 v[84:87], v[244:247], v[40:43], v[84:87]
    ds_read_b128 v[36:39], v1 offset:18432
    s_waitcnt lgkmcnt(3)
    v_mfma_f32_16x16x32_bf16 v[84:87], v[248:251], v[44:47], v[84:87]
    ds_read_b128 v[40:43], v1 offset:19456
    v_mfma_f32_16x16x32_bf16 v[84:87], v[252:255], v[48:51], v[84:87]
    ds_read_b128 v[44:47], v1 offset:20480
    s_waitcnt lgkmcnt(3)
    v_mfma_f32_16x16x32_bf16 v[92:95], v[192:195], v[56:59], 0
    ds_read_b128 v[48:51], v1 offset:21504
    v_mfma_f32_16x16x32_bf16 v[92:95], v[196:199], v[60:63], v[92:95]
    ds_read_b128 v[56:59], v1 offset:22528
    ds_read_b32 v26, v25 offset:384
    s_waitcnt lgkmcnt(4)
    v_mfma_f32_16x16x32_bf16 v[92:95], v[200:203], v[36:39], v[92:95]
    ds_read_b128 v[60:63], v1 offset:23552
    ds_read_b32 v8, v25 offset:64
    v_fma_f32 v84, v24, v52, v84
    v_fma_f32 v85, v24, v53, v85
    v_fma_f32 v86, v24, v54, v86
    v_fma_f32 v87, v24, v55, v87
    v_cvt_pk_bf16_f32 v100, v84, v85
    v_cvt_pk_bf16_f32 v101, v86, v87
    v_mul_f32 v108, 0x3fb8aa3b, v22
    v_mfma_f32_16x16x32_bf16 v[92:95], v[204:207], v[40:43], v[92:95]
    ds_read_b128 v[36:39], v1 offset:24576
    v_mfma_f32_16x16x16_bf16 v[102:105], v[18:19], v[100:101], 0
    s_waitcnt lgkmcnt(5)
    v_mfma_f32_16x16x32_bf16 v[92:95], v[208:211], v[44:47], v[92:95]
    ds_read_b128 v[40:43], v1 offset:25600
    v_mfma_f32_16x16x32_bf16 v[92:95], v[212:215], v[48:51], v[92:95]
    ds_read_b128 v[44:47], v1 offset:26624
    s_waitcnt lgkmcnt(4)
    v_mfma_f32_16x16x32_bf16 v[92:95], v[216:219], v[56:59], v[92:95]
    ds_read_b128 v[48:51], v1 offset:27648
    v_mfma_f32_16x16x32_bf16 v[92:95], v[220:223], v[60:63], v[92:95]
    ds_read_b128 v[56:59], v1 offset:28672
    v_max3_f32 v106, v102, v103, v104
    v_max3_f32 v107, -v102, -v103, -v104
    v_max_f32 v106, v106, v105
    v_max_f32_e64 v107, v107, -v105
    s_waitcnt lgkmcnt(3)
    v_mfma_f32_16x16x32_bf16 v[92:95], v[224:227], v[36:39], v[92:95]
    ds_read_b128 v[60:63], v1 offset:29696
    v_permlane32_swap_b32 v106, v107
    v_max_f32 v106, v106, v107
    v_mov_b32 v107, v106
    v_mfma_f32_16x16x32_bf16 v[92:95], v[228:231], v[40:43], v[92:95]
    ds_read_b128 v[36:39], v1 offset:30720
    s_waitcnt lgkmcnt(3)
    v_permlane16_swap_b32 v106, v107
    v_max_f32 v106, v106, v107
    v_mov_b32 v107, v106
    v_mfma_f32_16x16x32_bf16 v[92:95], v[232:235], v[44:47], v[92:95]
    ds_read_b128 v[40:43], v1 offset:31744
    v_permlane32_swap_b32 v106, v107
    v_mfma_f32_16x16x32_bf16 v[92:95], v[236:239], v[48:51], v[92:95]
    ds_read_b128 v[44:47], v1 offset:32768
    v_mul_f32_e64 v106, -v106, v108
    v_mul_f32_e64 v107, -v107, v108
    s_waitcnt lgkmcnt(3)
    v_mfma_f32_16x16x32_bf16 v[92:95], v[240:243], v[56:59], v[92:95]
    ds_read_b128 v[48:51], v1 offset:33792
    v_fma_f32 v110, v102, v108, v106
    v_fma_f32 v111, v103, v108, v106
    v_mfma_f32_16x16x32_bf16 v[92:95], v[244:247], v[60:63], v[92:95]
    ds_read_b128 v[56:59], v1 offset:34816
    v_fma_f32 v112, v104, v108, v106
    v_fma_f32 v113, v105, v108, v106
    s_waitcnt lgkmcnt(3)
    v_mfma_f32_16x16x32_bf16 v[92:95], v[248:251], v[36:39], v[92:95]
    ds_read_b128 v[60:63], v1 offset:35840
    v_fma_f32 v114, -v102, v108, v107
    v_fma_f32 v115, -v103, v108, v107
    v_mfma_f32_16x16x32_bf16 v[92:95], v[252:255], v[40:43], v[92:95]
    ds_read_b128 v[36:39], v1 offset:36864
    v_fma_f32 v116, -v104, v108, v107
    v_fma_f32 v117, -v105, v108, v107
    s_waitcnt lgkmcnt(3)
    v_mfma_f32_16x16x32_bf16 v[88:91], v[192:195], v[44:47], 0
    ds_read_b128 v[40:43], v1 offset:37888
    v_exp_f32 v110, v110
    v_mfma_f32_16x16x32_bf16 v[88:91], v[196:199], v[48:51], v[88:91]
    ds_read_b128 v[44:47], v1 offset:38912
    v_exp_f32 v111, v111
    v_fma_f32 v92, v26, v52, v92
    v_fma_f32 v93, v26, v53, v93
    v_fma_f32 v94, v26, v54, v94
    v_fma_f32 v95, v26, v55, v95
    v_cvt_pk_bf16_f32 v2, v92, v93
    s_waitcnt lgkmcnt(3)
    v_mfma_f32_16x16x32_bf16 v[88:91], v[200:203], v[56:59], v[88:91]
    ds_read_b128 v[48:51], v1 offset:39936
    v_exp_f32 v112, v112
    v_cvt_pk_bf16_f32 v3, v94, v95
    v_mul_f32 v0, 0x3fb8aa3b, v8
    v_mfma_f32_16x16x32_bf16 v[88:91], v[204:207], v[60:63], v[88:91]
    ds_read_b128 v[56:59], v1 offset:40960
    v_mfma_f32_16x16x16_bf16 v[4:7], v[18:19], v[2:3], 0
    v_exp_f32 v113, v113
    s_waitcnt lgkmcnt(3)
    v_mfma_f32_16x16x32_bf16 v[88:91], v[208:211], v[36:39], v[88:91]
    ds_read_b128 v[60:63], v1 offset:41984
    v_exp_f32 v114, v114
    v_mfma_f32_16x16x32_bf16 v[88:91], v[212:215], v[40:43], v[88:91]
    ds_read_b128 v[36:39], v1 offset:43008
    v_exp_f32 v115, v115
    s_waitcnt lgkmcnt(3)
    v_mfma_f32_16x16x32_bf16 v[88:91], v[216:219], v[44:47], v[88:91]
    ds_read_b128 v[40:43], v1 offset:44032
    v_exp_f32 v116, v116
    v_max3_f32 v72, v4, v5, v6
    v_max3_f32 v73, -v4, -v5, -v6
    v_max_f32 v72, v72, v7
    v_max_f32_e64 v73, v73, -v7
    v_mfma_f32_16x16x32_bf16 v[88:91], v[220:223], v[48:51], v[88:91]
    ds_read_b128 v[44:47], v1 offset:45056
    v_exp_f32 v117, v117
    v_permlane32_swap_b32 v72, v73
    v_max_f32 v72, v72, v73
    v_mov_b32 v73, v72
    s_waitcnt lgkmcnt(3)
    v_mfma_f32_16x16x32_bf16 v[88:91], v[224:227], v[56:59], v[88:91]
    ds_read_b128 v[48:51], v1 offset:46080
    v_cvt_pk_bf16_f32 v84, v110, v111
    v_cvt_pk_bf16_f32 v85, v112, v113
    v_permlane16_swap_b32 v72, v73
    v_mfma_f32_16x16x32_bf16 v[88:91], v[228:231], v[60:63], v[88:91]
    ds_read_b128 v[56:59], v1 offset:47104
    s_waitcnt lgkmcnt(3)
    v_cvt_pk_bf16_f32 v86, v114, v115
    v_cvt_pk_bf16_f32 v87, v116, v117
    v_max_f32 v72, v72, v73
    v_mov_b32 v73, v72
    v_mfma_f32_16x16x32_bf16 v[102:105], v[14:17], v[84:87], 0
    v_mfma_f32_16x16x32_bf16 v[88:91], v[232:235], v[36:39], v[88:91]
    ds_read_b128 v[60:63], v1 offset:48128
    v_permlane32_swap_b32 v72, v73
    v_mfma_f32_16x16x32_bf16 v[88:91], v[236:239], v[40:43], v[88:91]
    ds_read_b128 v[36:39], v1 offset:49152
    s_waitcnt lgkmcnt(3)
    v_mul_f32_e64 v72, -v72, v0
    v_mul_f32_e64 v73, -v73, v0
    v_mfma_f32_16x16x32_bf16 v[88:91], v[240:243], v[44:47], v[88:91]
    ds_read_b128 v[40:43], v1 offset:50176
    v_rcp_f32 v107, v103
    v_mul_f32 v21, 0x358637bd, v102
    v_mul_f32 v107, v102, v107
    v_fma_f32 v74, v4, v0, v72
    v_fma_f32 v75, v5, v0, v72
    v_mfma_f32_16x16x32_bf16 v[88:91], v[244:247], v[48:51], v[88:91]
    ds_read_b128 v[44:47], v1 offset:51200
    v_mul_f32 v114, v107, v114
    v_mul_f32 v115, v107, v115
    v_fma_f32 v76, v6, v0, v72
    v_fma_f32 v77, v7, v0, v72
    s_waitcnt lgkmcnt(3)
    v_mfma_f32_16x16x32_bf16 v[88:91], v[248:251], v[56:59], v[88:91]
    ds_read_b128 v[48:51], v1 offset:52224
    v_mul_f32 v116, v107, v116
    v_mul_f32 v117, v107, v117
    v_fma_f32 v78, -v4, v0, v73
    v_fma_f32 v79, -v5, v0, v73
    v_mfma_f32_16x16x32_bf16 v[88:91], v[252:255], v[60:63], v[88:91]
    ds_read_b128 v[56:59], v1 offset:53248
    s_waitcnt lgkmcnt(3)
    v_cvt_pk_bf16_f32 v86, v114, v115
    v_cvt_pk_bf16_f32 v87, v116, v117
    v_fma_f32 v80, -v6, v0, v73
    v_fma_f32 v81, -v7, v0, v73
    ds_read_b32 v24, v25 offset:448
    ds_read_b32 v22, v25 offset:128
    v_mfma_f32_16x16x32_bf16 v[96:99], v[192:195], v[36:39], 0
    ds_read_b128 v[60:63], v1 offset:54272
    v_exp_f32 v74, v74
    v_mfma_f32_16x16x32_bf16 v[96:99], v[196:199], v[40:43], v[96:99]
    ds_read_b128 v[36:39], v1 offset:55296
    s_waitcnt lgkmcnt(5)
    v_exp_f32 v75, v75
    v_mfma_f32_16x16x32_bf16 v[96:99], v[200:203], v[44:47], v[96:99]
    ds_read_b128 v[40:43], v1 offset:56320
    v_exp_f32 v76, v76
    v_mfma_f32_16x16x32_bf16 v[96:99], v[204:207], v[48:51], v[96:99]
    ds_read_b128 v[44:47], v1 offset:57344
    v_exp_f32 v77, v77
    s_waitcnt lgkmcnt(5)
    v_fma_f32 v88, v24, v52, v88
    v_fma_f32 v89, v24, v53, v89
    v_fma_f32 v90, v24, v54, v90
    v_fma_f32 v91, v24, v55, v91
    v_cvt_pk_bf16_f32 v100, v88, v89
    v_cvt_pk_bf16_f32 v101, v90, v91
    s_waitcnt lgkmcnt(4)
    v_mul_f32 v108, 0x3fb8aa3b, v22
    s_waitcnt lgkmcnt(3)
    v_mfma_f32_16x16x32_bf16 v[96:99], v[208:211], v[56:59], v[96:99]
    ds_read_b128 v[48:51], v1 offset:58368
    buffer_load_dwordx4 v[120:123], v27, s[32:35], s85 offen offset:1024 sc1
    buffer_load_dwordx4 a[224:227], v28, s[32:35], s85 offen offset:0 sc1
    v_mfma_f32_16x16x16_bf16 v[102:105], v[18:19], v[100:101], 0
    v_exp_f32 v78, v78
    v_mfma_f32_16x16x32_bf16 v[96:99], v[212:215], v[60:63], v[96:99]
    ds_read_b128 v[56:59], v1 offset:59392
    s_waitcnt lgkmcnt(3)
    v_exp_f32 v79, v79
    v_mfma_f32_16x16x32_bf16 v[96:99], v[216:219], v[36:39], v[96:99]
    ds_read_b128 v[60:63], v1 offset:60416
    buffer_load_dwordx4 a[228:231], v28, s[32:35], s86 offen offset:0 sc1
    buffer_load_dwordx4 a[232:235], v28, s[32:35], s85 offen offset:256 sc1
    v_max3_f32 v106, v102, v103, v104
    v_max3_f32 v107, -v102, -v103, -v104
    v_max_f32 v106, v106, v105
    v_max_f32_e64 v107, v107, -v105
    v_exp_f32 v80, v80
    v_mfma_f32_16x16x32_bf16 v[96:99], v[220:223], v[40:43], v[96:99]
    ds_read_b128 v[36:39], v1 offset:61440
    s_waitcnt lgkmcnt(3)
    v_permlane32_swap_b32 v106, v107
    v_max_f32 v106, v106, v107
    v_mov_b32 v107, v106
    v_exp_f32 v81, v81
    v_mfma_f32_16x16x32_bf16 v[96:99], v[224:227], v[44:47], v[96:99]
    ds_read_b128 v[40:43], v1 offset:62464
    buffer_load_dwordx4 a[236:239], v28, s[32:35], s86 offen offset:256 sc1
    buffer_load_dwordx4 a[240:243], v28, s[32:35], s85 offen offset:512 sc1
    v_permlane16_swap_b32 v106, v107
    v_cvt_pk_bf16_f32 v92, v74, v75
    v_cvt_pk_bf16_f32 v93, v76, v77
    v_mfma_f32_16x16x32_bf16 v[96:99], v[228:231], v[48:51], v[96:99]
    ds_read_b128 v[44:47], v1 offset:63488
    s_waitcnt lgkmcnt(3)
    v_max_f32 v106, v106, v107
    v_mov_b32 v107, v106
    v_cvt_pk_bf16_f32 v94, v78, v79
    v_cvt_pk_bf16_f32 v95, v80, v81
    v_mfma_f32_16x16x32_bf16 v[96:99], v[232:235], v[56:59], v[96:99]
    ds_read_b128 v[48:51], v1 offset:64512
    buffer_load_dwordx4 a[244:247], v28, s[32:35], s86 offen offset:512 sc1
    buffer_load_dwordx4 a[248:251], v28, s[32:35], s85 offen offset:768 sc1
    v_mfma_f32_16x16x32_bf16 v[4:7], v[14:17], v[92:95], 0
    v_permlane32_swap_b32 v106, v107
    v_mfma_f32_16x16x32_bf16 v[96:99], v[236:239], v[60:63], v[96:99]
    s_waitcnt lgkmcnt(2)
    v_mul_f32_e64 v106, -v106, v108
    v_mul_f32_e64 v107, -v107, v108
    v_mfma_f32_16x16x32_bf16 v[96:99], v[240:243], v[36:39], v[96:99]
    buffer_load_dwordx4 a[252:255], v28, s[32:35], s86 offen offset:768 sc1
    v_fma_f32 v110, v102, v108, v106
    v_fma_f32 v111, v103, v108, v106
    v_rcp_f32 v73, v5
    v_mul_f32 v23, 0x358637bd, v4
    v_mul_f32 v73, v4, v73
    v_mfma_f32_16x16x32_bf16 v[96:99], v[244:247], v[40:43], v[96:99]
    s_waitcnt lgkmcnt(0)
    v_fma_f32 v112, v104, v108, v106
    v_fma_f32 v113, v105, v108, v106
    v_mul_f32 v78, v73, v78
    v_mul_f32 v79, v73, v79
    v_mfma_f32_16x16x32_bf16 v[96:99], v[248:251], v[44:47], v[96:99]
    v_fma_f32 v114, -v102, v108, v107
    v_fma_f32 v115, -v103, v108, v107
    v_mul_f32 v80, v73, v80
    v_mul_f32 v81, v73, v81
    v_mfma_f32_16x16x32_bf16 v[96:99], v[252:255], v[48:51], v[96:99]
    v_fma_f32 v116, -v104, v108, v107
    v_fma_f32 v117, -v105, v108, v107
    v_cvt_pk_bf16_f32 v94, v78, v79
    v_cvt_pk_bf16_f32 v95, v80, v81
    ds_read_b32 v26, v25 offset:512
    ds_read_b32 v8, v25 offset:192
    v_exp_f32 v110, v110
    v_exp_f32 v111, v111
    v_exp_f32 v112, v112
    v_exp_f32 v113, v113
    v_exp_f32 v114, v114
    v_exp_f32 v115, v115
    v_exp_f32 v116, v116
    v_exp_f32 v117, v117
    v_cvt_pk_bf16_f32 v88, v110, v111
    v_cvt_pk_bf16_f32 v89, v112, v113
    v_cvt_pk_bf16_f32 v90, v114, v115
    v_cvt_pk_bf16_f32 v91, v116, v117
    s_waitcnt lgkmcnt(1)
    v_pk_fma_f32 v[96:97], v[26:27], v[52:53], v[96:97] op_sel_hi:[0,1,1]
    v_pk_fma_f32 v[98:99], v[26:27], v[54:55], v[98:99] op_sel_hi:[0,1,1]
    v_cvt_pk_bf16_f32 v2, v96, v97
    v_cvt_pk_bf16_f32 v3, v98, v99
    s_waitcnt lgkmcnt(0)
    v_mul_f32 v0, 0x3fb8aa3b, v8
    v_mfma_f32_16x16x32_bf16 v[102:105], v[14:17], v[88:91], 0
    v_mfma_f32_16x16x16_bf16 v[4:7], v[18:19], v[2:3], 0
    s_nop 6
    v_rcp_f32 v107, v103
    v_mul_f32 v29, 0x358637bd, v102
    v_mul_f32 v107, v102, v107
    v_mul_f32 v114, v107, v114
    v_mul_f32 v115, v107, v115
    v_mul_f32 v116, v107, v116
    v_mul_f32 v117, v107, v117
    v_cvt_pk_bf16_f32 v90, v114, v115
    v_max3_f32 v72, v4, v5, v6
    v_max3_f32 v73, -v4, -v5, -v6
    v_max_f32 v72, v72, v7
    v_max_f32_e64 v73, v73, -v7
    v_cvt_pk_bf16_f32 v91, v116, v117
    s_nop 0
    v_permlane32_swap_b32 v72, v73
    v_max_f32 v72, v72, v73
    v_mov_b32 v73, v72
    s_nop 1
    v_permlane16_swap_b32 v72, v73
    v_max_f32 v72, v72, v73
    v_mov_b32 v73, v72
    s_nop 1
    v_permlane32_swap_b32 v72, v73
    v_mul_f32_e64 v72, -v72, v0
    v_mul_f32_e64 v73, -v73, v0
    v_pk_fma_f32 v[74:75], v[4:5], v[0:1], v[72:73] op_sel_hi:[1,0,0]
    v_pk_fma_f32 v[76:77], v[6:7], v[0:1], v[72:73] op_sel_hi:[1,0,0]
    v_pk_fma_f32 v[78:79], v[4:5], v[0:1], v[72:73] op_sel:[0,0,1] op_sel_hi:[1,0,1] neg_lo:[1,0,0] neg_hi:[1,0,0]
    v_pk_fma_f32 v[80:81], v[6:7], v[0:1], v[72:73] op_sel:[0,0,1] op_sel_hi:[1,0,1] neg_lo:[1,0,0] neg_hi:[1,0,0]
    v_exp_f32 v74, v74
    v_exp_f32 v75, v75
    v_exp_f32 v76, v76
    v_exp_f32 v77, v77
    v_exp_f32 v78, v78
    v_exp_f32 v79, v79
    v_exp_f32 v80, v80
    v_exp_f32 v81, v81
    v_cvt_pk_bf16_f32 v96, v74, v75
    v_cvt_pk_bf16_f32 v97, v76, v77
    v_cvt_pk_bf16_f32 v98, v78, v79
    v_cvt_pk_bf16_f32 v99, v80, v81
    s_nop 1
    v_mfma_f32_16x16x32_bf16 v[4:7], v[14:17], v[96:99], 0
    s_nop 7
    v_rcp_f32 v73, v5
    v_mul_f32 v35, 0x358637bd, v4
    v_mul_f32 v73, v4, v73
    v_pk_mul_f32 v[78:79], v[72:73], v[78:79] op_sel:[1,0] op_sel_hi:[1,1]
    v_pk_mul_f32 v[80:81], v[72:73], v[80:81] op_sel:[1,0] op_sel_hi:[1,1]
    v_cvt_pk_bf16_f32 v98, v78, v79
    v_cvt_pk_bf16_f32 v99, v80, v81
    v_bfe_u32 v7, v1, 7, 2
    v_lshrrev_b32 v6, 8, v1
    v_mul_u32_u24 v6, 1024, v6
    v_lshl_add_u32 v6, v7, 5, v6
    v_bfe_u32 v7, v1, 6, 2
    v_lshl_add_u32 v6, v7, 7, v6
    v_bfe_u32 v7, v1, 4, 2
    v_lshl_add_u32 v6, v7, 3, v6
    v_add_u32 v6, 65536, v6
    v_xor_b32 v7, 32, v6
    v_xor_b32 v8, 64, v6
    v_xor_b32 v22, 96, v6
    ds_read_b64_tr_b16 a[0:1], v6 offset:0
    ds_read_b64_tr_b16 a[2:3], v6 offset:512
    ds_read_b64_tr_b16 a[4:5], v7 offset:0
    ds_read_b64_tr_b16 a[6:7], v7 offset:512
    ds_read_b64_tr_b16 a[8:9], v8 offset:0
    ds_read_b64_tr_b16 a[10:11], v8 offset:512
    ds_read_b64_tr_b16 a[12:13], v22 offset:0
    ds_read_b64_tr_b16 a[14:15], v22 offset:512
    ds_read_b64_tr_b16 a[16:17], v6 offset:4096
    ds_read_b64_tr_b16 a[18:19], v6 offset:4608
    ds_read_b64_tr_b16 a[20:21], v7 offset:4096
    ds_read_b64_tr_b16 a[22:23], v7 offset:4608
    ds_read_b64_tr_b16 a[24:25], v8 offset:4096
    ds_read_b64_tr_b16 a[26:27], v8 offset:4608
    ds_read_b64_tr_b16 a[28:29], v22 offset:4096
    ds_read_b64_tr_b16 a[30:31], v22 offset:4608
    ds_read_b64_tr_b16 a[32:33], v6 offset:8192
    ds_read_b64_tr_b16 a[34:35], v6 offset:8704
    ds_read_b64_tr_b16 a[36:37], v7 offset:8192
    ds_read_b64_tr_b16 a[38:39], v7 offset:8704
    ds_read_b64_tr_b16 a[40:41], v8 offset:8192
    ds_read_b64_tr_b16 a[42:43], v8 offset:8704
    ds_read_b64_tr_b16 a[44:45], v22 offset:8192
    ds_read_b64_tr_b16 a[46:47], v22 offset:8704
    ds_read_b64_tr_b16 a[48:49], v6 offset:12288
    ds_read_b64_tr_b16 a[50:51], v6 offset:12800
    ds_read_b64_tr_b16 a[52:53], v7 offset:12288
    ds_read_b64_tr_b16 a[54:55], v7 offset:12800
    ds_read_b64_tr_b16 a[56:57], v8 offset:12288
    ds_read_b64_tr_b16 a[58:59], v8 offset:12800
    ds_read_b64_tr_b16 a[60:61], v22 offset:12288
    ds_read_b64_tr_b16 a[62:63], v22 offset:12800
    v_and_b32 v24, 0xf0, v1
    v_lshrrev_b32 v25, 9, v1
    v_lshl_or_b32 v24, v25, 8, v24
    v_bfe_u32 v25, v1, 8, 1
    v_lshl_or_b32 v24, v25, 14, v24
    s_mov_b32 s89, 0x4000
L_s2_53:
    s_sub_u32 s89, s89, 1
    s_cmp_gt_i32 s89, 0
    s_cselect_b64 s[94:95], -1, 0
    s_waitcnt vmcnt(7)
    v_mfma_f32_16x16x32_bf16 v[72:75], v[30:33], a[224:227], 0
    v_add_f32_dpp v120, v120, v120 quad_perm:[1,0,3,2] row_mask:0xf bank_mask:0xf
    v_add_f32_dpp v121, v121, v121 quad_perm:[1,0,3,2] row_mask:0xf bank_mask:0xf
    v_add_f32_dpp v122, v122, v122 quad_perm:[1,0,3,2] row_mask:0xf bank_mask:0xf
    s_waitcnt vmcnt(6)
    v_mfma_f32_16x16x32_bf16 v[72:75], v[30:33], a[228:231], v[72:75]
    v_add_f32_dpp v123, v123, v123 quad_perm:[1,0,3,2] row_mask:0xf bank_mask:0xf
    v_add_f32_dpp v120, v120, v120 quad_perm:[2,3,0,1] row_mask:0xf bank_mask:0xf
    v_add_f32_dpp v121, v121, v121 quad_perm:[2,3,0,1] row_mask:0xf bank_mask:0xf
    s_waitcnt vmcnt(5)
    v_mfma_f32_16x16x32_bf16 v[72:75], v[68:71], a[232:235], v[72:75]
    v_add_f32_dpp v122, v122, v122 quad_perm:[2,3,0,1] row_mask:0xf bank_mask:0xf
    v_add_f32_dpp v123, v123, v123 quad_perm:[2,3,0,1] row_mask:0xf bank_mask:0xf
    v_add_f32_dpp v120, v120, v120 row_half_mirror row_mask:0xf bank_mask:0xf
    s_waitcnt vmcnt(4)
    v_mfma_f32_16x16x32_bf16 v[72:75], v[68:71], a[236:239], v[72:75]
    v_add_f32_dpp v121, v121, v121 row_half_mirror row_mask:0xf bank_mask:0xf
    v_add_f32_dpp v122, v122, v122 row_half_mirror row_mask:0xf bank_mask:0xf
    v_add_f32_dpp v123, v123, v123 row_half_mirror row_mask:0xf bank_mask:0xf
    s_waitcnt vmcnt(3)
    v_mfma_f32_16x16x32_bf16 v[76:79], v[30:33], a[240:243], 0
    v_add_f32 v0, v120, v121
    v_add_f32 v0, v0, v122
    s_waitcnt vmcnt(2)
    v_mfma_f32_16x16x32_bf16 v[76:79], v[30:33], a[244:247], v[76:79]
    v_add_f32 v0, v0, v123
    v_cvt_pk_bf16_f32 v120, v120, v121
    v_cvt_pk_bf16_f32 v121, v122, v123
    s_waitcnt vmcnt(1)
    v_mfma_f32_16x16x32_bf16 v[76:79], v[68:71], a[248:251], v[76:79]
    v_mov_b32_dpp v14, v120 row_newbcast:0 row_mask:0xf bank_mask:0xf
    v_mov_b32_dpp v16, v120 row_newbcast:8 row_mask:0xf bank_mask:0xf
    v_mov_b32_dpp v15, v121 row_newbcast:0 row_mask:0xf bank_mask:0xf
    s_waitcnt vmcnt(0)
    v_mfma_f32_16x16x32_bf16 v[76:79], v[68:71], a[252:255], v[76:79]
    v_mov_b32_dpp v17, v121 row_newbcast:8 row_mask:0xf bank_mask:0xf
    v_add_f32 v0, v0, v72
    v_cvt_pk_bf16_f32 v2, v72, v73
    v_cvt_pk_bf16_f32 v3, v74, v75
    s_nop 3
    v_add_f32 v0, v0, v76
    v_cmp_u_f32 vcc, v0, v0
    v_cvt_pk_bf16_f32 v4, v76, v77
    v_cvt_pk_bf16_f32 v5, v78, v79
    s_and_b64 vcc, vcc, s[94:95]
    s_cbranch_scc1 L_s2r_54
    v_mfma_f32_16x16x32_bf16 v[40:43], v[14:17], v[84:87], 0
    v_mfma_f32_16x16x32_bf16 v[48:51], v[14:17], v[92:95], 0
    v_mfma_f32_16x16x32_bf16 v[60:63], v[14:17], v[88:91], 0
    v_mfma_f32_16x16x32_bf16 v[104:107], v[14:17], v[96:99], 0
    v_mfma_f32_16x16x32_bf16 v[36:39], v[2:5], v[84:87], 0
    v_mfma_f32_16x16x32_bf16 v[44:47], v[2:5], v[92:95], 0
    v_mfma_f32_16x16x32_bf16 v[56:59], v[2:5], v[88:91], 0
    v_mfma_f32_16x16x32_bf16 v[100:103], v[2:5], v[96:99], 0
    s_nop 0
    v_add_f32 v40, v21, v40
    v_rcp_f32 v40, v40
    v_add_f32 v48, v23, v48
    v_add_f32 v60, v29, v60
    v_add_f32 v104, v35, v104
    v_rcp_f32 v48, v48
    v_rcp_f32 v60, v60
    v_rcp_f32 v104, v104
    v_pk_mul_f32 v[36:37], v[40:41], v[36:37] op_sel_hi:[0,1]
    v_pk_mul_f32 v[44:45], v[48:49], v[44:45] op_sel_hi:[0,1]
    v_pk_mul_f32 v[56:57], v[60:61], v[56:57] op_sel_hi:[0,1]
    v_pk_mul_f32 v[100:101], v[104:105], v[100:101] op_sel_hi:[0,1]
    v_pk_mul_f32 v[38:39], v[40:41], v[38:39] op_sel_hi:[0,1]
    v_pk_mul_f32 v[46:47], v[48:49], v[46:47] op_sel_hi:[0,1]
    v_pk_mul_f32 v[58:59], v[60:61], v[58:59] op_sel_hi:[0,1]
    v_pk_mul_f32 v[102:103], v[104:105], v[102:103] op_sel_hi:[0,1]
    v_cvt_pk_bf16_f32 v72, v36, v37
    v_cvt_pk_bf16_f32 v74, v44, v45
    v_cvt_pk_bf16_f32 v76, v56, v57
    v_cvt_pk_bf16_f32 v78, v100, v101
    v_cvt_pk_bf16_f32 v73, v38, v39
    v_cvt_pk_bf16_f32 v75, v46, v47
    v_cvt_pk_bf16_f32 v77, v58, v59
    v_cvt_pk_bf16_f32 v79, v102, v103
    v_permlane16_swap_b32 v72, v74
    v_permlane16_swap_b32 v73, v75
    v_permlane16_swap_b32 v76, v78
    v_permlane16_swap_b32 v77, v79
    s_add_u32 s76, s46, 3
    v_mov_b32 v25, s76
    s_add_u32 s81, s60, 32768
    s_cmp_eq_u32 s47, 0
    s_cbranch_scc1 L_slow_55
    buffer_store_dwordx4 v[72:75], v24, s[32:35], s60 offen
    buffer_store_dwordx4 v[76:79], v24, s[32:35], s81 offen
L_back_56:
    ds_read_b64_tr_b16 a[64:65], v6 offset:16384
    ds_read_b64_tr_b16 a[66:67], v6 offset:16896
    ds_read_b64_tr_b16 a[68:69], v7 offset:16384
    ds_read_b64_tr_b16 a[70:71], v7 offset:16896
    ds_read_b64_tr_b16 a[72:73], v8 offset:16384
    ds_read_b64_tr_b16 a[74:75], v8 offset:16896
    ds_read_b64_tr_b16 a[76:77], v22 offset:16384
    ds_read_b64_tr_b16 a[78:79], v22 offset:16896
    ds_read_b64_tr_b16 a[80:81], v6 offset:20480
    ds_read_b64_tr_b16 a[82:83], v6 offset:20992
    ds_read_b64_tr_b16 a[84:85], v7 offset:20480
    ds_read_b64_tr_b16 a[86:87], v7 offset:20992
    ds_read_b64_tr_b16 a[88:89], v8 offset:20480
    ds_read_b64_tr_b16 a[90:91], v8 offset:20992
    ds_read_b64_tr_b16 a[92:93], v22 offset:20480
    ds_read_b64_tr_b16 a[94:95], v22 offset:20992
    ds_read_b64_tr_b16 a[96:97], v6 offset:24576
    ds_read_b64_tr_b16 a[98:99], v6 offset:25088
    ds_read_b64_tr_b16 a[100:101], v7 offset:24576
    ds_read_b64_tr_b16 a[102:103], v7 offset:25088
    ds_read_b64_tr_b16 a[104:105], v8 offset:24576
    ds_read_b64_tr_b16 a[106:107], v8 offset:25088
    ds_read_b64_tr_b16 a[108:109], v22 offset:24576
    ds_read_b64_tr_b16 a[110:111], v22 offset:25088
    ds_read_b64_tr_b16 a[112:113], v6 offset:28672
    ds_read_b64_tr_b16 a[114:115], v6 offset:29184
    ds_read_b64_tr_b16 a[116:117], v7 offset:28672
    ds_read_b64_tr_b16 a[118:119], v7 offset:29184
    ds_read_b64_tr_b16 a[120:121], v8 offset:28672
    ds_read_b64_tr_b16 a[122:123], v8 offset:29184
    ds_read_b64_tr_b16 a[124:125], v22 offset:28672
    ds_read_b64_tr_b16 a[126:127], v22 offset:29184
    ds_read_b64_tr_b16 a[128:129], v6 offset:32768
    ds_read_b64_tr_b16 a[130:131], v6 offset:33280
    ds_read_b64_tr_b16 a[132:133], v7 offset:32768
    ds_read_b64_tr_b16 a[134:135], v7 offset:33280
    ds_read_b64_tr_b16 a[136:137], v8 offset:32768
    ds_read_b64_tr_b16 a[138:139], v8 offset:33280
    ds_read_b64_tr_b16 a[140:141], v22 offset:32768
    ds_read_b64_tr_b16 a[142:143], v22 offset:33280
    s_waitcnt vmcnt(0)
    s_barrier
    s_cmp_eq_u32 s47, 0
    s_cbranch_scc1 L_slow_57
    buffer_store_dword v25, v9, s[32:35], s67 offen offset:0
L_back_58:
    s_lshl_b32 s80, s40, 11
    s_add_u32 s80, s80, 131072
    v_add_u32 v0, s80, v1
    ds_read_b128 v[28:31], v0 offset:0
    ds_read_b128 v[32:35], v0 offset:1024
    ds_read_b64_tr_b16 a[144:145], v6 offset:36864
    ds_read_b64_tr_b16 a[146:147], v6 offset:37376
    ds_read_b64_tr_b16 a[148:149], v7 offset:36864
    ds_read_b64_tr_b16 a[150:151], v7 offset:37376
    ds_read_b64_tr_b16 a[152:153], v8 offset:36864
    ds_read_b64_tr_b16 a[154:155], v8 offset:37376
    ds_read_b64_tr_b16 a[156:157], v22 offset:36864
    ds_read_b64_tr_b16 a[158:159], v22 offset:37376
    ds_read_b64_tr_b16 a[160:161], v6 offset:40960
    ds_read_b64_tr_b16 a[162:163], v6 offset:41472
    ds_read_b64_tr_b16 a[164:165], v7 offset:40960
    ds_read_b64_tr_b16 a[166:167], v7 offset:41472
    ds_read_b64_tr_b16 a[168:169], v8 offset:40960
    ds_read_b64_tr_b16 a[170:171], v8 offset:41472
    ds_read_b64_tr_b16 a[172:173], v22 offset:40960
    ds_read_b64_tr_b16 a[174:175], v22 offset:41472
    s_waitcnt lgkmcnt(15)
    v_lshlrev_b32 v2, 16, v28
    v_and_b32 v3, 0xffff0000, v28
    v_lshlrev_b32 v4, 16, v29
    v_and_b32 v5, 0xffff0000, v29
    v_lshlrev_b32 v10, 16, v30
    v_and_b32 v11, 0xffff0000, v30
    v_lshlrev_b32 v12, 16, v31
    v_and_b32 v13, 0xffff0000, v31
    v_lshlrev_b32 v14, 16, v32
    v_and_b32 v15, 0xffff0000, v32
    v_lshlrev_b32 v16, 16, v33
    v_and_b32 v17, 0xffff0000, v33
    v_lshlrev_b32 v24, 16, v34
    v_and_b32 v25, 0xffff0000, v34
    v_lshlrev_b32 v26, 16, v35
    v_and_b32 v27, 0xffff0000, v35
    v_bfe_u32 v21, v1, 4, 4
    v_lshlrev_b32 v21, 10, v21
    v_lshrrev_b32 v23, 9, v1
    v_lshl_or_b32 v21, v23, 4, v21
    v_bfe_u32 v23, v1, 8, 1
    v_lshl_or_b32 v21, v23, 5, v21
    s_lshl_b32 s83, s43, 16
    s_lshl_b32 s81, s40, 14
    s_add_u32 s83, s83, s81
    s_lshl_b32 s81, s41, 7
    s_add_u32 s83, s83, s81
    v_bfe_u32 v23, v1, 4, 3
    v_lshlrev_b32 v23, 2, v23
    s_add_u32 s85, s61, 4096
    s_add_u32 s86, s61, 8192
    s_add_u32 s87, s61, 12288
L_poll_59:
    buffer_load_dword v92, v23, s[32:35], s66 offen offset:0 sc1
    s_sub_u32 s48, s48, 1
    s_max_i32 s48, s48, 0
    s_cmp_lg_u32 s48, 0
    s_cselect_b64 s[94:95], -1, 0
    s_waitcnt vmcnt(0)
    v_cmp_ne_u32 vcc, s76, v92
    s_nop 0
    s_and_b64 vcc, vcc, s[94:95]
    s_cbranch_scc1 L_poll_59
    s_barrier
    buffer_load_dwordx4 v[28:31], v1, s[32:35], s61 offen offset:0 sc1
    buffer_load_dwordx4 v[32:35], v1, s[32:35], s61 offen offset:1024 sc1
    buffer_load_dwordx4 v[36:39], v1, s[32:35], s61 offen offset:2048 sc1
    buffer_load_dwordx4 v[40:43], v1, s[32:35], s61 offen offset:3072 sc1
    buffer_load_dwordx4 v[44:47], v1, s[32:35], s85 offen offset:0 sc1
    buffer_load_dwordx4 v[48:51], v1, s[32:35], s85 offen offset:1024 sc1
    buffer_load_dwordx4 v[52:55], v1, s[32:35], s85 offen offset:2048 sc1
    buffer_load_dwordx4 v[56:59], v1, s[32:35], s85 offen offset:3072 sc1
    ds_read_b64_tr_b16 a[176:177], v6 offset:45056
    ds_read_b64_tr_b16 a[178:179], v6 offset:45568
    ds_read_b64_tr_b16 a[180:181], v7 offset:45056
    ds_read_b64_tr_b16 a[182:183], v7 offset:45568
    ds_read_b64_tr_b16 a[184:185], v8 offset:45056
    ds_read_b64_tr_b16 a[186:187], v8 offset:45568
    ds_read_b64_tr_b16 a[188:189], v22 offset:45056
    ds_read_b64_tr_b16 a[190:191], v22 offset:45568
    ds_read_b64_tr_b16 a[192:193], v6 offset:49152
    ds_read_b64_tr_b16 a[194:195], v6 offset:49664
    ds_read_b64_tr_b16 a[196:197], v7 offset:49152
    ds_read_b64_tr_b16 a[198:199], v7 offset:49664
    ds_read_b64_tr_b16 a[200:201], v8 offset:49152
    ds_read_b64_tr_b16 a[202:203], v8 offset:49664
    ds_read_b64_tr_b16 a[204:205], v22 offset:49152
    ds_read_b64_tr_b16 a[206:207], v22 offset:49664
    ds_read_b64_tr_b16 a[208:209], v6 offset:53248
    ds_read_b64_tr_b16 a[210:211], v6 offset:53760
    ds_read_b64_tr_b16 a[212:213], v7 offset:53248
    ds_read_b64_tr_b16 a[214:215], v7 offset:53760
    ds_read_b64_tr_b16 a[216:217], v8 offset:53248
    ds_read_b64_tr_b16 a[218:219], v8 offset:53760
    ds_read_b64_tr_b16 a[220:221], v22 offset:53248
    ds_read_b64_tr_b16 a[222:223], v22 offset:53760
    ds_read_b64_tr_b16 a[224:225], v6 offset:57344
    ds_read_b64_tr_b16 a[226:227], v6 offset:57856
    ds_read_b64_tr_b16 a[228:229], v7 offset:57344
    ds_read_b64_tr_b16 a[230:231], v7 offset:57856
    ds_read_b64_tr_b16 a[232:233], v8 offset:57344
    ds_read_b64_tr_b16 a[234:235], v8 offset:57856
    ds_read_b64_tr_b16 a[236:237], v22 offset:57344
    ds_read_b64_tr_b16 a[238:239], v22 offset:57856
    ds_read_b64_tr_b16 a[240:241], v6 offset:61440
    ds_read_b64_tr_b16 a[242:243], v6 offset:61952
    ds_read_b64_tr_b16 a[244:245], v7 offset:61440
    ds_read_b64_tr_b16 a[246:247], v7 offset:61952
    ds_read_b64_tr_b16 a[248:249], v8 offset:61440
    ds_read_b64_tr_b16 a[250:251], v8 offset:61952
    ds_read_b64_tr_b16 a[252:253], v22 offset:61440
    ds_read_b64_tr_b16 a[254:255], v22 offset:61952
    s_waitcnt vmcnt(7)
    v_mfma_f32_16x16x32_bf16 v[2:5], a[0:3], v[28:31], v[2:5]
    v_mfma_f32_16x16x32_bf16 v[10:13], a[4:7], v[28:31], v[10:13]
    v_mfma_f32_16x16x32_bf16 v[14:17], a[8:11], v[28:31], v[14:17]
    v_mfma_f32_16x16x32_bf16 v[24:27], a[12:15], v[28:31], v[24:27]
    buffer_load_dwordx4 v[60:63], v1, s[32:35], s86 offen offset:0 sc1
    s_waitcnt vmcnt(7)
    v_mfma_f32_16x16x32_bf16 v[2:5], a[16:19], v[32:35], v[2:5]
    v_mfma_f32_16x16x32_bf16 v[10:13], a[20:23], v[32:35], v[10:13]
    v_mfma_f32_16x16x32_bf16 v[14:17], a[24:27], v[32:35], v[14:17]
    v_mfma_f32_16x16x32_bf16 v[24:27], a[28:31], v[32:35], v[24:27]
    buffer_load_dwordx4 v[64:67], v1, s[32:35], s86 offen offset:1024 sc1
    s_waitcnt vmcnt(7)
    v_mfma_f32_16x16x32_bf16 v[2:5], a[32:35], v[36:39], v[2:5]
    v_mfma_f32_16x16x32_bf16 v[10:13], a[36:39], v[36:39], v[10:13]
    v_mfma_f32_16x16x32_bf16 v[14:17], a[40:43], v[36:39], v[14:17]
    v_mfma_f32_16x16x32_bf16 v[24:27], a[44:47], v[36:39], v[24:27]
    buffer_load_dwordx4 v[68:71], v1, s[32:35], s86 offen offset:2048 sc1
    s_waitcnt vmcnt(7)
    v_mfma_f32_16x16x32_bf16 v[2:5], a[48:51], v[40:43], v[2:5]
    v_mfma_f32_16x16x32_bf16 v[10:13], a[52:55], v[40:43], v[10:13]
    v_mfma_f32_16x16x32_bf16 v[14:17], a[56:59], v[40:43], v[14:17]
    v_mfma_f32_16x16x32_bf16 v[24:27], a[60:63], v[40:43], v[24:27]
    buffer_load_dwordx4 v[72:75], v1, s[32:35], s86 offen offset:3072 sc1
    s_waitcnt vmcnt(7)
    v_mfma_f32_16x16x32_bf16 v[2:5], a[64:67], v[44:47], v[2:5]
    v_mfma_f32_16x16x32_bf16 v[10:13], a[68:71], v[44:47], v[10:13]
    v_mfma_f32_16x16x32_bf16 v[14:17], a[72:75], v[44:47], v[14:17]
    v_mfma_f32_16x16x32_bf16 v[24:27], a[76:79], v[44:47], v[24:27]
    buffer_load_dwordx4 v[76:79], v1, s[32:35], s87 offen offset:0 sc1
    s_waitcnt vmcnt(7)
    v_mfma_f32_16x16x32_bf16 v[2:5], a[80:83], v[48:51], v[2:5]
    v_mfma_f32_16x16x32_bf16 v[10:13], a[84:87], v[48:51], v[10:13]
    v_mfma_f32_16x16x32_bf16 v[14:17], a[88:91], v[48:51], v[14:17]
    v_mfma_f32_16x16x32_bf16 v[24:27], a[92:95], v[48:51], v[24:27]
    buffer_load_dwordx4 v[80:83], v1, s[32:35], s87 offen offset:1024 sc1
    s_waitcnt vmcnt(7)
    v_mfma_f32_16x16x32_bf16 v[2:5], a[96:99], v[52:55], v[2:5]
    v_mfma_f32_16x16x32_bf16 v[10:13], a[100:103], v[52:55], v[10:13]
    v_mfma_f32_16x16x32_bf16 v[14:17], a[104:107], v[52:55], v[14:17]
    v_mfma_f32_16x16x32_bf16 v[24:27], a[108:111], v[52:55], v[24:27]
    buffer_load_dwordx4 v[84:87], v1, s[32:35], s87 offen offset:2048 sc1
    s_waitcnt vmcnt(7)
    v_mfma_f32_16x16x32_bf16 v[2:5], a[112:115], v[56:59], v[2:5]
    v_mfma_f32_16x16x32_bf16 v[10:13], a[116:119], v[56:59], v[10:13]
    v_mfma_f32_16x16x32_bf16 v[14:17], a[120:123], v[56:59], v[14:17]
    v_mfma_f32_16x16x32_bf16 v[24:27], a[124:127], v[56:59], v[24:27]
    buffer_load_dwordx4 v[88:91], v1, s[32:35], s87 offen offset:3072 sc1
    s_waitcnt vmcnt(7)
    v_mfma_f32_16x16x32_bf16 v[2:5], a[128:131], v[60:63], v[2:5]
    v_mfma_f32_16x16x32_bf16 v[10:13], a[132:135], v[60:63], v[10:13]
    v_mfma_f32_16x16x32_bf16 v[14:17], a[136:139], v[60:63], v[14:17]
    v_mfma_f32_16x16x32_bf16 v[24:27], a[140:143], v[60:63], v[24:27]
    s_waitcnt vmcnt(6) lgkmcnt(15)
    v_mfma_f32_16x16x32_bf16 v[2:5], a[144:147], v[64:67], v[2:5]
    v_mfma_f32_16x16x32_bf16 v[10:13], a[148:151], v[64:67], v[10:13]
    v_mfma_f32_16x16x32_bf16 v[14:17], a[152:155], v[64:67], v[14:17]
    v_mfma_f32_16x16x32_bf16 v[24:27], a[156:159], v[64:67], v[24:27]
    s_waitcnt vmcnt(5)
    v_mfma_f32_16x16x32_bf16 v[2:5], a[160:163], v[68:71], v[2:5]
    v_mfma_f32_16x16x32_bf16 v[10:13], a[164:167], v[68:71], v[10:13]
    v_mfma_f32_16x16x32_bf16 v[14:17], a[168:171], v[68:71], v[14:17]
    v_mfma_f32_16x16x32_bf16 v[24:27], a[172:175], v[68:71], v[24:27]
    s_waitcnt vmcnt(4)
    v_mfma_f32_16x16x32_bf16 v[2:5], a[176:179], v[72:75], v[2:5]
    v_mfma_f32_16x16x32_bf16 v[10:13], a[180:183], v[72:75], v[10:13]
    v_mfma_f32_16x16x32_bf16 v[14:17], a[184:187], v[72:75], v[14:17]
    v_mfma_f32_16x16x32_bf16 v[24:27], a[188:191], v[72:75], v[24:27]
    s_waitcnt vmcnt(3)
    v_mfma_f32_16x16x32_bf16 v[2:5], a[192:195], v[76:79], v[2:5]
    v_mfma_f32_16x16x32_bf16 v[10:13], a[196:199], v[76:79], v[10:13]
    v_mfma_f32_16x16x32_bf16 v[14:17], a[200:203], v[76:79], v[14:17]
    v_mfma_f32_16x16x32_bf16 v[24:27], a[204:207], v[76:79], v[24:27]
    s_waitcnt vmcnt(2)
    v_mfma_f32_16x16x32_bf16 v[2:5], a[208:211], v[80:83], v[2:5]
    v_mfma_f32_16x16x32_bf16 v[10:13], a[212:215], v[80:83], v[10:13]
    v_mfma_f32_16x16x32_bf16 v[14:17], a[216:219], v[80:83], v[14:17]
    v_mfma_f32_16x16x32_bf16 v[24:27], a[220:223], v[80:83], v[24:27]
    s_waitcnt vmcnt(1) lgkmcnt(8)
    v_mfma_f32_16x16x32_bf16 v[2:5], a[224:227], v[84:87], v[2:5]
    v_mfma_f32_16x16x32_bf16 v[10:13], a[228:231], v[84:87], v[10:13]
    v_mfma_f32_16x16x32_bf16 v[14:17], a[232:235], v[84:87], v[14:17]
    v_mfma_f32_16x16x32_bf16 v[24:27], a[236:239], v[84:87], v[24:27]
    s_waitcnt vmcnt(0) lgkmcnt(0)
    v_mfma_f32_16x16x32_bf16 v[2:5], a[240:243], v[88:91], v[2:5]
    v_mfma_f32_16x16x32_bf16 v[10:13], a[244:247], v[88:91], v[10:13]
    v_mfma_f32_16x16x32_bf16 v[14:17], a[248:251], v[88:91], v[14:17]
    v_mfma_f32_16x16x32_bf16 v[24:27], a[252:255], v[88:91], v[24:27]
    s_nop 4
    v_cvt_pk_bf16_f32 v28, v2, v3
    v_cvt_pk_bf16_f32 v29, v4, v5
    v_cvt_pk_bf16_f32 v30, v10, v11
    v_cvt_pk_bf16_f32 v31, v12, v13
    v_cvt_pk_bf16_f32 v32, v14, v15
    v_cvt_pk_bf16_f32 v33, v16, v17
    v_cvt_pk_bf16_f32 v34, v24, v25
    v_cvt_pk_bf16_f32 v35, v26, v27
    v_permlane16_swap_b32 v28, v30
    v_permlane16_swap_b32 v29, v31
    v_permlane16_swap_b32 v32, v34
    v_permlane16_swap_b32 v33, v35
    buffer_store_dwordx4 v[28:31], v21, s[28:31], s83 offen offset:0 sc1
    buffer_store_dwordx4 v[32:35], v21, s[28:31], s83 offen offset:64 sc1
    v_mov_b32 v2, s46
    s_cmp_eq_u32 s2, 0
    s_cselect_b32 s80, 0, 0x40000000
    v_or_b32 v3, s80, v9
    buffer_store_dword v2, v3, s[32:35], 0 offen offset:0
L_exit:
    s_endpgm
L_spin_1:
buffer_load_dwordx2 v[202:203], v5, s[32:35], s86 offen offset:0 sc1
s_sub_u32 s48, s48, 1
s_max_i32 s48, s48, 0
s_cmp_lg_u32 s48, 0
s_cselect_b64 s[94:95], -1, 0
s_waitcnt vmcnt(0)
v_cmp_ne_u32 vcc, s46, v202
s_nop 1
s_and_b64 vcc, vcc, s[94:95]
s_cbranch_scc1 L_spin_1
s_branch L_ok_2
L_slow_3:
    s_nop 7
    buffer_store_dwordx4 v[144:147], v47, s[32:35], s60 offen sc1
    buffer_store_dwordx4 v[148:151], v47, s[32:35], s81 offen sc1
    s_nop 1
    s_branch L_back_4
L_slow_5:
    s_nop 7
    buffer_store_dword v0, v9, s[32:35], s67 offen offset:0 sc1
    s_nop 1
    s_branch L_back_6
L_slow_7:
    s_nop 7
    buffer_store_dwordx4 v[152:155], v1, s[32:35], s91 offen offset:0 sc1
    buffer_store_dwordx4 v[152:155], v1, s[32:35], s91 offen offset:1024 sc1
    buffer_store_dwordx4 v[152:155], v1, s[32:35], s91 offen offset:1280 sc1
    s_nop 1
    s_branch L_back_8
L_slow_10:
    s_nop 7
    buffer_store_dwordx4 v[24:27], v6, s[32:35], s62 offen offset:0 sc1
    buffer_store_dwordx4 v[28:31], v6, s[32:35], s62 offen offset:1024 sc1
    s_nop 1
    s_branch L_back_11
L_slow_12:
    s_nop 7
    buffer_store_dword v2, v10, s[32:35], s64 offen sc1
    s_nop 1
    s_branch L_back_13
L_slow_14:
    s_nop 7
    buffer_store_dword v0, v9, s[32:35], s67 offen offset:32 sc1
    s_nop 1
    s_branch L_back_15
L_spin_17:
buffer_load_dword v125, v124, s[32:35], s3 offen offset:0 sc1
s_sub_u32 s48, s48, 1
s_max_i32 s48, s48, 0
s_cmp_lg_u32 s48, 0
s_cselect_b64 s[94:95], -1, 0
s_waitcnt vmcnt(0)
v_cmp_ne_u32 vcc, s46, v125
s_nop 1
s_and_b64 vcc, vcc, s[94:95]
s_cbranch_scc1 L_spin_17
s_branch L_ok_18
L_slow_19:
    s_nop 7
    buffer_store_dwordx4 v[72:75], v0, s[32:35], s88 offen offset:1024 sc1
    buffer_store_dwordx4 v[76:79], v0, s[32:35], s88 offen offset:1040 sc1
    buffer_store_dwordx4 v[22:25], v1, s[32:35], s88 offen sc1
    s_nop 1
    s_branch L_back_20
L_s2r_23:
    s_nop 7
    buffer_load_dwordx4 v[124:127], v29, s[32:35], s85 offen offset:1024 sc1
    buffer_load_dwordx4 v[42:45], v30, s[32:35], s85 offen offset:0 sc1
    buffer_load_dwordx4 v[46:49], v30, s[32:35], s86 offen offset:0 sc1
    buffer_load_dwordx4 v[50:53], v30, s[32:35], s85 offen offset:256 sc1
    buffer_load_dwordx4 v[58:61], v30, s[32:35], s86 offen offset:256 sc1
    buffer_load_dwordx4 v[64:67], v30, s[32:35], s85 offen offset:512 sc1
    buffer_load_dwordx4 v[68:71], v30, s[32:35], s86 offen offset:512 sc1
    buffer_load_dwordx4 v[22:25], v30, s[32:35], s85 offen offset:768 sc1
    buffer_load_dwordx4 v[72:75], v30, s[32:35], s86 offen offset:768 sc1
    s_waitcnt vmcnt(0)
    s_branch L_s2_22
L_slow_24:
    s_nop 7
    buffer_store_dwordx4 v[84:87], v6, s[32:35], s60 offen sc1
    buffer_store_dwordx4 v[88:91], v6, s[32:35], s81 offen sc1
    s_nop 1
    s_branch L_back_25
L_slow_26:
    s_nop 7
    buffer_store_dword v14, v9, s[32:35], s67 offen offset:0 sc1
    s_nop 1
    s_branch L_back_27
L_slow_29:
    s_nop 7
    buffer_store_dwordx4 v[24:27], v6, s[32:35], s62 offen offset:0 sc1
    buffer_store_dwordx4 v[28:31], v6, s[32:35], s62 offen offset:1024 sc1
    s_nop 1
    s_branch L_back_30
L_slow_31:
    s_nop 7
    buffer_store_dword v2, v7, s[32:35], s64 offen sc1
    s_nop 1
    s_branch L_back_32
L_slow_33:
    s_nop 7
    buffer_store_dword v0, v9, s[32:35], s67 offen offset:32 sc1
    s_nop 1
    s_branch L_back_34
L_spin_36:
buffer_load_dword v21, v2, s[32:35], s82 offen offset:0 sc1
s_sub_u32 s48, s48, 1
s_max_i32 s48, s48, 0
s_cmp_lg_u32 s48, 0
s_cselect_b64 s[94:95], -1, 0
s_waitcnt vmcnt(0)
v_cmp_ne_u32 vcc, s86, v21
s_nop 1
s_and_b64 vcc, vcc, s[94:95]
s_cbranch_scc1 L_spin_36
s_branch L_ok_37
L_slow_38:
    s_nop 7
    buffer_store_dwordx4 v[68:71], v0, s[32:35], s60 offen sc1
    buffer_store_dwordx4 v[72:75], v0, s[32:35], s81 offen sc1
    s_nop 1
    s_branch L_back_39
L_slow_40:
    s_nop 7
    buffer_store_dword v2, v9, s[32:35], s67 offen offset:0 sc1
    s_nop 1
    s_branch L_back_41
L_slow_43:
    s_nop 7
    buffer_store_dwordx4 v[24:27], v6, s[32:35], s62 offen offset:0 sc1
    buffer_store_dwordx4 v[28:31], v6, s[32:35], s62 offen offset:1024 sc1
    s_nop 1
    s_branch L_back_44
L_slow_45:
    s_nop 7
    buffer_store_dword v2, v7, s[32:35], s64 offen sc1
    s_nop 1
    s_branch L_back_46
L_slow_47:
    s_nop 7
    buffer_store_dword v8, v9, s[32:35], s67 offen offset:32 sc1
    s_nop 1
    s_branch L_back_48
L_slow_50:
    s_nop 7
    buffer_store_dwordx4 v[60:63], v0, s[32:35], s88 offen offset:1024 sc1
    buffer_store_dwordx4 v[64:67], v0, s[32:35], s88 offen offset:1040 sc1
    buffer_store_dwordx4 v[10:13], v1, s[32:35], s88 offen sc1
    s_nop 1
    s_branch L_back_51
L_s2r_54:
    s_nop 7
    buffer_load_dwordx4 v[120:123], v27, s[32:35], s85 offen offset:1024 sc1
    buffer_load_dwordx4 a[224:227], v28, s[32:35], s85 offen offset:0 sc1
    buffer_load_dwordx4 a[228:231], v28, s[32:35], s86 offen offset:0 sc1
    buffer_load_dwordx4 a[232:235], v28, s[32:35], s85 offen offset:256 sc1
    buffer_load_dwordx4 a[236:239], v28, s[32:35], s86 offen offset:256 sc1
    buffer_load_dwordx4 a[240:243], v28, s[32:35], s85 offen offset:512 sc1
    buffer_load_dwordx4 a[244:247], v28, s[32:35], s86 offen offset:512 sc1
    buffer_load_dwordx4 a[248:251], v28, s[32:35], s85 offen offset:768 sc1
    buffer_load_dwordx4 a[252:255], v28, s[32:35], s86 offen offset:768 sc1
    s_waitcnt vmcnt(0)
    s_branch L_s2_53
L_slow_55:
    s_nop 7
    buffer_store_dwordx4 v[72:75], v24, s[32:35], s60 offen sc1
    buffer_store_dwordx4 v[76:79], v24, s[32:35], s81 offen sc1
    s_nop 1
    s_branch L_back_56
L_slow_57:
    s_nop 7
    buffer_store_dword v25, v9, s[32:35], s67 offen offset:0 sc1
    s_nop 1
    s_branch L_back_58
L_code_end:
    s_endpgm
.section .rodata,"a"
.p2align 6
.amdhsa_kernel interleave_layers__sliding_local_dilated__linear_kernel_hedgehog__prompt_kernel
  .amdhsa_next_free_vgpr 512
  .amdhsa_next_free_sgpr 102
  .amdhsa_accum_offset 256
  .amdhsa_group_segment_fixed_size 0
  .amdhsa_kernarg_size 80
  .amdhsa_user_sgpr_count 2
  .amdhsa_user_sgpr_kernarg_segment_ptr 1
  .amdhsa_system_sgpr_workgroup_id_x 1
.end_amdhsa_kernel
```
